```python
import torch

def _softmax(x, axis=-1):
    return torch.softmax(x, dim=axis)
def _gelu(x):
    return torch.nn.functional.gelu(x, approximate="tanh")
def _silu(x):
    return torch.nn.functional.silu(x)
def _sigmoid(x):
    return torch.sigmoid(x)
def _layernorm(x, axis=-1, eps=1e-5):
    m = x.mean(dim=axis, keepdim=True)
    v = x.var(dim=axis, keepdim=True, unbiased=False)
    return (x - m) / torch.sqrt(v + eps)
def _scatter_add(tgt, idx, src, axis=0):
    return tgt.clone().index_add_(axis, idx, src)
def _segment_sum(src, seg, n):
    out = torch.zeros((n,) + src.shape[1:], dtype=src.dtype)
    return out.index_add_(0, seg, src)
def _pad(x, pw):
    flat = tuple(v for pair in reversed(pw) for v in pair)
    return torch.nn.functional.pad(x, flat)

kernel_name = 'recurrent_scan__sliding_local_dilated__glu_gated_bilinear__prompt'

def setup_inputs():

    _w = (lambda a: (lambda t: t.to(torch.bfloat16) if t.is_floating_point() else t)(torch.as_tensor(a)))
    def _A_setup():
        B, S, D = 1, 2048, 512
        return {
            "x": _w((lambda *s: torch.randn(*s, dtype=torch.bfloat16) * 0.05)(B, S, D)),
            "wqkv": _w((lambda *s: torch.randn(*s, dtype=torch.bfloat16) * 0.2)(D, 3 * D)),
            "wo": _w((lambda *s: torch.randn(*s, dtype=torch.bfloat16) * 0.2)(D, D)),
        }
    _A_in = _A_setup()

    def _B_setup():
        B, S, D, F = 1, 2048, 512, 1792
        return {
            "x": _w((lambda *s: torch.randn(*s, dtype=torch.bfloat16) * 0.05)(B, S, D)),
            "w_gate": _w((lambda *s: torch.randn(*s, dtype=torch.bfloat16) * 0.1)(D, F) * (D ** -0.5)),
            "w_up": _w((lambda *s: torch.randn(*s, dtype=torch.bfloat16) * 0.1)(D, F) * (D ** -0.5)),
            "w_down": _w((lambda *s: torch.randn(*s, dtype=torch.bfloat16) * 0.1)(F, D) * (F ** -0.5)),
        }
    _B_in = _B_setup()

    return {
        "A_x": _A_in["x"],
        "A_wqkv": _A_in["wqkv"],
        "A_wo": _A_in["wo"],
        "B_x": _B_in["x"],
        "B_w_gate": _B_in["w_gate"],
        "B_w_up": _B_in["w_up"],
        "B_w_down": _B_in["w_down"],
    }

def reference(A_x, A_wqkv, A_wo, B_x, B_w_gate, B_w_up, B_w_down):
    def _A_ref(x, wqkv, wo):
        B, S, D = x.shape
        H = 32; Dh = D // H
        W, dil = 8, 2
        qkv = (lambda x, *d: x.permute(*d))((x @ wqkv).reshape(B, S, 3, H, Dh), 2, 0, 3, 1, 4)
        q, k, v = qkv[0], qkv[1], qkv[2]
        scale = Dh ** -0.5
        pos = torch.arange(S)
        off = torch.arange(W) * dil
        idx = pos[:, None] - off[None, :]
        mask = idx >= 0
        idx_c = torch.where(mask, idx, 0).reshape(-1)
        kg = k[:, :, idx_c, :].reshape(B, H, S, W, Dh)
        vg = v[:, :, idx_c, :].reshape(B, H, S, W, Dh)
        logits = torch.einsum("bhsd,bhswd->bhsw", q, kg) * scale
        logits = torch.where(mask[None, None, :, :], logits, -1e9)
        attn = _softmax(logits, axis=-1)
        o = torch.einsum("bhsw,bhswd->bhsd", attn, vg)
        return (lambda x, *d: x.permute(*d))(o, 0, 2, 1, 3).reshape(B, S, D) @ wo

    def _B_ref(x, w_gate, w_up, w_down):
        g = torch.einsum("bsd,df->bsf", x, w_gate)
        u = torch.einsum("bsd,df->bsf", x, w_up)
        h = g * u
        return torch.einsum("bsf,fd->bsd", h, w_down)

    x = A_x
    xn = _layernorm(x, axis=-1)
    s = _A_ref(xn, A_wqkv, A_wo)
    g = _silu(_B_ref(xn, B_w_gate, B_w_up, B_w_down))
    return x + s * g
```

```asm
; @launch grid=(256,1,1) block=(256,1,1) lds=163840
.amdgcn_target "amdgcn-amd-amdhsa--gfx950"
.text
.globl recurrent_scan__sliding_local_dilated__glu_gated_bilinear__prompt_kernel
.p2align 8
.type recurrent_scan__sliding_local_dilated__glu_gated_bilinear__prompt_kernel,@function
recurrent_scan__sliding_local_dilated__glu_gated_bilinear__prompt_kernel:
    s_cmp_ge_u32 s2, 0x100
    s_cbranch_scc1 L_end
    s_load_dwordx16 s[8:23], s[0:1], 0
    s_load_dwordx4 s[24:27], s[0:1], 64
    s_lshr_b32 s6, s2, 3
    s_getpc_b64 s[48:49]
L_pc_1:
    s_and_b32 s51, s6, 15
    s_lshl_b32 s51, s51, 12
    v_lshrrev_b32 v201, 3, v0
    v_and_b32 v201, 24, v201
    v_and_or_b32 v201, v0, 7, v201
    v_lshl_add_u32 v201, v201, 7, s51
    s_mov_b32 s51, L_code_end-L_pc_1-4
    v_min_u32 v201, s51, v201
    global_load_dword a199, v201, s[48:49]
    s_bitcmp1_b32 s6, 3
    s_cbranch_scc1 L_typeB
    v_and_b32 v200, 63, v0
    v_lshrrev_b32 v201, 6, v0
    s_and_b32 s7, s2, 7
    v_readfirstlane_b32 s3, v201
    s_and_b32 s4, s7, 1
    s_lshl_b32 s4, s4, 3
    s_and_b32 s51, s6, 7
    s_add_u32 s4, s4, s51
    s_and_b32 s5, s7, 6
    s_lshr_b32 s51, s6, 4
    s_add_u32 s5, s5, s51
    v_and_b32 v201, 7, v200
    v_lshrrev_b32 v202, 4, v200
    v_xor_b32 v201, v201, v202
    v_lshlrev_b32 v201, 4, v201
    v_lshrrev_b32 v202, 3, v200
    v_lshlrev_b32 v202, 10, v202
    v_or_b32 v204, v201, v202
    v_xor_b32 v203, 64, v204
    v_add_u32 v205, 0x1c00, v203
    v_add_u32 v206, 0x3800, v204
    v_add_u32 v207, 0x5400, v203
    s_lshl_b32 s50, s3, 15
    s_lshl_b32 s51, s4, 17
    s_add_u32 s74, s51, s50
    s_lshr_b32 s52, s6, 3
    s_add_u32 s52, s52, s6
    s_and_b32 s76, s52, 3
    s_lshl_b32 s75, s76, 8
    s_mov_b32 s42, 0x1f00000
    s_mov_b32 s43, 0x20000
    s_mov_b32 s30, 0x180000
    s_mov_b32 s31, 0x20000
    s_sub_u32 s52, s51, 0x4000
    v_add_u32 v196, s52, v204
    s_add_u32 s52, s52, 0x400
    v_add_u32 v197, s52, v205
    s_add_u32 s49, s3, s76
    s_and_b32 s49, s49, 3
    s_lshl_b32 s49, s49, 8
    s_lshr_b32 s55, s50, 3
    s_lshl_b32 s65, s5, 1
    s_lshl_b32 s53, s5, 7
    s_mul_i32 s51, s76, 0x60000
    s_add_u32 s53, s53, s51
    v_and_b32 v201, 3, v200
    v_mul_u32_u24 v201, 0xc00, v201
    v_lshrrev_b32 v202, 4, v200
    v_min_u32 v202, 2, v202
    v_lshlrev_b32 v202, 10, v202
    v_add_u32 v242, v201, v202
    s_and_b32 s51, s6, 4
    s_and_b32 s52, s7, 1
    s_lshl_b32 s52, s52, 3
    s_add_u32 s51, s51, s52
    s_add_u32 s51, s51, s3
    s_waitcnt lgkmcnt(0)
    s_mov_b32 s28, s10
    s_mov_b32 s29, s11
    s_mov_b32 s10, 0x200000
    s_mov_b32 s11, 0x20000
    s_mov_b32 s40, s26
    s_mov_b32 s41, s27
    s_mov_b32 s26, 0x100
    s_mov_b32 s27, 0x20000
    s_add_u32 m0, s55, 0x20000
    s_nop 0
    buffer_load_dwordx4 v196, s[8:11], s49 offen lds
    s_add_u32 m0, s55, 0x20400
    s_nop 0
    buffer_load_dwordx4 v197, s[8:11], s49 offen lds
    s_add_u32 s49, s49, 0x80
    s_add_u32 m0, s55, 0x20800
    s_nop 0
    buffer_load_dwordx4 v196, s[8:11], s49 offen lds
    s_add_u32 m0, s55, 0x20c00
    s_nop 0
    buffer_load_dwordx4 v197, s[8:11], s49 offen lds
    s_or_b32 s64, s2, s3
    s_cbranch_scc1 L_noep_2
    s_mov_b32 s64, 30408704
    buffer_load_dword v249, off, s[40:43], s64 sc1
L_noep_2:
    s_add_u32 m0, s50, 0
    s_add_u32 s48, s74, s75
    buffer_load_dwordx4 v204, s[8:11], s48 offen lds
    buffer_load_dwordx4 v205, s[8:11], s48 offen offset:1024 lds
    buffer_load_dwordx4 v206, s[8:11], s48 offen offset:2048 lds
    buffer_load_dwordx4 v207, s[8:11], s48 offen offset:3072 lds
    s_add_u32 s75, s75, 0x80
    s_and_b32 s75, s75, 0x3ff
    s_add_u32 m0, s50, 0x1000
    s_add_u32 s48, s74, s75
    buffer_load_dwordx4 v204, s[8:11], s48 offen lds
    buffer_load_dwordx4 v205, s[8:11], s48 offen offset:1024 lds
    buffer_load_dwordx4 v206, s[8:11], s48 offen offset:2048 lds
    buffer_load_dwordx4 v207, s[8:11], s48 offen offset:3072 lds
    s_add_u32 s75, s75, 0x80
    s_and_b32 s75, s75, 0x3ff
    s_mul_i32 s51, s51, 0x3000
    s_add_u32 s67, s51, s53
    s_cmp_ge_u32 s3, 2
    s_cselect_b32 s44, s18, s16
    s_cselect_b32 s45, s19, s17
    v_and_b32 v190, 15, v200
    v_lshrrev_b32 v191, 4, v200
    v_lshrrev_b32 v193, 5, v200
    v_and_b32 v194, 1, v191
    v_lshrrev_b32 v192, 2, v190
    v_lshlrev_b32 v243, 4, v200
    s_mov_b32 s62, 0xffff0000
    s_mov_b32 s63, 0x3f803f80
    s_mov_b32 s77, 0x3b000000
    s_mov_b32 s71, 0x3eb8aa3b
    v_and_b32 v208, 31, v200
    v_lshlrev_b32 v209, 7, v208
    v_bfe_u32 v208, v200, 1, 3
    v_xor_b32 v208, v208, v193
    v_lshlrev_b32 v208, 4, v208
    v_add_u32 v209, s50, v209
    v_xor_b32 v210, 0, v208
    v_add_u32 v216, v209, v210
    v_xor_b32 v210, 32, v208
    v_add_u32 v217, v209, v210
    v_xor_b32 v210, 64, v208
    v_add_u32 v218, v209, v210
    v_xor_b32 v210, 0x60, v208
    v_add_u32 v219, v209, v210
    v_mov_b32 v220, 0
    v_mov_b32 v221, 0
    v_mov_b32 v222, 0
    v_mov_b32 v223, 0
    v_lshlrev_b32 v209, 7, v190
    v_lshrrev_b32 v208, 1, v190
    v_xor_b32 v208, v208, v191
    v_lshlrev_b32 v208, 4, v208
    s_add_u32 s51, s55, 0x20000
    v_add_u32 v209, s51, v209
    v_add_u32 v144, v209, v208
    v_xor_b32 v208, 64, v208
    v_add_u32 v145, v209, v208
    v_mov_b32 v149, 0
    v_mov_b32 v150, 0
    v_mov_b32 v151, 0
    v_mov_b32 v152, 0
    v_add_u32 v247, 0x24000, v243
    v_lshlrev_b32 v146, 3, v200
    v_add_u32 v146, 0x20000, v146
    v_add_u32 v147, s55, v146
    v_add_u32 v148, s55, v247
    s_and_b32 s51, s3, 1
    s_lshl_b32 s51, s51, 4
    s_lshr_b32 s70, s3, 1
    s_lshl_b32 s52, s70, 3
    s_add_u32 s52, s52, s51
    v_lshrrev_b32 v208, 3, v200
    v_and_b32 v209, 2, v208
    v_lshlrev_b32 v209, 5, v209
    v_and_b32 v210, 7, v200
    v_lshlrev_b32 v210, 4, v210
    v_xor_b32 v210, v210, v209
    v_add_u32 v211, s52, v208
    v_mul_u32_u24 v212, 0xc00, v211
    v_add_u32 v240, v212, v210
    s_lshl_b32 s51, s51, 1
    v_lshrrev_b32 v212, 2, v200
    v_add_u32 v212, s51, v212
    v_mul_u32_u24 v212, 0xe00, v212
    v_and_b32 v213, 3, v200
    v_lshlrev_b32 v213, 4, v213
    s_lshl_b32 s52, s70, 5
    v_xor_b32 v213, s52, v213
    v_add_u32 v238, v212, v213
    s_lshl_b32 s54, s65, 5
    s_mov_b32 s46, 0x1c0000
    s_mov_b32 s47, 0x20000
    s_mul_i32 s51, s76, 0x70000
    s_add_u32 s54, s54, s51
    v_and_b32 v250, 3, v200
    v_lshlrev_b32 v250, 2, v250
    v_lshl_add_u32 v241, v208, 10, v210
    v_min_u32 v239, 13, v200
    v_lshlrev_b32 v239, 7, v239
    v_lshlrev_b32 v234, 5, v250
    v_and_b32 v235, 15, v200
    v_mul_u32_u24 v235, 0xe00, v235
    v_lshlrev_b32 v208, 7, v192
    v_and_b32 v209, 3, v200
    v_lshlrev_b32 v209, 3, v209
    v_add_u32 v208, v208, v209
    v_and_b32 v210, 2, v192
    v_or_b32 v211, v210, v194
    v_lshlrev_b32 v211, 5, v211
    v_lshlrev_b32 v212, 16, v193
    v_add_u32 v212, v212, v208
    v_xor_b32 v214, 0, v211
    v_add_u32 v236, v214, v212
    v_xor_b32 v214, 64, v211
    v_add_u32 v237, v214, v212
    v_lshlrev_b32 v214, 3, v193
    v_add_u32 v214, v214, v192
    v_lshlrev_b32 v214, 6, v214
    v_lshlrev_b32 v215, 16, v194
    v_add3_u32 v214, v214, v215, v209
    v_lshlrev_b32 v215, 5, v194
    v_add_u32 v232, v214, v215
    v_xor_b32 v215, 32, v215
    v_add_u32 v233, v214, v215
    v_lshlrev_b32 v212, 9, v193
    v_add_u32 v212, v212, v208
    s_lshl_b32 s51, s70, 6
    v_xor_b32 v214, s51, v211
    v_add_u32 v213, v214, v212
    v_xor_b32 v214, 64, v213
    s_lshl_b32 s51, s70, 16
    s_lshl_b32 s52, s70, 11
    s_add_u32 s52, s52, 0x20000
    v_add_u32 v215, s51, v213
    v_accvgpr_write_b32 a192, v215
    v_add_u32 v215, s52, v213
    v_accvgpr_write_b32 a194, v215
    v_add_u32 v215, s51, v214
    v_accvgpr_write_b32 a193, v215
    v_add_u32 v215, s52, v214
    v_accvgpr_write_b32 a195, v215
    v_lshlrev_b32 v212, 16, v194
    v_lshlrev_b32 v213, 15, v193
    v_add3_u32 v212, v212, v213, v208
    v_xor_b32 v214, s3, v210
    v_lshlrev_b32 v214, 5, v214
    v_add_u32 v246, v212, v214
    s_mul_i32 s51, s3, 0x1800
    s_add_u32 s51, s51, 0x20000
    v_add_u32 v251, s51, v243
    v_lshlrev_b32 v212, 5, v194
    v_add_u32 v212, v212, v190
    v_lshlrev_b32 v212, 4, v212
    v_lshlrev_b32 v213, 3, v193
    s_mov_b32 s51, 0x20000
    v_add3_u32 v252, v212, v213, s51
    v_and_b32 v208, 31, v200
    v_add_u32 v209, 18, v208
    v_mov_b32 v212, 0x5555
    v_mov_b32 v213, 0
    v_lshlrev_b64 v[210:211], v209, v[212:213]
    s_or_b32 s52, s4, s3
    s_cselect_b32 s52, -1, 0
    v_and_b32 v210, s52, v210
    v_lshlrev_b32 v209, 2, v193
    v_lshrrev_b32 v210, v209, v210
    v_lshrrev_b32 v211, v209, v211
    v_not_b32 v210, v210
    v_not_b32 v211, v211
    v_accvgpr_write_b32 a196, v210
    v_accvgpr_write_b32 a197, v211
    v_and_b32 v210, 1, v208
    v_lshlrev_b32 v210, 4, v210
    v_mov_b32 v211, 0xffff
    v_lshlrev_b32 v253, v210, v211
    v_bfe_i32 v210, v208, 4, 1
    v_and_b32 v254, v210, v253
    v_xor_b32 v255, v254, v253
    s_mov_b64 exec, 0
    s_cmp_eq_u32 s3, 1
    s_cbranch_scc1 L_padA_1
    s_cmp_eq_u32 s3, 2
    s_cbranch_scc1 L_padA_2
    s_cmp_eq_u32 s3, 3
    s_cbranch_scc1 L_padA_3
    s_branch L_padA_0
L_backA:
    s_mov_b64 exec, -1
    s_waitcnt vmcnt(8)
    s_or_b32 s51, s2, s3
    s_cbranch_scc1 L_nopub_3
    s_mov_b32 s51, 0x9e3779b1
    v_mul_lo_u32 v249, v249, s51
    v_add_u32 v249, 0x7f4a7c15, v249
    v_max_u32 v249, 1, v249
    s_mov_b32 s51, 30408704
    buffer_store_dword v249, off, s[40:43], s51 sc1
    buffer_store_dword v249, off, s[24:27], 0 sc1
L_nopub_3:
    ds_read_b128 v[128:131], v144 offset:0
    ds_read_b128 v[132:135], v145 offset:0
    ds_read_b128 v[136:139], v144 offset:2048
    ds_read_b128 v[140:143], v145 offset:2048
    s_add_u32 m0, s50, 0x2000
    s_add_u32 s48, s74, s75
    buffer_load_dwordx4 v204, s[8:11], s48 offen lds
    buffer_load_dwordx4 v205, s[8:11], s48 offen offset:1024 lds
    buffer_load_dwordx4 v206, s[8:11], s48 offen offset:2048 lds
    buffer_load_dwordx4 v207, s[8:11], s48 offen offset:3072 lds
    s_add_u32 s75, s75, 0x80
    s_and_b32 s75, s75, 0x3ff
    s_waitcnt lgkmcnt(1)
    v_dot2_f32_bf16 v149, v128, s63, v149
    v_dot2_f32_bf16 v151, v128, v128, v151
    v_dot2_f32_bf16 v150, v129, s63, v150
    v_dot2_f32_bf16 v152, v129, v129, v152
    v_dot2_f32_bf16 v149, v130, s63, v149
    v_dot2_f32_bf16 v151, v130, v130, v151
    v_dot2_f32_bf16 v150, v131, s63, v150
    v_dot2_f32_bf16 v152, v131, v131, v152
    v_dot2_f32_bf16 v149, v132, s63, v149
    v_dot2_f32_bf16 v151, v132, v132, v151
    v_dot2_f32_bf16 v150, v133, s63, v150
    v_dot2_f32_bf16 v152, v133, v133, v152
    v_dot2_f32_bf16 v149, v134, s63, v149
    v_dot2_f32_bf16 v151, v134, v134, v151
    v_dot2_f32_bf16 v150, v135, s63, v150
    v_dot2_f32_bf16 v152, v135, v135, v152
    v_dot2_f32_bf16 v149, v136, s63, v149
    v_dot2_f32_bf16 v151, v136, v136, v151
    v_dot2_f32_bf16 v150, v137, s63, v150
    v_dot2_f32_bf16 v152, v137, v137, v152
    v_dot2_f32_bf16 v149, v138, s63, v149
    v_dot2_f32_bf16 v151, v138, v138, v151
    v_dot2_f32_bf16 v150, v139, s63, v150
    v_dot2_f32_bf16 v152, v139, v139, v152
    s_waitcnt lgkmcnt(0)
    v_dot2_f32_bf16 v149, v140, s63, v149
    v_dot2_f32_bf16 v151, v140, v140, v151
    v_dot2_f32_bf16 v150, v141, s63, v150
    v_dot2_f32_bf16 v152, v141, v141, v152
    v_dot2_f32_bf16 v149, v142, s63, v149
    v_dot2_f32_bf16 v151, v142, v142, v151
    v_dot2_f32_bf16 v150, v143, s63, v150
    v_dot2_f32_bf16 v152, v143, v143, v152
    s_nop 1
    v_add_f32 v154, v149, v150
    v_add_f32 v155, v151, v152
    v_mov_b32 v156, v154
    v_mov_b32 v157, v155
    s_nop 0
    v_permlane16_swap_b32 v154, v156
    v_permlane16_swap_b32 v155, v157
    v_add_f32 v154, v154, v156
    v_add_f32 v155, v155, v157
    v_mov_b32 v156, v154
    v_mov_b32 v157, v155
    s_nop 0
    v_permlane32_swap_b32 v154, v156
    v_permlane32_swap_b32 v155, v157
    v_add_f32 v154, v154, v156
    v_add_f32 v155, v155, v157
    ds_write_b64 v147, v[154:155] offset:0
    s_waitcnt vmcnt(8)
    ds_read_b128 v[0:3], v216 offset:0
    ds_read_b128 v[4:7], v217 offset:0
    ds_read_b128 v[8:11], v218 offset:0
    ds_read_b128 v[12:15], v219 offset:0
    s_add_u32 m0, s50, 0x3000
    s_add_u32 s48, s74, s75
    buffer_load_dwordx4 v204, s[8:11], s48 offen lds
    buffer_load_dwordx4 v205, s[8:11], s48 offen offset:1024 lds
    buffer_load_dwordx4 v206, s[8:11], s48 offen offset:2048 lds
    buffer_load_dwordx4 v207, s[8:11], s48 offen offset:3072 lds
    s_add_u32 s75, s75, 0x80
    s_and_b32 s75, s75, 0x3ff
    s_waitcnt lgkmcnt(1)
    s_barrier
    ds_read_b64 v[158:159], v146 offset:0
    ds_read_b64 v[160:161], v146 offset:4096
    ds_read_b64 v[162:163], v146 offset:8192
    ds_read_b64 v[164:165], v146 offset:12288
    s_waitcnt lgkmcnt(2)
    v_add_f32 v154, v158, v160
    v_add_f32 v155, v159, v161
    s_waitcnt lgkmcnt(0)
    v_add_f32 v156, v162, v164
    v_add_f32 v157, v163, v165
    v_add_f32 v154, v154, v156
    v_add_f32 v155, v155, v157
    v_mul_f32 v154, s77, v154
    v_mul_f32 v156, v154, v154
    v_fma_f32 v155, v155, s77, -v156
    v_max_f32 v155, 0, v155
    v_cvt_pk_bf16_f32 v156, v154, v155
    v_and_b32 v157, s62, v156
    v_add_f32 v157, 0x3727c5ac, v157
    v_cvt_pk_bf16_f32 v157, v157, v157
    v_and_b32 v157, s62, v157
    v_sqrt_f32 v157, v157
    s_nop 0
    v_cvt_pk_bf16_f32 v157, v157, v157
    v_and_b32 v157, s62, v157
    v_rcp_f32 v158, v157
    v_lshlrev_b32 v156, 16, v156
    v_mul_f32 v159, -v156, v158
    v_lshlrev_b32 v224, 16, v128
    v_and_b32 v225, s62, v128
    v_fma_f32 v224, v224, v158, v159
    v_fma_f32 v225, v225, v158, v159
    v_cvt_pk_bf16_f32 v128, v224, v225
    v_lshlrev_b32 v226, 16, v129
    v_and_b32 v227, s62, v129
    v_fma_f32 v226, v226, v158, v159
    v_fma_f32 v227, v227, v158, v159
    v_cvt_pk_bf16_f32 v129, v226, v227
    v_lshlrev_b32 v228, 16, v130
    v_and_b32 v229, s62, v130
    v_fma_f32 v228, v228, v158, v159
    v_fma_f32 v229, v229, v158, v159
    v_cvt_pk_bf16_f32 v130, v228, v229
    v_lshlrev_b32 v230, 16, v131
    v_and_b32 v231, s62, v131
    v_fma_f32 v230, v230, v158, v159
    v_fma_f32 v231, v231, v158, v159
    v_cvt_pk_bf16_f32 v131, v230, v231
    ds_write_b128 v148, v[128:131] offset:0
    v_lshlrev_b32 v224, 16, v132
    v_and_b32 v225, s62, v132
    v_fma_f32 v224, v224, v158, v159
    v_fma_f32 v225, v225, v158, v159
    v_cvt_pk_bf16_f32 v132, v224, v225
    v_lshlrev_b32 v226, 16, v133
    v_and_b32 v227, s62, v133
    v_fma_f32 v226, v226, v158, v159
    v_fma_f32 v227, v227, v158, v159
    v_cvt_pk_bf16_f32 v133, v226, v227
    v_lshlrev_b32 v228, 16, v134
    v_and_b32 v229, s62, v134
    v_fma_f32 v228, v228, v158, v159
    v_fma_f32 v229, v229, v158, v159
    v_cvt_pk_bf16_f32 v134, v228, v229
    v_lshlrev_b32 v230, 16, v135
    v_and_b32 v231, s62, v135
    v_fma_f32 v230, v230, v158, v159
    v_fma_f32 v231, v231, v158, v159
    v_cvt_pk_bf16_f32 v135, v230, v231
    ds_write_b128 v148, v[132:135] offset:1024
    v_lshlrev_b32 v224, 16, v136
    v_and_b32 v225, s62, v136
    v_fma_f32 v224, v224, v158, v159
    v_fma_f32 v225, v225, v158, v159
    v_cvt_pk_bf16_f32 v136, v224, v225
    v_lshlrev_b32 v226, 16, v137
    v_and_b32 v227, s62, v137
    v_fma_f32 v226, v226, v158, v159
    v_fma_f32 v227, v227, v158, v159
    v_cvt_pk_bf16_f32 v137, v226, v227
    v_lshlrev_b32 v228, 16, v138
    v_and_b32 v229, s62, v138
    v_fma_f32 v228, v228, v158, v159
    v_fma_f32 v229, v229, v158, v159
    v_cvt_pk_bf16_f32 v138, v228, v229
    v_lshlrev_b32 v230, 16, v139
    v_and_b32 v231, s62, v139
    v_fma_f32 v230, v230, v158, v159
    v_fma_f32 v231, v231, v158, v159
    v_cvt_pk_bf16_f32 v139, v230, v231
    ds_write_b128 v148, v[136:139] offset:2048
    v_lshlrev_b32 v224, 16, v140
    v_and_b32 v225, s62, v140
    v_fma_f32 v224, v224, v158, v159
    v_fma_f32 v225, v225, v158, v159
    v_cvt_pk_bf16_f32 v140, v224, v225
    v_lshlrev_b32 v226, 16, v141
    v_and_b32 v227, s62, v141
    v_fma_f32 v226, v226, v158, v159
    v_fma_f32 v227, v227, v158, v159
    v_cvt_pk_bf16_f32 v141, v226, v227
    v_lshlrev_b32 v228, 16, v142
    v_and_b32 v229, s62, v142
    v_fma_f32 v228, v228, v158, v159
    v_fma_f32 v229, v229, v158, v159
    v_cvt_pk_bf16_f32 v142, v228, v229
    v_lshlrev_b32 v230, 16, v143
    v_and_b32 v231, s62, v143
    v_fma_f32 v230, v230, v158, v159
    v_fma_f32 v231, v231, v158, v159
    v_cvt_pk_bf16_f32 v143, v230, v231
    ds_write_b128 v148, v[140:143] offset:3072
    s_waitcnt vmcnt(8)
    ds_read_b128 v[16:19], v216 offset:4096
    ds_read_b128 v[20:23], v217 offset:4096
    ds_read_b128 v[24:27], v218 offset:4096
    ds_read_b128 v[28:31], v219 offset:4096
    s_add_u32 m0, s50, 0x4000
    s_add_u32 s48, s74, s75
    buffer_load_dwordx4 v204, s[8:11], s48 offen lds
    buffer_load_dwordx4 v205, s[8:11], s48 offen offset:1024 lds
    buffer_load_dwordx4 v206, s[8:11], s48 offen offset:2048 lds
    buffer_load_dwordx4 v207, s[8:11], s48 offen offset:3072 lds
    s_add_u32 s75, s75, 0x80
    s_and_b32 s75, s75, 0x3ff
    v_dot2_f32_bf16 v220, v0, s63, v220
    v_dot2_f32_bf16 v222, v0, v0, v222
    v_dot2_f32_bf16 v221, v1, s63, v221
    v_dot2_f32_bf16 v223, v1, v1, v223
    v_dot2_f32_bf16 v220, v2, s63, v220
    v_dot2_f32_bf16 v222, v2, v2, v222
    v_dot2_f32_bf16 v221, v3, s63, v221
    v_dot2_f32_bf16 v223, v3, v3, v223
    v_dot2_f32_bf16 v220, v4, s63, v220
    v_dot2_f32_bf16 v222, v4, v4, v222
    v_dot2_f32_bf16 v221, v5, s63, v221
    v_dot2_f32_bf16 v223, v5, v5, v223
    v_dot2_f32_bf16 v220, v6, s63, v220
    v_dot2_f32_bf16 v222, v6, v6, v222
    v_dot2_f32_bf16 v221, v7, s63, v221
    v_dot2_f32_bf16 v223, v7, v7, v223
    v_dot2_f32_bf16 v220, v8, s63, v220
    v_dot2_f32_bf16 v222, v8, v8, v222
    v_dot2_f32_bf16 v221, v9, s63, v221
    v_dot2_f32_bf16 v223, v9, v9, v223
    v_dot2_f32_bf16 v220, v10, s63, v220
    v_dot2_f32_bf16 v222, v10, v10, v222
    v_dot2_f32_bf16 v221, v11, s63, v221
    v_dot2_f32_bf16 v223, v11, v11, v223
    v_dot2_f32_bf16 v220, v12, s63, v220
    v_dot2_f32_bf16 v222, v12, v12, v222
    v_dot2_f32_bf16 v221, v13, s63, v221
    v_dot2_f32_bf16 v223, v13, v13, v223
    v_dot2_f32_bf16 v220, v14, s63, v220
    v_dot2_f32_bf16 v222, v14, v14, v222
    v_dot2_f32_bf16 v221, v15, s63, v221
    v_dot2_f32_bf16 v223, v15, v15, v223
    s_waitcnt vmcnt(8)
    ds_read_b128 v[32:35], v216 offset:8192
    ds_read_b128 v[36:39], v217 offset:8192
    ds_read_b128 v[40:43], v218 offset:8192
    ds_read_b128 v[44:47], v219 offset:8192
    s_add_u32 m0, s50, 0x5000
    s_add_u32 s48, s74, s75
    buffer_load_dwordx4 v204, s[8:11], s48 offen lds
    buffer_load_dwordx4 v205, s[8:11], s48 offen offset:1024 lds
    buffer_load_dwordx4 v206, s[8:11], s48 offen offset:2048 lds
    buffer_load_dwordx4 v207, s[8:11], s48 offen offset:3072 lds
    s_add_u32 s75, s75, 0x80
    s_and_b32 s75, s75, 0x3ff
    s_waitcnt lgkmcnt(1)
    v_dot2_f32_bf16 v220, v16, s63, v220
    v_dot2_f32_bf16 v222, v16, v16, v222
    v_dot2_f32_bf16 v221, v17, s63, v221
    v_dot2_f32_bf16 v223, v17, v17, v223
    v_dot2_f32_bf16 v220, v18, s63, v220
    v_dot2_f32_bf16 v222, v18, v18, v222
    v_dot2_f32_bf16 v221, v19, s63, v221
    v_dot2_f32_bf16 v223, v19, v19, v223
    v_dot2_f32_bf16 v220, v20, s63, v220
    v_dot2_f32_bf16 v222, v20, v20, v222
    v_dot2_f32_bf16 v221, v21, s63, v221
    v_dot2_f32_bf16 v223, v21, v21, v223
    v_dot2_f32_bf16 v220, v22, s63, v220
    v_dot2_f32_bf16 v222, v22, v22, v222
L_padA_0:
    s_cbranch_execz L_padA_4
    v_dot2_f32_bf16 v221, v23, s63, v221
    v_dot2_f32_bf16 v223, v23, v23, v223
    v_dot2_f32_bf16 v220, v24, s63, v220
    v_dot2_f32_bf16 v222, v24, v24, v222
    v_dot2_f32_bf16 v221, v25, s63, v221
    v_dot2_f32_bf16 v223, v25, v25, v223
    v_dot2_f32_bf16 v220, v26, s63, v220
    v_dot2_f32_bf16 v222, v26, v26, v222
    v_dot2_f32_bf16 v221, v27, s63, v221
    v_dot2_f32_bf16 v223, v27, v27, v223
    v_dot2_f32_bf16 v220, v28, s63, v220
    v_dot2_f32_bf16 v222, v28, v28, v222
    v_dot2_f32_bf16 v221, v29, s63, v221
    v_dot2_f32_bf16 v223, v29, v29, v223
    v_dot2_f32_bf16 v220, v30, s63, v220
    v_dot2_f32_bf16 v222, v30, v30, v222
    v_dot2_f32_bf16 v221, v31, s63, v221
    v_dot2_f32_bf16 v223, v31, v31, v223
    s_waitcnt vmcnt(8)
    ds_read_b128 v[48:51], v216 offset:12288
    ds_read_b128 v[52:55], v217 offset:12288
    ds_read_b128 v[56:59], v218 offset:12288
    ds_read_b128 v[60:63], v219 offset:12288
    s_add_u32 m0, s50, 0x6000
    s_add_u32 s48, s74, s75
    buffer_load_dwordx4 v204, s[8:11], s48 offen lds
    buffer_load_dwordx4 v205, s[8:11], s48 offen offset:1024 lds
    buffer_load_dwordx4 v206, s[8:11], s48 offen offset:2048 lds
    buffer_load_dwordx4 v207, s[8:11], s48 offen offset:3072 lds
    s_add_u32 s75, s75, 0x80
    s_and_b32 s75, s75, 0x3ff
    v_dot2_f32_bf16 v220, v32, s63, v220
    v_dot2_f32_bf16 v222, v32, v32, v222
    v_dot2_f32_bf16 v221, v33, s63, v221
    v_dot2_f32_bf16 v223, v33, v33, v223
    v_dot2_f32_bf16 v220, v34, s63, v220
    v_dot2_f32_bf16 v222, v34, v34, v222
    v_dot2_f32_bf16 v221, v35, s63, v221
    v_dot2_f32_bf16 v223, v35, v35, v223
    v_dot2_f32_bf16 v220, v36, s63, v220
    v_dot2_f32_bf16 v222, v36, v36, v222
    v_dot2_f32_bf16 v221, v37, s63, v221
    v_dot2_f32_bf16 v223, v37, v37, v223
    v_dot2_f32_bf16 v220, v38, s63, v220
    v_dot2_f32_bf16 v222, v38, v38, v222
    v_dot2_f32_bf16 v221, v39, s63, v221
    v_dot2_f32_bf16 v223, v39, v39, v223
    v_dot2_f32_bf16 v220, v40, s63, v220
    v_dot2_f32_bf16 v222, v40, v40, v222
    v_dot2_f32_bf16 v221, v41, s63, v221
    v_dot2_f32_bf16 v223, v41, v41, v223
    v_dot2_f32_bf16 v220, v42, s63, v220
    v_dot2_f32_bf16 v222, v42, v42, v222
    v_dot2_f32_bf16 v221, v43, s63, v221
    v_dot2_f32_bf16 v223, v43, v43, v223
    s_waitcnt lgkmcnt(0)
    v_dot2_f32_bf16 v220, v44, s63, v220
    v_dot2_f32_bf16 v222, v44, v44, v222
    v_dot2_f32_bf16 v221, v45, s63, v221
    v_dot2_f32_bf16 v223, v45, v45, v223
    v_dot2_f32_bf16 v220, v46, s63, v220
    v_dot2_f32_bf16 v222, v46, v46, v222
    v_dot2_f32_bf16 v221, v47, s63, v221
    v_dot2_f32_bf16 v223, v47, v47, v223
    s_waitcnt vmcnt(8)
    ds_read_b128 v[64:67], v216 offset:16384
    ds_read_b128 v[68:71], v217 offset:16384
    ds_read_b128 v[72:75], v218 offset:16384
    ds_read_b128 v[76:79], v219 offset:16384
    s_add_u32 m0, s50, 0x7000
    s_add_u32 s48, s74, s75
    buffer_load_dwordx4 v204, s[8:11], s48 offen lds
    buffer_load_dwordx4 v205, s[8:11], s48 offen offset:1024 lds
    buffer_load_dwordx4 v206, s[8:11], s48 offen offset:2048 lds
    buffer_load_dwordx4 v207, s[8:11], s48 offen offset:3072 lds
    v_dot2_f32_bf16 v220, v48, s63, v220
    v_dot2_f32_bf16 v222, v48, v48, v222
    v_dot2_f32_bf16 v221, v49, s63, v221
    v_dot2_f32_bf16 v223, v49, v49, v223
    v_dot2_f32_bf16 v220, v50, s63, v220
    v_dot2_f32_bf16 v222, v50, v50, v222
    v_dot2_f32_bf16 v221, v51, s63, v221
    v_dot2_f32_bf16 v223, v51, v51, v223
    v_dot2_f32_bf16 v220, v52, s63, v220
    v_dot2_f32_bf16 v222, v52, v52, v222
    v_dot2_f32_bf16 v221, v53, s63, v221
    v_dot2_f32_bf16 v223, v53, v53, v223
    v_dot2_f32_bf16 v220, v54, s63, v220
    v_dot2_f32_bf16 v222, v54, v54, v222
    v_dot2_f32_bf16 v221, v55, s63, v221
    v_dot2_f32_bf16 v223, v55, v55, v223
    v_dot2_f32_bf16 v220, v56, s63, v220
    v_dot2_f32_bf16 v222, v56, v56, v222
    v_dot2_f32_bf16 v221, v57, s63, v221
    v_dot2_f32_bf16 v223, v57, v57, v223
    v_dot2_f32_bf16 v220, v58, s63, v220
    v_dot2_f32_bf16 v222, v58, v58, v222
    v_dot2_f32_bf16 v221, v59, s63, v221
    v_dot2_f32_bf16 v223, v59, v59, v223
    v_dot2_f32_bf16 v220, v60, s63, v220
    v_dot2_f32_bf16 v222, v60, v60, v222
    v_dot2_f32_bf16 v221, v61, s63, v221
    v_dot2_f32_bf16 v223, v61, v61, v223
    v_dot2_f32_bf16 v220, v62, s63, v220
    v_dot2_f32_bf16 v222, v62, v62, v222
    v_dot2_f32_bf16 v221, v63, s63, v221
    v_dot2_f32_bf16 v223, v63, v63, v223
    s_add_u32 m0, s50, 0
    s_nop 0
    buffer_load_dwordx4 v240, s[28:31], s53 offen lds
    buffer_load_dwordx4 v240, s[28:31], s53 offen offset:1024 lds
    buffer_load_dwordx4 v240, s[28:31], s53 offen offset:2048 lds
    s_add_u32 s53, s53, 0x18000
    s_waitcnt vmcnt(11)
    ds_read_b128 v[80:83], v216 offset:20480
    ds_read_b128 v[84:87], v217 offset:20480
    ds_read_b128 v[88:91], v218 offset:20480
    ds_read_b128 v[92:95], v219 offset:20480
    s_waitcnt lgkmcnt(4)
    v_dot2_f32_bf16 v220, v64, s63, v220
    v_dot2_f32_bf16 v222, v64, v64, v222
    v_dot2_f32_bf16 v221, v65, s63, v221
    v_dot2_f32_bf16 v223, v65, v65, v223
    v_dot2_f32_bf16 v220, v66, s63, v220
    v_dot2_f32_bf16 v222, v66, v66, v222
    v_dot2_f32_bf16 v221, v67, s63, v221
    v_dot2_f32_bf16 v223, v67, v67, v223
    v_dot2_f32_bf16 v220, v68, s63, v220
    v_dot2_f32_bf16 v222, v68, v68, v222
    v_dot2_f32_bf16 v221, v69, s63, v221
    v_dot2_f32_bf16 v223, v69, v69, v223
    v_dot2_f32_bf16 v220, v70, s63, v220
    v_dot2_f32_bf16 v222, v70, v70, v222
    v_dot2_f32_bf16 v221, v71, s63, v221
    v_dot2_f32_bf16 v223, v71, v71, v223
    v_dot2_f32_bf16 v220, v72, s63, v220
    v_dot2_f32_bf16 v222, v72, v72, v222
    v_dot2_f32_bf16 v221, v73, s63, v221
    v_dot2_f32_bf16 v223, v73, v73, v223
    v_dot2_f32_bf16 v220, v74, s63, v220
    v_dot2_f32_bf16 v222, v74, v74, v222
    v_dot2_f32_bf16 v221, v75, s63, v221
    v_dot2_f32_bf16 v223, v75, v75, v223
    v_dot2_f32_bf16 v220, v76, s63, v220
    v_dot2_f32_bf16 v222, v76, v76, v222
    v_dot2_f32_bf16 v221, v77, s63, v221
    v_dot2_f32_bf16 v223, v77, v77, v223
    v_dot2_f32_bf16 v220, v78, s63, v220
    v_dot2_f32_bf16 v222, v78, v78, v222
    v_dot2_f32_bf16 v221, v79, s63, v221
    v_dot2_f32_bf16 v223, v79, v79, v223
    s_add_u32 m0, s50, 0xc00
    s_nop 0
    buffer_load_dwordx4 v240, s[28:31], s53 offen lds
    buffer_load_dwordx4 v240, s[28:31], s53 offen offset:1024 lds
    buffer_load_dwordx4 v240, s[28:31], s53 offen offset:2048 lds
    s_add_u32 s53, s53, 0x18000
    s_waitcnt lgkmcnt(0)
    v_dot2_f32_bf16 v220, v80, s63, v220
    v_dot2_f32_bf16 v222, v80, v80, v222
    v_dot2_f32_bf16 v221, v81, s63, v221
    v_dot2_f32_bf16 v223, v81, v81, v223
    v_dot2_f32_bf16 v220, v82, s63, v220
    v_dot2_f32_bf16 v222, v82, v82, v222
    v_dot2_f32_bf16 v221, v83, s63, v221
    v_dot2_f32_bf16 v223, v83, v83, v223
    v_dot2_f32_bf16 v220, v84, s63, v220
    v_dot2_f32_bf16 v222, v84, v84, v222
    v_dot2_f32_bf16 v221, v85, s63, v221
    v_dot2_f32_bf16 v223, v85, v85, v223
    v_dot2_f32_bf16 v220, v86, s63, v220
    v_dot2_f32_bf16 v222, v86, v86, v222
    v_dot2_f32_bf16 v221, v87, s63, v221
    v_dot2_f32_bf16 v223, v87, v87, v223
    v_dot2_f32_bf16 v220, v88, s63, v220
    v_dot2_f32_bf16 v222, v88, v88, v222
    v_dot2_f32_bf16 v221, v89, s63, v221
    v_dot2_f32_bf16 v223, v89, v89, v223
    v_dot2_f32_bf16 v220, v90, s63, v220
    v_dot2_f32_bf16 v222, v90, v90, v222
    v_dot2_f32_bf16 v221, v91, s63, v221
    v_dot2_f32_bf16 v223, v91, v91, v223
    v_dot2_f32_bf16 v220, v92, s63, v220
    v_dot2_f32_bf16 v222, v92, v92, v222
    v_dot2_f32_bf16 v221, v93, s63, v221
    v_dot2_f32_bf16 v223, v93, v93, v223
    v_dot2_f32_bf16 v220, v94, s63, v220
    v_dot2_f32_bf16 v222, v94, v94, v222
    v_dot2_f32_bf16 v221, v95, s63, v221
    v_dot2_f32_bf16 v223, v95, v95, v223
    s_waitcnt vmcnt(10)
    ds_read_b128 v[96:99], v216 offset:24576
    ds_read_b128 v[100:103], v217 offset:24576
    ds_read_b128 v[104:107], v218 offset:24576
    ds_read_b128 v[108:111], v219 offset:24576
    s_add_u32 m0, s50, 0x1800
    s_nop 0
    buffer_load_dwordx4 v240, s[28:31], s53 offen lds
    buffer_load_dwordx4 v240, s[28:31], s53 offen offset:1024 lds
    buffer_load_dwordx4 v240, s[28:31], s53 offen offset:2048 lds
    s_add_u32 s53, s53, 0x18000
    s_waitcnt lgkmcnt(3)
    v_dot2_f32_bf16 v220, v96, s63, v220
    v_dot2_f32_bf16 v222, v96, v96, v222
    v_dot2_f32_bf16 v221, v97, s63, v221
    v_dot2_f32_bf16 v223, v97, v97, v223
    v_dot2_f32_bf16 v220, v98, s63, v220
    v_dot2_f32_bf16 v222, v98, v98, v222
    v_dot2_f32_bf16 v221, v99, s63, v221
    v_dot2_f32_bf16 v223, v99, v99, v223
    s_waitcnt lgkmcnt(0)
    v_dot2_f32_bf16 v220, v100, s63, v220
    v_dot2_f32_bf16 v222, v100, v100, v222
    v_dot2_f32_bf16 v221, v101, s63, v221
    v_dot2_f32_bf16 v223, v101, v101, v223
    v_dot2_f32_bf16 v220, v102, s63, v220
    v_dot2_f32_bf16 v222, v102, v102, v222
    v_dot2_f32_bf16 v221, v103, s63, v221
    v_dot2_f32_bf16 v223, v103, v103, v223
    v_dot2_f32_bf16 v220, v104, s63, v220
    v_dot2_f32_bf16 v222, v104, v104, v222
    v_dot2_f32_bf16 v221, v105, s63, v221
    v_dot2_f32_bf16 v223, v105, v105, v223
    v_dot2_f32_bf16 v220, v106, s63, v220
    v_dot2_f32_bf16 v222, v106, v106, v222
    v_dot2_f32_bf16 v221, v107, s63, v221
    v_dot2_f32_bf16 v223, v107, v107, v223
    v_dot2_f32_bf16 v220, v108, s63, v220
    v_dot2_f32_bf16 v222, v108, v108, v222
    v_dot2_f32_bf16 v221, v109, s63, v221
    v_dot2_f32_bf16 v223, v109, v109, v223
    v_dot2_f32_bf16 v220, v110, s63, v220
    v_dot2_f32_bf16 v222, v110, v110, v222
    v_dot2_f32_bf16 v221, v111, s63, v221
    v_dot2_f32_bf16 v223, v111, v111, v223
    s_waitcnt vmcnt(9)
    ds_read_b128 v[112:115], v216 offset:28672
    ds_read_b128 v[116:119], v217 offset:28672
    ds_read_b128 v[120:123], v218 offset:28672
    ds_read_b128 v[124:127], v219 offset:28672
    s_add_u32 m0, s50, 0x2400
    s_nop 0
    buffer_load_dwordx4 v240, s[28:31], s53 offen lds
    buffer_load_dwordx4 v240, s[28:31], s53 offen offset:1024 lds
    buffer_load_dwordx4 v240, s[28:31], s53 offen offset:2048 lds
    s_add_u32 s53, s53, 0x18000
    s_cmp_eq_u32 s76, 3
    s_cselect_b32 s55, 0x180000, 0
    s_sub_u32 s53, s53, s55
    s_waitcnt lgkmcnt(0)
    v_dot2_f32_bf16 v220, v112, s63, v220
    v_dot2_f32_bf16 v222, v112, v112, v222
    v_dot2_f32_bf16 v221, v113, s63, v221
    v_dot2_f32_bf16 v223, v113, v113, v223
    v_dot2_f32_bf16 v220, v114, s63, v220
    v_dot2_f32_bf16 v222, v114, v114, v222
    v_dot2_f32_bf16 v221, v115, s63, v221
    v_dot2_f32_bf16 v223, v115, v115, v223
    v_dot2_f32_bf16 v220, v116, s63, v220
    v_dot2_f32_bf16 v222, v116, v116, v222
    v_dot2_f32_bf16 v221, v117, s63, v221
    v_dot2_f32_bf16 v223, v117, v117, v223
    v_dot2_f32_bf16 v220, v118, s63, v220
    v_dot2_f32_bf16 v222, v118, v118, v222
    v_dot2_f32_bf16 v221, v119, s63, v221
    v_dot2_f32_bf16 v223, v119, v119, v223
    v_dot2_f32_bf16 v220, v120, s63, v220
    v_dot2_f32_bf16 v222, v120, v120, v222
    v_dot2_f32_bf16 v221, v121, s63, v221
    v_dot2_f32_bf16 v223, v121, v121, v223
    v_dot2_f32_bf16 v220, v122, s63, v220
    v_dot2_f32_bf16 v222, v122, v122, v222
    v_dot2_f32_bf16 v221, v123, s63, v221
    v_dot2_f32_bf16 v223, v123, v123, v223
    v_dot2_f32_bf16 v220, v124, s63, v220
    v_dot2_f32_bf16 v222, v124, v124, v222
    v_dot2_f32_bf16 v221, v125, s63, v221
    v_dot2_f32_bf16 v223, v125, v125, v223
    v_dot2_f32_bf16 v220, v126, s63, v220
    v_dot2_f32_bf16 v222, v126, v126, v222
    v_dot2_f32_bf16 v221, v127, s63, v221
    v_dot2_f32_bf16 v223, v127, v127, v223
    s_nop 1
    v_add_f32 v220, v220, v221
    v_add_f32 v222, v222, v223
    v_mov_b32 v221, v220
    v_mov_b32 v223, v222
    s_nop 0
    v_permlane32_swap_b32 v220, v221
    v_permlane32_swap_b32 v222, v223
    v_add_f32 v220, v220, v221
    v_add_f32 v222, v222, v223
    v_mul_f32 v220, s77, v220
    v_mul_f32 v221, v220, v220
    v_fma_f32 v222, v222, s77, -v221
    v_max_f32 v222, 0, v222
    v_cvt_pk_bf16_f32 v221, v220, v222
    v_and_b32 v223, s62, v221
    v_add_f32 v223, 0x3727c5ac, v223
    v_cvt_pk_bf16_f32 v223, v223, v223
    v_and_b32 v223, s62, v223
    v_sqrt_f32 v223, v223
    s_nop 0
    v_cvt_pk_bf16_f32 v223, v223, v223
    v_and_b32 v223, s62, v223
    v_rcp_f32 v244, v223
    v_lshlrev_b32 v221, 16, v221
    v_mul_f32 v245, -v221, v244
    s_waitcnt vmcnt(6)
    s_barrier
    ds_read_b64_tr_b16 a[0:1], v236 offset:1024
    ds_read_b64_tr_b16 a[2:3], v236 offset:1536
    ds_read_b64_tr_b16 a[4:5], v237 offset:1024
    ds_read_b64_tr_b16 a[6:7], v237 offset:1536
    ds_read_b64_tr_b16 a[8:9], v236 offset:2048
    ds_read_b64_tr_b16 a[10:11], v236 offset:2560
    ds_read_b64_tr_b16 a[12:13], v237 offset:2048
    ds_read_b64_tr_b16 a[14:15], v237 offset:2560
    ds_read_b64_tr_b16 a[16:17], v236 offset:0
    ds_read_b64_tr_b16 a[18:19], v236 offset:512
    ds_read_b64_tr_b16 a[20:21], v237 offset:0
    ds_read_b64_tr_b16 a[22:23], v237 offset:512
    v_lshlrev_b32 v224, 16, v0
    v_and_b32 v225, s62, v0
    v_fma_f32 v224, v224, v244, v245
    v_fma_f32 v225, v225, v244, v245
    v_cvt_pk_bf16_f32 v0, v224, v225
    v_lshlrev_b32 v226, 16, v1
    v_and_b32 v227, s62, v1
    v_fma_f32 v226, v226, v244, v245
    v_fma_f32 v227, v227, v244, v245
    v_cvt_pk_bf16_f32 v1, v226, v227
    v_lshlrev_b32 v228, 16, v2
    v_and_b32 v229, s62, v2
    v_fma_f32 v228, v228, v244, v245
    v_fma_f32 v229, v229, v244, v245
    v_cvt_pk_bf16_f32 v2, v228, v229
    v_lshlrev_b32 v230, 16, v3
    v_and_b32 v231, s62, v3
    v_fma_f32 v230, v230, v244, v245
    v_fma_f32 v231, v231, v244, v245
    v_cvt_pk_bf16_f32 v3, v230, v231
    s_waitcnt lgkmcnt(0)
    s_nop 0
    v_mfma_f32_32x32x16_bf16 v[160:175], a[0:3], v[0:3], 0
    ds_read_b64_tr_b16 a[24:25], v236 offset:33792
    ds_read_b64_tr_b16 a[26:27], v236 offset:34304
    ds_read_b128 a[168:171], v247 offset:0
    ds_read_b64_tr_b16 a[176:177], v246 offset:1024
    ds_read_b64_tr_b16 a[178:179], v246 offset:1536
    v_mfma_f32_32x32x16_bf16 v[176:191], a[4:7], v[0:3], 0
    ds_read_b64_tr_b16 a[28:29], v237 offset:33792
    ds_read_b64_tr_b16 a[30:31], v237 offset:34304
    ds_read_b64_tr_b16 a[180:181], v246 offset:2048
    ds_read_b64_tr_b16 a[182:183], v246 offset:2560
    v_lshlrev_b32 v224, 16, v4
    v_and_b32 v225, s62, v4
    v_fma_f32 v224, v224, v244, v245
    v_mfma_f32_32x32x16_bf16 v[192:207], v[0:3], a[8:11], 0
    ds_read_b64_tr_b16 a[32:33], v236 offset:34816
    ds_read_b64_tr_b16 a[34:35], v236 offset:35328
    v_fma_f32 v225, v225, v244, v245
    v_cvt_pk_bf16_f32 v4, v224, v225
    v_lshlrev_b32 v226, 16, v5
    v_and_b32 v227, s62, v5
    v_fma_f32 v226, v226, v244, v245
    v_mfma_f32_32x32x16_bf16 v[208:223], v[0:3], a[12:15], 0
    ds_read_b64_tr_b16 a[36:37], v237 offset:34816
    ds_read_b64_tr_b16 a[38:39], v237 offset:35328
    v_fma_f32 v227, v227, v244, v245
    v_cvt_pk_bf16_f32 v5, v226, v227
    v_lshlrev_b32 v228, 16, v6
    v_and_b32 v229, s62, v6
    s_add_u32 m0, s50, 0x3000
    v_mfma_f32_32x32x16_bf16 v[128:143], a[16:19], v[0:3], 0
    ds_read_b64_tr_b16 a[40:41], v236 offset:32768
    ds_read_b64_tr_b16 a[42:43], v236 offset:33280
    buffer_load_dwordx4 v240, s[28:31], s53 offen lds
    v_fma_f32 v228, v228, v244, v245
    v_fma_f32 v229, v229, v244, v245
    v_cvt_pk_bf16_f32 v6, v228, v229
    v_mfma_f32_32x32x16_bf16 v[144:159], a[20:23], v[0:3], 0
    ds_read_b64_tr_b16 a[44:45], v237 offset:32768
    ds_read_b64_tr_b16 a[46:47], v237 offset:33280
    v_lshlrev_b32 v230, 16, v7
    v_and_b32 v231, s62, v7
    v_fma_f32 v230, v230, v244, v245
    v_fma_f32 v231, v231, v244, v245
    buffer_load_dwordx4 v240, s[28:31], s53 offen offset:1024 lds
    v_cvt_pk_bf16_f32 v7, v230, v231
    s_waitcnt lgkmcnt(2)
    s_nop 0
    v_mfma_f32_32x32x16_bf16 v[160:175], a[24:27], v[4:7], v[160:175]
    ds_read_b64_tr_b16 a[0:1], v236 offset:4096
    ds_read_b64_tr_b16 a[2:3], v236 offset:4608
    v_mfma_f32_16x16x32_bf16 a[160:163], a[176:179], a[168:171], 0
    s_mov_b32 s36, s22
    s_mov_b32 s37, s23
    s_mov_b32 s22, 0x1c0000
    s_mov_b32 s23, 0x20000
    s_mov_b32 s14, 0x80000
    v_mfma_f32_32x32x16_bf16 v[176:191], a[28:31], v[4:7], v[176:191]
    ds_read_b64_tr_b16 a[4:5], v237 offset:4096
    ds_read_b64_tr_b16 a[6:7], v237 offset:4608
    buffer_load_dwordx4 v240, s[28:31], s53 offen offset:2048 lds
    s_mov_b32 s15, 0x20000
    s_and_b32 s68, s6, 3
    s_lshr_b32 s69, s6, 2
    v_mfma_f32_32x32x16_bf16 v[192:207], v[4:7], a[32:35], v[192:207]
    ds_read_b64_tr_b16 a[8:9], v236 offset:5120
    ds_read_b64_tr_b16 a[10:11], v236 offset:5632
    s_lshl_b32 s69, s69, 7
    v_mfma_f32_16x16x32_bf16 a[164:167], a[168:171], a[180:183], 0
    s_lshl_b32 s51, s7, 3
    s_lshl_b32 s52, s68, 1
    s_add_u32 s51, s51, s52
    v_lshlrev_b32 v224, 16, v8
    v_and_b32 v225, s62, v8
    v_fma_f32 v224, v224, v244, v245
    s_add_u32 s53, s53, 0x18000
    s_add_u32 m0, s50, 0x3c00
    v_fma_f32 v225, v225, v244, v245
    v_cvt_pk_bf16_f32 v8, v224, v225
    v_mfma_f32_32x32x16_bf16 v[208:223], v[4:7], a[36:39], v[208:223]
    ds_read_b64_tr_b16 a[12:13], v237 offset:5120
    ds_read_b64_tr_b16 a[14:15], v237 offset:5632
    buffer_load_dwordx4 v240, s[28:31], s53 offen lds
    v_lshlrev_b32 v226, 16, v9
    v_and_b32 v227, s62, v9
    v_fma_f32 v226, v226, v244, v245
    v_fma_f32 v227, v227, v244, v245
    v_cvt_pk_bf16_f32 v9, v226, v227
    v_mfma_f32_32x32x16_bf16 v[128:143], a[40:43], v[4:7], v[128:143]
    ds_read_b64_tr_b16 a[16:17], v236 offset:3072
    ds_read_b64_tr_b16 a[18:19], v236 offset:3584
    buffer_load_dwordx4 v240, s[28:31], s53 offen offset:1024 lds
    v_lshlrev_b32 v228, 16, v10
    v_and_b32 v229, s62, v10
    v_fma_f32 v228, v228, v244, v245
    v_fma_f32 v229, v229, v244, v245
    v_cvt_pk_bf16_f32 v10, v228, v229
    s_waitcnt lgkmcnt(2)
    v_mfma_f32_32x32x16_bf16 v[144:159], a[44:47], v[4:7], v[144:159]
    ds_read_b64_tr_b16 a[20:21], v237 offset:3072
    ds_read_b64_tr_b16 a[22:23], v237 offset:3584
    v_lshlrev_b32 v230, 16, v11
    v_and_b32 v231, s62, v11
    v_fma_f32 v230, v230, v244, v245
    v_fma_f32 v231, v231, v244, v245
    v_cvt_pk_bf16_f32 v11, v230, v231
    s_nop 1
    v_mfma_f32_32x32x16_bf16 v[160:175], a[0:3], v[8:11], v[160:175]
    ds_read_b64_tr_b16 a[24:25], v236 offset:36864
    ds_read_b64_tr_b16 a[26:27], v236 offset:37376
    buffer_load_dwordx4 v240, s[28:31], s53 offen offset:2048 lds
    s_and_b32 s52, s3, 1
    v_mfma_f32_32x32x16_bf16 v[176:191], a[4:7], v[8:11], v[176:191]
    ds_read_b64_tr_b16 a[28:29], v237 offset:36864
    ds_read_b64_tr_b16 a[30:31], v237 offset:37376
    s_add_u32 s51, s51, s52
    s_lshl_b32 s58, s51, 1
    s_add_u32 s58, s58, s70
    s_mul_i32 s58, s58, 0x400
    s_add_u32 s58, s58, 0x1c00000
    s_add_u32 s53, s53, 0x18000
    s_add_u32 m0, s50, 0x4800
    v_mfma_f32_32x32x16_bf16 v[192:207], v[8:11], a[8:11], v[192:207]
    ds_read_b64_tr_b16 a[32:33], v236 offset:37888
    ds_read_b64_tr_b16 a[34:35], v236 offset:38400
    buffer_load_dwordx4 v240, s[28:31], s53 offen lds
    s_mul_i32 s56, s51, 0x24000
    v_lshlrev_b32 v224, 16, v12
    v_and_b32 v225, s62, v12
    v_fma_f32 v224, v224, v244, v245
    v_fma_f32 v225, v225, v244, v245
    v_cvt_pk_bf16_f32 v12, v224, v225
    v_mfma_f32_32x32x16_bf16 v[208:223], v[8:11], a[12:15], v[208:223]
    ds_read_b64_tr_b16 a[36:37], v237 offset:37888
    ds_read_b64_tr_b16 a[38:39], v237 offset:38400
    buffer_load_dwordx4 v240, s[28:31], s53 offen offset:1024 lds
    ds_read_b128 a[172:175], v247 offset:1024
    ds_read_b64_tr_b16 a[184:185], v246 offset:4096
    ds_read_b64_tr_b16 a[186:187], v246 offset:4608
    ds_read_b64_tr_b16 a[188:189], v246 offset:5120
    ds_read_b64_tr_b16 a[190:191], v246 offset:5632
    v_lshlrev_b32 v226, 16, v13
    v_and_b32 v227, s62, v13
    v_fma_f32 v226, v226, v244, v245
    v_fma_f32 v227, v227, v244, v245
    v_cvt_pk_bf16_f32 v13, v226, v227
    s_waitcnt lgkmcnt(4)
    v_mfma_f32_32x32x16_bf16 v[128:143], a[16:19], v[8:11], v[128:143]
    ds_read_b64_tr_b16 a[40:41], v236 offset:35840
    ds_read_b64_tr_b16 a[42:43], v236 offset:36352
    s_lshl_b32 s66, s51, 15
    buffer_load_dwordx4 v240, s[28:31], s53 offen offset:2048 lds
    v_lshlrev_b32 v228, 16, v14
    v_and_b32 v229, s62, v14
    v_fma_f32 v228, v228, v244, v245
    v_fma_f32 v229, v229, v244, v245
    v_cvt_pk_bf16_f32 v14, v228, v229
    s_add_u32 s53, s53, 0x18000
    v_mfma_f32_32x32x16_bf16 v[144:159], a[20:23], v[8:11], v[144:159]
    ds_read_b64_tr_b16 a[44:45], v237 offset:35840
    ds_read_b64_tr_b16 a[46:47], v237 offset:36352
    s_and_b32 s66, s66, 0xffff7fff
    v_lshlrev_b32 v230, 16, v15
    v_and_b32 v231, s62, v15
    v_fma_f32 v230, v230, v244, v245
    v_fma_f32 v231, v231, v244, v245
    v_cvt_pk_bf16_f32 v15, v230, v231
    s_waitcnt vmcnt(9)
    s_barrier
    v_mfma_f32_32x32x16_bf16 v[160:175], a[24:27], v[12:15], v[160:175]
    ds_read_b64_tr_b16 a[0:1], v236 offset:7168
    ds_read_b64_tr_b16 a[2:3], v236 offset:7680
    s_add_u32 m0, s50, 0
    s_add_u32 s66, s66, s69
    buffer_load_dwordx4 v240, s[28:31], s53 offen lds
    v_mfma_f32_32x32x16_bf16 v[176:191], a[28:31], v[12:15], v[176:191]
    ds_read_b64_tr_b16 a[4:5], v237 offset:7168
    ds_read_b64_tr_b16 a[6:7], v237 offset:7680
    buffer_load_dwordx4 v240, s[28:31], s53 offen offset:1024 lds
    s_lshr_b32 s51, s50, 1
    s_add_u32 s66, s66, s51
    s_waitcnt lgkmcnt(2)
    v_mfma_f32_16x16x32_bf16 a[160:163], a[184:187], a[172:175], a[160:163]
    s_lshl_b32 s52, s52, 13
    v_mfma_f32_32x32x16_bf16 v[192:207], v[12:15], a[32:35], v[192:207]
    ds_read_b64_tr_b16 a[8:9], v236 offset:8192
    ds_read_b64_tr_b16 a[10:11], v236 offset:8704
    s_add_u32 s52, s52, s69
    s_mul_i32 s51, s70, 0xc000
    s_add_u32 s78, s56, s51
    s_mul_i32 s51, s70, 0xc0000
    s_add_u32 s81, s51, s52
    v_lshlrev_b32 v224, 16, v16
    v_and_b32 v225, s62, v16
    v_fma_f32 v224, v224, v244, v245
    v_fma_f32 v225, v225, v244, v245
    v_cvt_pk_bf16_f32 v16, v224, v225
    v_mfma_f32_32x32x16_bf16 v[208:223], v[12:15], a[36:39], v[208:223]
    ds_read_b64_tr_b16 a[12:13], v237 offset:8192
    ds_read_b64_tr_b16 a[14:15], v237 offset:8704
    buffer_load_dwordx4 v240, s[28:31], s53 offen offset:2048 lds
    s_mul_i32 s51, s70, 0x2000
    v_mfma_f32_16x16x32_bf16 a[164:167], a[172:175], a[188:191], a[164:167]
    s_add_u32 s79, s56, s51
    s_mul_i32 s51, s70, 0x20000
    v_lshlrev_b32 v226, 16, v17
    v_and_b32 v227, s62, v17
    v_fma_f32 v226, v226, v244, v245
    v_fma_f32 v227, v227, v244, v245
    v_cvt_pk_bf16_f32 v17, v226, v227
    v_mfma_f32_32x32x16_bf16 v[128:143], a[40:43], v[12:15], v[128:143]
    ds_read_b64_tr_b16 a[16:17], v236 offset:6144
    ds_read_b64_tr_b16 a[18:19], v236 offset:6656
    s_add_u32 s53, s53, 0x18000
    s_cmp_eq_u32 s76, 2
    s_cselect_b32 s55, 0x180000, 0
    s_sub_u32 s53, s53, s55
    v_lshlrev_b32 v228, 16, v18
    v_and_b32 v229, s62, v18
    v_fma_f32 v228, v228, v244, v245
    v_fma_f32 v229, v229, v244, v245
    v_cvt_pk_bf16_f32 v18, v228, v229
    v_mfma_f32_32x32x16_bf16 v[144:159], a[44:47], v[12:15], v[144:159]
    ds_read_b64_tr_b16 a[20:21], v237 offset:6144
    ds_read_b64_tr_b16 a[22:23], v237 offset:6656
L_padA_1:
    s_cbranch_execz L_padA_5
    s_add_u32 s82, s51, s52
    s_mul_i32 s51, s70, 0x4000
    s_add_u32 s80, s56, s51
    v_lshlrev_b32 v230, 16, v19
    v_and_b32 v231, s62, v19
    v_fma_f32 v230, v230, v244, v245
    v_fma_f32 v231, v231, v244, v245
    v_cvt_pk_bf16_f32 v19, v230, v231
    s_nop 1
    v_mfma_f32_32x32x16_bf16 v[160:175], a[0:3], v[16:19], v[160:175]
    ds_read_b64_tr_b16 a[24:25], v236 offset:39936
    ds_read_b64_tr_b16 a[26:27], v236 offset:40448
    s_mul_i32 s51, s70, 0x40000
    s_add_u32 s83, s51, s52
    s_waitcnt lgkmcnt(2)
    v_mfma_f32_32x32x16_bf16 v[176:191], a[4:7], v[16:19], v[176:191]
    ds_read_b64_tr_b16 a[28:29], v237 offset:39936
    ds_read_b64_tr_b16 a[30:31], v237 offset:40448
    s_lshl_b32 s73, s3, 10
    s_add_u32 s73, s73, 0x20000
    s_lshl_b32 s51, s4, 2
    s_add_u32 s51, s51, s3
    s_mul_i32 s52, s51, 0x90
    v_mfma_f32_32x32x16_bf16 v[192:207], v[16:19], a[8:11], v[192:207]
    ds_read_b64_tr_b16 a[32:33], v236 offset:40960
    ds_read_b64_tr_b16 a[34:35], v236 offset:41472
    s_add_u32 s61, s52, s65
    s_mul_i32 s61, s61, 0x400
    s_mul_i32 s59, s65, 0x400
    s_add_u32 s59, s59, s61
    s_add_u32 s59, s59, 0x1c000
    v_lshlrev_b32 v224, 16, v20
    v_and_b32 v225, s62, v20
    v_fma_f32 v224, v224, v244, v245
    v_fma_f32 v225, v225, v244, v245
    v_cvt_pk_bf16_f32 v20, v224, v225
    v_mfma_f32_32x32x16_bf16 v[208:223], v[16:19], a[12:15], v[208:223]
    ds_read_b64_tr_b16 a[36:37], v237 offset:40960
    ds_read_b64_tr_b16 a[38:39], v237 offset:41472
    v_mov_b32 v242, v243
    s_lshl_b32 s51, s51, 1
    s_lshr_b32 s52, s5, 2
    ds_read_b128 a[168:171], v247 offset:2048
    ds_read_b64_tr_b16 a[176:177], v246 offset:7168
    ds_read_b64_tr_b16 a[178:179], v246 offset:7680
    ds_read_b64_tr_b16 a[180:181], v246 offset:8192
    ds_read_b64_tr_b16 a[182:183], v246 offset:8704
    v_lshlrev_b32 v226, 16, v21
    v_and_b32 v227, s62, v21
    v_fma_f32 v226, v226, v244, v245
    v_fma_f32 v227, v227, v244, v245
    v_cvt_pk_bf16_f32 v21, v226, v227
    v_mfma_f32_32x32x16_bf16 v[128:143], a[16:19], v[16:19], v[128:143]
    ds_read_b64_tr_b16 a[40:41], v236 offset:38912
    ds_read_b64_tr_b16 a[42:43], v236 offset:39424
    s_add_u32 s51, s51, s52
    s_mul_i32 s51, s51, 0x400
    s_and_b32 s52, s5, 3
    v_lshlrev_b32 v228, 16, v22
    v_and_b32 v229, s62, v22
    v_fma_f32 v228, v228, v244, v245
    v_fma_f32 v229, v229, v244, v245
    v_cvt_pk_bf16_f32 v22, v228, v229
    v_mfma_f32_32x32x16_bf16 v[144:159], a[20:23], v[16:19], v[144:159]
    ds_read_b64_tr_b16 a[44:45], v237 offset:38912
    ds_read_b64_tr_b16 a[46:47], v237 offset:39424
    s_lshl_b32 s52, s52, 2
    s_add_u32 s51, s51, s52
    v_lshlrev_b32 v230, 16, v23
    v_and_b32 v231, s62, v23
    v_fma_f32 v230, v230, v244, v245
    v_fma_f32 v231, v231, v244, v245
    v_cvt_pk_bf16_f32 v23, v230, v231
    s_waitcnt lgkmcnt(2)
    s_nop 0
    v_mfma_f32_32x32x16_bf16 v[160:175], a[24:27], v[20:23], v[160:175]
    ds_read_b64_tr_b16 a[0:1], v236 offset:10240
    ds_read_b64_tr_b16 a[2:3], v236 offset:10752
    s_add_u32 s57, s51, 0x1c00000
    s_mov_b32 s38, 0x200000
    s_mov_b32 s39, 0x20000
    v_mfma_f32_32x32x16_bf16 v[176:191], a[28:31], v[20:23], v[176:191]
    ds_read_b64_tr_b16 a[4:5], v237 offset:10240
    ds_read_b64_tr_b16 a[6:7], v237 offset:10752
    s_lshr_b32 s51, s81, 4
    s_sub_u32 s78, s78, s51
    s_lshr_b32 s51, s83, 4
    s_sub_u32 s80, s80, s51
    s_add_u32 s51, s68, 3
    v_mfma_f32_16x16x32_bf16 a[160:163], a[176:179], a[168:171], a[160:163]
    s_and_b32 s51, s51, 3
    s_lshl_b32 s51, s51, 16
    v_mfma_f32_32x32x16_bf16 v[192:207], v[20:23], a[32:35], v[192:207]
    ds_read_b64_tr_b16 a[8:9], v236 offset:11264
    ds_read_b64_tr_b16 a[10:11], v236 offset:11776
    s_add_u32 s69, s83, s51
    s_mul_i32 s51, s51, 3
    s_add_u32 s5, s81, s51
    s_add_u32 s51, s68, 2
    s_and_b32 s51, s51, 3
    v_lshlrev_b32 v224, 16, v24
    v_and_b32 v225, s62, v24
    v_fma_f32 v224, v224, v244, v245
    v_fma_f32 v225, v225, v244, v245
    v_cvt_pk_bf16_f32 v24, v224, v225
    v_mfma_f32_32x32x16_bf16 v[208:223], v[20:23], a[36:39], v[208:223]
    ds_read_b64_tr_b16 a[12:13], v237 offset:11264
    ds_read_b64_tr_b16 a[14:15], v237 offset:11776
    s_lshl_b32 s51, s51, 16
    s_add_u32 s7, s83, s51
    s_mul_i32 s51, s51, 3
    v_mfma_f32_16x16x32_bf16 a[164:167], a[168:171], a[180:183], a[164:167]
    s_add_u32 s1, s81, s51
    s_add_u32 s51, s68, 1
    v_lshlrev_b32 v226, 16, v25
    v_and_b32 v227, s62, v25
    v_fma_f32 v226, v226, v244, v245
    v_fma_f32 v227, v227, v244, v245
    v_cvt_pk_bf16_f32 v25, v226, v227
    v_mfma_f32_32x32x16_bf16 v[128:143], a[40:43], v[20:23], v[128:143]
    ds_read_b64_tr_b16 a[16:17], v236 offset:9216
    ds_read_b64_tr_b16 a[18:19], v236 offset:9728
    s_and_b32 s51, s51, 3
    v_lshlrev_b32 v228, 16, v26
    v_and_b32 v229, s62, v26
    v_fma_f32 v228, v228, v244, v245
    v_fma_f32 v229, v229, v244, v245
    v_cvt_pk_bf16_f32 v26, v228, v229
    s_waitcnt lgkmcnt(2)
    v_mfma_f32_32x32x16_bf16 v[144:159], a[44:47], v[20:23], v[144:159]
    ds_read_b64_tr_b16 a[20:21], v237 offset:9216
    ds_read_b64_tr_b16 a[22:23], v237 offset:9728
    v_lshlrev_b32 v230, 16, v27
    v_and_b32 v231, s62, v27
    v_fma_f32 v230, v230, v244, v245
    v_fma_f32 v231, v231, v244, v245
    v_cvt_pk_bf16_f32 v27, v230, v231
    s_nop 1
    v_mfma_f32_32x32x16_bf16 v[160:175], a[0:3], v[24:27], v[160:175]
    ds_read_b64_tr_b16 a[24:25], v236 offset:43008
    ds_read_b64_tr_b16 a[26:27], v236 offset:43520
    s_lshl_b32 s51, s51, 16
    s_add_u32 s6, s83, s51
    s_mul_i32 s51, s51, 3
    v_mfma_f32_32x32x16_bf16 v[176:191], a[4:7], v[24:27], v[176:191]
    ds_read_b64_tr_b16 a[28:29], v237 offset:43008
    ds_read_b64_tr_b16 a[30:31], v237 offset:43520
    s_add_u32 s0, s81, s51
    s_add_u32 s51, s68, 0
    s_and_b32 s51, s51, 3
    s_lshl_b32 s51, s51, 16
    s_add_u32 s83, s83, s51
    v_mfma_f32_32x32x16_bf16 v[192:207], v[24:27], a[8:11], v[192:207]
    ds_read_b64_tr_b16 a[32:33], v236 offset:44032
    ds_read_b64_tr_b16 a[34:35], v236 offset:44544
    s_mul_i32 s51, s51, 3
    s_add_u32 s81, s81, s51
    s_lshl_b32 s75, s2, 2
    s_add_u32 s75, s75, s3
    s_mul_i32 s67, s75, 0x700
    buffer_load_dword a199, v239, s[20:23], s67 offen
    v_lshlrev_b32 v224, 16, v28
    v_and_b32 v225, s62, v28
    v_fma_f32 v224, v224, v244, v245
    v_fma_f32 v225, v225, v244, v245
    v_cvt_pk_bf16_f32 v28, v224, v225
    v_mfma_f32_32x32x16_bf16 v[208:223], v[24:27], a[12:15], v[208:223]
    ds_read_b64_tr_b16 a[36:37], v237 offset:44032
    ds_read_b64_tr_b16 a[38:39], v237 offset:44544
    ds_read_b128 a[172:175], v247 offset:3072
    ds_read_b64_tr_b16 a[184:185], v246 offset:10240
    ds_read_b64_tr_b16 a[186:187], v246 offset:10752
    ds_read_b64_tr_b16 a[188:189], v246 offset:11264
    ds_read_b64_tr_b16 a[190:191], v246 offset:11776
    v_lshlrev_b32 v226, 16, v29
    v_and_b32 v227, s62, v29
    v_fma_f32 v226, v226, v244, v245
    v_fma_f32 v227, v227, v244, v245
    v_cvt_pk_bf16_f32 v29, v226, v227
    s_waitcnt lgkmcnt(4)
    v_mfma_f32_32x32x16_bf16 v[128:143], a[16:19], v[24:27], v[128:143]
    ds_read_b64_tr_b16 a[40:41], v236 offset:41984
    ds_read_b64_tr_b16 a[42:43], v236 offset:42496
    v_lshlrev_b32 v228, 16, v30
    v_and_b32 v229, s62, v30
    v_fma_f32 v228, v228, v244, v245
    v_fma_f32 v229, v229, v244, v245
    v_cvt_pk_bf16_f32 v30, v228, v229
    v_mfma_f32_32x32x16_bf16 v[144:159], a[20:23], v[24:27], v[144:159]
    ds_read_b64_tr_b16 a[44:45], v237 offset:41984
    ds_read_b64_tr_b16 a[46:47], v237 offset:42496
    v_lshlrev_b32 v230, 16, v31
    v_and_b32 v231, s62, v31
    v_fma_f32 v230, v230, v244, v245
    v_fma_f32 v231, v231, v244, v245
    v_cvt_pk_bf16_f32 v31, v230, v231
    s_waitcnt vmcnt(7)
    s_barrier
    v_mfma_f32_32x32x16_bf16 v[160:175], a[24:27], v[28:31], v[160:175]
    ds_read_b64_tr_b16 a[0:1], v236 offset:13312
    ds_read_b64_tr_b16 a[2:3], v236 offset:13824
    s_add_u32 m0, s50, 0xc00
    s_waitcnt lgkmcnt(2)
    v_mfma_f32_16x16x32_bf16 a[160:163], a[184:187], a[172:175], a[160:163]
    buffer_load_dwordx4 v240, s[28:31], s53 offen lds
    v_lshlrev_b32 v224, 16, v32
    v_mfma_f32_32x32x16_bf16 v[176:191], a[28:31], v[28:31], v[176:191]
    ds_read_b64_tr_b16 a[4:5], v237 offset:13312
    ds_read_b64_tr_b16 a[6:7], v237 offset:13824
    buffer_load_dwordx4 v240, s[28:31], s53 offen offset:1024 lds
    v_mfma_f32_16x16x32_bf16 a[164:167], a[172:175], a[188:191], a[164:167]
    v_and_b32 v225, s62, v32
    v_fma_f32 v224, v224, v244, v245
    v_fma_f32 v225, v225, v244, v245
    v_cvt_pk_bf16_f32 v32, v224, v225
    v_lshlrev_b32 v226, 16, v33
    v_mfma_f32_32x32x16_bf16 v[192:207], v[28:31], a[32:35], v[192:207]
    ds_read_b64_tr_b16 a[8:9], v236 offset:14336
    ds_read_b64_tr_b16 a[10:11], v236 offset:14848
    buffer_load_dwordx4 v240, s[28:31], s53 offen offset:2048 lds
    v_and_b32 v227, s62, v33
    v_fma_f32 v226, v226, v244, v245
    v_fma_f32 v227, v227, v244, v245
    v_mfma_f32_32x32x16_bf16 v[208:223], v[28:31], a[36:39], v[208:223]
    ds_read_b64_tr_b16 a[12:13], v237 offset:14336
    ds_read_b64_tr_b16 a[14:15], v237 offset:14848
    s_add_u32 s53, s53, 0x18000
    s_add_u32 m0, s50, 0x1800
    v_cvt_pk_bf16_f32 v33, v226, v227
    buffer_load_dwordx4 v240, s[28:31], s53 offen lds
    v_mfma_f32_32x32x16_bf16 v[128:143], a[40:43], v[28:31], v[128:143]
    ds_read_b64_tr_b16 a[16:17], v236 offset:12288
    ds_read_b64_tr_b16 a[18:19], v236 offset:12800
    buffer_load_dwordx4 v240, s[28:31], s53 offen offset:1024 lds
    v_lshlrev_b32 v228, 16, v34
    v_and_b32 v229, s62, v34
    v_fma_f32 v228, v228, v244, v245
    v_fma_f32 v229, v229, v244, v245
    v_cvt_pk_bf16_f32 v34, v228, v229
    v_mfma_f32_32x32x16_bf16 v[144:159], a[44:47], v[28:31], v[144:159]
    ds_read_b64_tr_b16 a[20:21], v237 offset:12288
    ds_read_b64_tr_b16 a[22:23], v237 offset:12800
    v_lshlrev_b32 v230, 16, v35
    v_and_b32 v231, s62, v35
    v_fma_f32 v230, v230, v244, v245
    buffer_load_dwordx4 v240, s[28:31], s53 offen offset:2048 lds
    v_fma_f32 v231, v231, v244, v245
    v_cvt_pk_bf16_f32 v35, v230, v231
    s_waitcnt lgkmcnt(2)
    s_nop 0
    v_mfma_f32_32x32x16_bf16 v[160:175], a[0:3], v[32:35], v[160:175]
    ds_read_b64_tr_b16 a[24:25], v236 offset:46080
    ds_read_b64_tr_b16 a[26:27], v236 offset:46592
    ds_read_b128 a[168:171], v247 offset:4096
    ds_read_b64_tr_b16 a[176:177], v246 offset:13312
    ds_read_b64_tr_b16 a[178:179], v246 offset:13824
    v_mfma_f32_32x32x16_bf16 v[176:191], a[4:7], v[32:35], v[176:191]
    ds_read_b64_tr_b16 a[28:29], v237 offset:46080
    ds_read_b64_tr_b16 a[30:31], v237 offset:46592
    s_add_u32 s53, s53, 0x18000
    ds_read_b64_tr_b16 a[180:181], v246 offset:14336
    ds_read_b64_tr_b16 a[182:183], v246 offset:14848
    v_lshlrev_b32 v224, 16, v36
    v_and_b32 v225, s62, v36
    v_mfma_f32_32x32x16_bf16 v[192:207], v[32:35], a[8:11], v[192:207]
    ds_read_b64_tr_b16 a[32:33], v236 offset:47104
    ds_read_b64_tr_b16 a[34:35], v236 offset:47616
    v_fma_f32 v224, v224, v244, v245
    v_fma_f32 v225, v225, v244, v245
    v_cvt_pk_bf16_f32 v36, v224, v225
    v_lshlrev_b32 v226, 16, v37
    v_and_b32 v227, s62, v37
    v_mfma_f32_32x32x16_bf16 v[208:223], v[32:35], a[12:15], v[208:223]
    ds_read_b64_tr_b16 a[36:37], v237 offset:47104
    ds_read_b64_tr_b16 a[38:39], v237 offset:47616
    v_fma_f32 v226, v226, v244, v245
    v_fma_f32 v227, v227, v244, v245
    v_cvt_pk_bf16_f32 v37, v226, v227
    v_lshlrev_b32 v228, 16, v38
    v_and_b32 v229, s62, v38
    v_mfma_f32_32x32x16_bf16 v[128:143], a[16:19], v[32:35], v[128:143]
    ds_read_b64_tr_b16 a[40:41], v236 offset:45056
    ds_read_b64_tr_b16 a[42:43], v236 offset:45568
    v_fma_f32 v228, v228, v244, v245
    v_fma_f32 v229, v229, v244, v245
    v_cvt_pk_bf16_f32 v38, v228, v229
    v_lshlrev_b32 v230, 16, v39
    s_waitcnt lgkmcnt(2)
    v_mfma_f32_32x32x16_bf16 v[144:159], a[20:23], v[32:35], v[144:159]
    ds_read_b64_tr_b16 a[44:45], v237 offset:45056
    ds_read_b64_tr_b16 a[46:47], v237 offset:45568
    v_and_b32 v231, s62, v39
    v_fma_f32 v230, v230, v244, v245
    v_fma_f32 v231, v231, v244, v245
    v_cvt_pk_bf16_f32 v39, v230, v231
    v_mfma_f32_16x16x32_bf16 a[160:163], a[176:179], a[168:171], a[160:163]
    v_lshlrev_b32 v224, 16, v40
    v_and_b32 v225, s62, v40
    v_fma_f32 v224, v224, v244, v245
    v_mfma_f32_32x32x16_bf16 v[160:175], a[24:27], v[36:39], v[160:175]
    ds_read_b64_tr_b16 a[0:1], v236 offset:16384
    ds_read_b64_tr_b16 a[2:3], v236 offset:16896
    s_lshl_b32 s67, s75, 9
    buffer_load_dword a199, v234, s[12:15], s67 offen
    v_fma_f32 v225, v225, v244, v245
    v_cvt_pk_bf16_f32 v40, v224, v225
    v_mfma_f32_32x32x16_bf16 v[176:191], a[28:31], v[36:39], v[176:191]
    ds_read_b64_tr_b16 a[4:5], v237 offset:16384
    ds_read_b64_tr_b16 a[6:7], v237 offset:16896
    buffer_load_dword a199, v239, s[40:43], s58 offen sc1
    v_mfma_f32_16x16x32_bf16 a[164:167], a[168:171], a[180:183], a[164:167]
    v_lshlrev_b32 v226, 16, v41
    v_and_b32 v227, s62, v41
    v_fma_f32 v226, v226, v244, v245
    v_fma_f32 v227, v227, v244, v245
    v_cvt_pk_bf16_f32 v41, v226, v227
    v_mfma_f32_32x32x16_bf16 v[192:207], v[36:39], a[32:35], v[192:207]
    ds_read_b64_tr_b16 a[8:9], v236 offset:17408
    ds_read_b64_tr_b16 a[10:11], v236 offset:17920
    v_lshlrev_b32 v228, 16, v42
    v_and_b32 v229, s62, v42
    v_fma_f32 v228, v228, v244, v245
    v_fma_f32 v229, v229, v244, v245
    v_cvt_pk_bf16_f32 v42, v228, v229
    v_mfma_f32_32x32x16_bf16 v[208:223], v[36:39], a[36:39], v[208:223]
    ds_read_b64_tr_b16 a[12:13], v237 offset:17408
    ds_read_b64_tr_b16 a[14:15], v237 offset:17920
    v_lshlrev_b32 v230, 16, v43
    v_and_b32 v231, s62, v43
    v_fma_f32 v230, v230, v244, v245
    v_fma_f32 v231, v231, v244, v245
    s_waitcnt lgkmcnt(2)
    v_mfma_f32_32x32x16_bf16 v[128:143], a[40:43], v[36:39], v[128:143]
    ds_read_b64_tr_b16 a[16:17], v236 offset:15360
    ds_read_b64_tr_b16 a[18:19], v236 offset:15872
    v_cvt_pk_bf16_f32 v43, v230, v231
    ds_read_b128 a[172:175], v247 offset:5120
    ds_read_b64_tr_b16 a[184:185], v246 offset:16384
    ds_read_b64_tr_b16 a[186:187], v246 offset:16896
    ds_read_b64_tr_b16 a[188:189], v246 offset:17408
    v_mfma_f32_32x32x16_bf16 v[144:159], a[44:47], v[36:39], v[144:159]
    ds_read_b64_tr_b16 a[20:21], v237 offset:15360
    ds_read_b64_tr_b16 a[22:23], v237 offset:15872
    ds_read_b64_tr_b16 a[190:191], v246 offset:17920
    v_lshlrev_b32 v224, 16, v44
    v_and_b32 v225, s62, v44
    v_fma_f32 v224, v224, v244, v245
    v_fma_f32 v225, v225, v244, v245
    v_mfma_f32_32x32x16_bf16 v[160:175], a[0:3], v[40:43], v[160:175]
    ds_read_b64_tr_b16 a[24:25], v236 offset:49152
    ds_read_b64_tr_b16 a[26:27], v236 offset:49664
    v_cvt_pk_bf16_f32 v44, v224, v225
    v_lshlrev_b32 v226, 16, v45
    v_and_b32 v227, s62, v45
    v_fma_f32 v226, v226, v244, v245
    v_fma_f32 v227, v227, v244, v245
    v_mfma_f32_32x32x16_bf16 v[176:191], a[4:7], v[40:43], v[176:191]
    ds_read_b64_tr_b16 a[28:29], v237 offset:49152
    ds_read_b64_tr_b16 a[30:31], v237 offset:49664
    v_cvt_pk_bf16_f32 v45, v226, v227
    v_lshlrev_b32 v228, 16, v46
    v_and_b32 v229, s62, v46
    v_fma_f32 v228, v228, v244, v245
    v_fma_f32 v229, v229, v244, v245
    v_mfma_f32_32x32x16_bf16 v[192:207], v[40:43], a[8:11], v[192:207]
    ds_read_b64_tr_b16 a[32:33], v236 offset:50176
    ds_read_b64_tr_b16 a[34:35], v236 offset:50688
    v_cvt_pk_bf16_f32 v46, v228, v229
    v_lshlrev_b32 v230, 16, v47
    v_and_b32 v231, s62, v47
    v_fma_f32 v230, v230, v244, v245
    s_waitcnt lgkmcnt(2)
    v_mfma_f32_32x32x16_bf16 v[208:223], v[40:43], a[12:15], v[208:223]
    ds_read_b64_tr_b16 a[36:37], v237 offset:50176
    ds_read_b64_tr_b16 a[38:39], v237 offset:50688
    v_fma_f32 v231, v231, v244, v245
    v_cvt_pk_bf16_f32 v47, v230, v231
    v_mfma_f32_16x16x32_bf16 a[160:163], a[184:187], a[172:175], a[160:163]
    v_lshlrev_b32 v224, 16, v48
    v_and_b32 v225, s62, v48
    v_fma_f32 v224, v224, v244, v245
    v_fma_f32 v225, v225, v244, v245
    v_cvt_pk_bf16_f32 v48, v224, v225
    v_mfma_f32_32x32x16_bf16 v[128:143], a[16:19], v[40:43], v[128:143]
    ds_read_b64_tr_b16 a[40:41], v236 offset:48128
    ds_read_b64_tr_b16 a[42:43], v236 offset:48640
    v_lshlrev_b32 v226, 16, v49
    v_and_b32 v227, s62, v49
    v_fma_f32 v226, v226, v244, v245
    v_fma_f32 v227, v227, v244, v245
    v_cvt_pk_bf16_f32 v49, v226, v227
    v_mfma_f32_32x32x16_bf16 v[144:159], a[20:23], v[40:43], v[144:159]
    ds_read_b64_tr_b16 a[44:45], v237 offset:48128
    ds_read_b64_tr_b16 a[46:47], v237 offset:48640
    v_lshlrev_b32 v228, 16, v50
    v_and_b32 v229, s62, v50
    v_fma_f32 v228, v228, v244, v245
    s_waitcnt vmcnt(9)
    s_barrier
    v_mfma_f32_32x32x16_bf16 v[160:175], a[24:27], v[44:47], v[160:175]
    ds_read_b64_tr_b16 a[0:1], v236 offset:19456
    ds_read_b64_tr_b16 a[2:3], v236 offset:19968
    s_add_u32 m0, s50, 0x2400
    v_fma_f32 v229, v229, v244, v245
    buffer_load_dwordx4 v240, s[28:31], s53 offen lds
    v_cvt_pk_bf16_f32 v50, v228, v229
    v_mfma_f32_32x32x16_bf16 v[176:191], a[28:31], v[44:47], v[176:191]
    ds_read_b64_tr_b16 a[4:5], v237 offset:19456
    ds_read_b64_tr_b16 a[6:7], v237 offset:19968
    buffer_load_dwordx4 v240, s[28:31], s53 offen offset:1024 lds
    v_mfma_f32_16x16x32_bf16 a[164:167], a[172:175], a[188:191], a[164:167]
    v_lshlrev_b32 v230, 16, v51
    v_and_b32 v231, s62, v51
    v_fma_f32 v230, v230, v244, v245
    v_fma_f32 v231, v231, v244, v245
    s_waitcnt lgkmcnt(2)
    v_mfma_f32_32x32x16_bf16 v[192:207], v[44:47], a[32:35], v[192:207]
    ds_read_b64_tr_b16 a[8:9], v236 offset:20480
    ds_read_b64_tr_b16 a[10:11], v236 offset:20992
    buffer_load_dwordx4 v240, s[28:31], s53 offen offset:2048 lds
    v_cvt_pk_bf16_f32 v51, v230, v231
    ds_read_b128 a[168:171], v247 offset:6144
    ds_read_b64_tr_b16 a[176:177], v246 offset:19456
    v_mfma_f32_32x32x16_bf16 v[208:223], v[44:47], a[36:39], v[208:223]
    ds_read_b64_tr_b16 a[12:13], v237 offset:20480
    ds_read_b64_tr_b16 a[14:15], v237 offset:20992
    s_add_u32 s53, s53, 0x18000
    s_add_u32 m0, s50, 0x3000
    ds_read_b64_tr_b16 a[178:179], v246 offset:19968
    buffer_load_dwordx4 v240, s[28:31], s53 offen lds
    v_mfma_f32_32x32x16_bf16 v[128:143], a[40:43], v[44:47], v[128:143]
    ds_read_b64_tr_b16 a[16:17], v236 offset:18432
    ds_read_b64_tr_b16 a[18:19], v236 offset:18944
    buffer_load_dwordx4 v240, s[28:31], s53 offen offset:1024 lds
    ds_read_b64_tr_b16 a[180:181], v246 offset:20480
    ds_read_b64_tr_b16 a[182:183], v246 offset:20992
    v_lshlrev_b32 v224, 16, v52
    v_mfma_f32_32x32x16_bf16 v[144:159], a[44:47], v[44:47], v[144:159]
    ds_read_b64_tr_b16 a[20:21], v237 offset:18432
    ds_read_b64_tr_b16 a[22:23], v237 offset:18944
    v_and_b32 v225, s62, v52
    v_fma_f32 v224, v224, v244, v245
    v_fma_f32 v225, v225, v244, v245
    v_cvt_pk_bf16_f32 v52, v224, v225
    v_lshlrev_b32 v226, 16, v53
    buffer_load_dwordx4 v240, s[28:31], s53 offen offset:2048 lds
    v_mfma_f32_32x32x16_bf16 v[160:175], a[0:3], v[48:51], v[160:175]
    ds_read_b64_tr_b16 a[24:25], v236 offset:52224
    ds_read_b64_tr_b16 a[26:27], v236 offset:52736
    v_and_b32 v227, s62, v53
    v_fma_f32 v226, v226, v244, v245
    s_waitcnt lgkmcnt(2)
    v_mfma_f32_32x32x16_bf16 v[176:191], a[4:7], v[48:51], v[176:191]
    ds_read_b64_tr_b16 a[28:29], v237 offset:52224
    ds_read_b64_tr_b16 a[30:31], v237 offset:52736
    s_add_u32 s53, s53, 0x18000
    s_cmp_eq_u32 s76, 1
    s_cselect_b32 s55, 0x180000, 0
    s_sub_u32 s53, s53, s55
    v_fma_f32 v227, v227, v244, v245
    v_mfma_f32_32x32x16_bf16 v[192:207], v[48:51], a[8:11], v[192:207]
    ds_read_b64_tr_b16 a[32:33], v236 offset:53248
    ds_read_b64_tr_b16 a[34:35], v236 offset:53760
    v_cvt_pk_bf16_f32 v53, v226, v227
    v_lshlrev_b32 v228, 16, v54
    v_and_b32 v229, s62, v54
    v_fma_f32 v228, v228, v244, v245
    v_fma_f32 v229, v229, v244, v245
    v_mfma_f32_32x32x16_bf16 v[208:223], v[48:51], a[12:15], v[208:223]
    ds_read_b64_tr_b16 a[36:37], v237 offset:53248
    ds_read_b64_tr_b16 a[38:39], v237 offset:53760
    v_cvt_pk_bf16_f32 v54, v228, v229
    v_lshlrev_b32 v230, 16, v55
    v_and_b32 v231, s62, v55
    v_fma_f32 v230, v230, v244, v245
    v_fma_f32 v231, v231, v244, v245
    v_mfma_f32_32x32x16_bf16 v[128:143], a[16:19], v[48:51], v[128:143]
    ds_read_b64_tr_b16 a[40:41], v236 offset:51200
    ds_read_b64_tr_b16 a[42:43], v236 offset:51712
    v_cvt_pk_bf16_f32 v55, v230, v231
    v_mfma_f32_16x16x32_bf16 a[160:163], a[176:179], a[168:171], a[160:163]
    v_lshlrev_b32 v224, 16, v56
    v_and_b32 v225, s62, v56
    v_fma_f32 v224, v224, v244, v245
    v_fma_f32 v225, v225, v244, v245
    v_cvt_pk_bf16_f32 v56, v224, v225
    v_lshlrev_b32 v226, 16, v57
    v_mfma_f32_32x32x16_bf16 v[144:159], a[20:23], v[48:51], v[144:159]
    ds_read_b64_tr_b16 a[44:45], v237 offset:51200
    ds_read_b64_tr_b16 a[46:47], v237 offset:51712
    v_and_b32 v227, s62, v57
    v_fma_f32 v226, v226, v244, v245
    v_fma_f32 v227, v227, v244, v245
    v_cvt_pk_bf16_f32 v57, v226, v227
    s_waitcnt lgkmcnt(2)
    v_mfma_f32_32x32x16_bf16 v[160:175], a[24:27], v[52:55], v[160:175]
    ds_read_b64_tr_b16 a[0:1], v236 offset:1024
    ds_read_b64_tr_b16 a[2:3], v236 offset:1536
    v_lshlrev_b32 v228, 16, v58
    v_and_b32 v229, s62, v58
    v_fma_f32 v228, v228, v244, v245
    v_fma_f32 v229, v229, v244, v245
    v_cvt_pk_bf16_f32 v58, v228, v229
    v_mfma_f32_32x32x16_bf16 v[176:191], a[28:31], v[52:55], v[176:191]
    ds_read_b64_tr_b16 a[4:5], v237 offset:1024
    ds_read_b64_tr_b16 a[6:7], v237 offset:1536
    v_mfma_f32_16x16x32_bf16 a[164:167], a[168:171], a[180:183], a[164:167]
    v_lshlrev_b32 v230, 16, v59
    v_and_b32 v231, s62, v59
    v_fma_f32 v230, v230, v244, v245
    v_fma_f32 v231, v231, v244, v245
    v_cvt_pk_bf16_f32 v59, v230, v231
    ds_read_b128 a[172:175], v247 offset:7168
    ds_read_b64_tr_b16 a[184:185], v246 offset:1024
    v_mfma_f32_32x32x16_bf16 v[192:207], v[52:55], a[32:35], v[192:207]
    ds_read_b64_tr_b16 a[8:9], v236 offset:2048
    ds_read_b64_tr_b16 a[10:11], v236 offset:2560
    ds_read_b64_tr_b16 a[186:187], v246 offset:1536
    ds_read_b64_tr_b16 a[188:189], v246 offset:2048
    ds_read_b64_tr_b16 a[190:191], v246 offset:2560
    v_lshlrev_b32 v224, 16, v60
    v_and_b32 v225, s62, v60
    v_mfma_f32_32x32x16_bf16 v[208:223], v[52:55], a[36:39], v[208:223]
    ds_read_b64_tr_b16 a[12:13], v237 offset:2048
    ds_read_b64_tr_b16 a[14:15], v237 offset:2560
    v_fma_f32 v224, v224, v244, v245
    v_fma_f32 v225, v225, v244, v245
    v_cvt_pk_bf16_f32 v60, v224, v225
    v_lshlrev_b32 v226, 16, v61
    v_and_b32 v227, s62, v61
    v_mfma_f32_32x32x16_bf16 v[128:143], a[40:43], v[52:55], v[128:143]
    ds_read_b64_tr_b16 a[16:17], v236 offset:0
    ds_read_b64_tr_b16 a[18:19], v236 offset:512
    v_fma_f32 v226, v226, v244, v245
    v_fma_f32 v227, v227, v244, v245
    v_cvt_pk_bf16_f32 v61, v226, v227
    v_lshlrev_b32 v228, 16, v62
    s_waitcnt lgkmcnt(2)
    v_mfma_f32_32x32x16_bf16 v[144:159], a[44:47], v[52:55], v[144:159]
    ds_read_b64_tr_b16 a[20:21], v237 offset:0
    ds_read_b64_tr_b16 a[22:23], v237 offset:512
    v_and_b32 v229, s62, v62
    v_fma_f32 v228, v228, v244, v245
    v_fma_f32 v229, v229, v244, v245
    v_cvt_pk_bf16_f32 v62, v228, v229
    v_lshlrev_b32 v230, 16, v63
    v_mfma_f32_32x32x16_bf16 v[160:175], a[0:3], v[56:59], v[160:175]
    ds_read_b64_tr_b16 a[24:25], v236 offset:33792
    ds_read_b64_tr_b16 a[26:27], v236 offset:34304
    v_and_b32 v231, s62, v63
    v_fma_f32 v230, v230, v244, v245
    v_fma_f32 v231, v231, v244, v245
    v_cvt_pk_bf16_f32 v63, v230, v231
    s_and_b32 s67, s3, 1
    v_mfma_f32_32x32x16_bf16 v[176:191], a[4:7], v[56:59], v[176:191]
    ds_read_b64_tr_b16 a[28:29], v237 offset:33792
    ds_read_b64_tr_b16 a[30:31], v237 offset:34304
    s_mul_i32 s67, s67, 16
    s_lshl_b32 s75, s4, 5
    s_add_u32 s67, s67, s75
    s_mul_i32 s67, s67, 0xe00
    s_lshl_b32 s75, s65, 5
    s_add_u32 s67, s67, s75
    buffer_load_dword a199, v235, s[44:47], s67 offen
    v_mfma_f32_32x32x16_bf16 v[192:207], v[56:59], a[8:11], v[192:207]
    ds_read_b64_tr_b16 a[32:33], v236 offset:34816
    ds_read_b64_tr_b16 a[34:35], v236 offset:35328
    v_mfma_f32_16x16x32_bf16 a[160:163], a[184:187], a[172:175], a[160:163]
    v_lshlrev_b32 v224, 16, v64
    v_and_b32 v225, s62, v64
    v_fma_f32 v224, v224, v244, v245
    v_fma_f32 v225, v225, v244, v245
    v_cvt_pk_bf16_f32 v64, v224, v225
    v_mfma_f32_32x32x16_bf16 v[208:223], v[56:59], a[12:15], v[208:223]
    ds_read_b64_tr_b16 a[36:37], v237 offset:34816
    ds_read_b64_tr_b16 a[38:39], v237 offset:35328
    v_lshlrev_b32 v226, 16, v65
    v_and_b32 v227, s62, v65
    v_fma_f32 v226, v226, v244, v245
    v_fma_f32 v227, v227, v244, v245
    s_waitcnt lgkmcnt(2)
    v_mfma_f32_32x32x16_bf16 v[128:143], a[16:19], v[56:59], v[128:143]
    ds_read_b64_tr_b16 a[40:41], v236 offset:32768
    ds_read_b64_tr_b16 a[42:43], v236 offset:33280
    v_cvt_pk_bf16_f32 v65, v226, v227
    v_lshlrev_b32 v228, 16, v66
    v_and_b32 v229, s62, v66
    v_fma_f32 v228, v228, v244, v245
    v_fma_f32 v229, v229, v244, v245
    v_mfma_f32_32x32x16_bf16 v[144:159], a[20:23], v[56:59], v[144:159]
    ds_read_b64_tr_b16 a[44:45], v237 offset:32768
    ds_read_b64_tr_b16 a[46:47], v237 offset:33280
    v_cvt_pk_bf16_f32 v66, v228, v229
    v_lshlrev_b32 v230, 16, v67
    v_and_b32 v231, s62, v67
    s_waitcnt vmcnt(9)
    s_barrier
    v_mfma_f32_32x32x16_bf16 v[160:175], a[24:27], v[60:63], v[160:175]
    ds_read_b64_tr_b16 a[0:1], v236 offset:4096
L_padA_2:
    s_cbranch_execz L_padA_6
    ds_read_b64_tr_b16 a[2:3], v236 offset:4608
    s_add_u32 m0, s50, 0x3c00
    v_fma_f32 v230, v230, v244, v245
    buffer_load_dwordx4 v240, s[28:31], s53 offen lds
    v_fma_f32 v231, v231, v244, v245
    v_mfma_f32_32x32x16_bf16 v[176:191], a[28:31], v[60:63], v[176:191]
    ds_read_b64_tr_b16 a[4:5], v237 offset:4096
    ds_read_b64_tr_b16 a[6:7], v237 offset:4608
    buffer_load_dwordx4 v240, s[28:31], s53 offen offset:1024 lds
    v_mfma_f32_16x16x32_bf16 a[164:167], a[172:175], a[188:191], a[164:167]
    v_cvt_pk_bf16_f32 v67, v230, v231
    ds_read_b128 a[168:171], v247 offset:8192
    ds_read_b64_tr_b16 a[176:177], v246 offset:4096
    ds_read_b64_tr_b16 a[178:179], v246 offset:4608
    ds_read_b64_tr_b16 a[180:181], v246 offset:5120
    v_mfma_f32_32x32x16_bf16 v[192:207], v[60:63], a[32:35], v[192:207]
    ds_read_b64_tr_b16 a[8:9], v236 offset:5120
    ds_read_b64_tr_b16 a[10:11], v236 offset:5632
    buffer_load_dwordx4 v240, s[28:31], s53 offen offset:2048 lds
    ds_read_b64_tr_b16 a[182:183], v246 offset:5632
    v_lshlrev_b32 v224, 16, v68
    s_waitcnt lgkmcnt(6)
    v_mfma_f32_32x32x16_bf16 v[208:223], v[60:63], a[36:39], v[208:223]
    ds_read_b64_tr_b16 a[12:13], v237 offset:5120
    ds_read_b64_tr_b16 a[14:15], v237 offset:5632
    s_add_u32 s53, s53, 0x18000
    s_add_u32 m0, s50, 0x4800
    v_and_b32 v225, s62, v68
    buffer_load_dwordx4 v240, s[28:31], s53 offen lds
    v_mfma_f32_32x32x16_bf16 v[128:143], a[40:43], v[60:63], v[128:143]
    ds_read_b64_tr_b16 a[16:17], v236 offset:3072
    ds_read_b64_tr_b16 a[18:19], v236 offset:3584
    buffer_load_dwordx4 v240, s[28:31], s53 offen offset:1024 lds
    v_fma_f32 v224, v224, v244, v245
    v_fma_f32 v225, v225, v244, v245
    v_cvt_pk_bf16_f32 v68, v224, v225
    v_mfma_f32_32x32x16_bf16 v[144:159], a[44:47], v[60:63], v[144:159]
    ds_read_b64_tr_b16 a[20:21], v237 offset:3072
    ds_read_b64_tr_b16 a[22:23], v237 offset:3584
    v_lshlrev_b32 v226, 16, v69
    v_and_b32 v227, s62, v69
    v_fma_f32 v226, v226, v244, v245
    v_fma_f32 v227, v227, v244, v245
    v_cvt_pk_bf16_f32 v69, v226, v227
    buffer_load_dwordx4 v240, s[28:31], s53 offen offset:2048 lds
    v_mfma_f32_32x32x16_bf16 v[160:175], a[0:3], v[64:67], v[160:175]
    ds_read_b64_tr_b16 a[24:25], v236 offset:36864
    ds_read_b64_tr_b16 a[26:27], v236 offset:37376
    v_lshlrev_b32 v228, 16, v70
    v_and_b32 v229, s62, v70
    v_fma_f32 v228, v228, v244, v245
    v_mfma_f32_32x32x16_bf16 v[176:191], a[4:7], v[64:67], v[176:191]
    ds_read_b64_tr_b16 a[28:29], v237 offset:36864
    ds_read_b64_tr_b16 a[30:31], v237 offset:37376
    s_add_u32 m0, s50, 0x5800
    s_add_u32 s49, s81, 0x40000
    buffer_load_dwordx4 v241, s[20:23], s49 offen lds
    s_waitcnt lgkmcnt(2)
    v_mfma_f32_32x32x16_bf16 v[192:207], v[64:67], a[8:11], v[192:207]
    ds_read_b64_tr_b16 a[32:33], v236 offset:37888
    ds_read_b64_tr_b16 a[34:35], v236 offset:38400
    v_fma_f32 v229, v229, v244, v245
    v_cvt_pk_bf16_f32 v70, v228, v229
    v_lshlrev_b32 v230, 16, v71
    v_and_b32 v231, s62, v71
    v_fma_f32 v230, v230, v244, v245
    v_mfma_f32_32x32x16_bf16 v[208:223], v[64:67], a[12:15], v[208:223]
    ds_read_b64_tr_b16 a[36:37], v237 offset:37888
    ds_read_b64_tr_b16 a[38:39], v237 offset:38400
    s_add_u32 m0, s50, 0x5c00
    s_add_u32 s49, s81, 0x44000
    buffer_load_dwordx4 v241, s[20:23], s49 offen lds
    v_fma_f32 v231, v231, v244, v245
    v_mfma_f32_32x32x16_bf16 v[128:143], a[16:19], v[64:67], v[128:143]
    ds_read_b64_tr_b16 a[40:41], v236 offset:35840
    ds_read_b64_tr_b16 a[42:43], v236 offset:36352
    v_cvt_pk_bf16_f32 v71, v230, v231
    v_mfma_f32_16x16x32_bf16 a[160:163], a[176:179], a[168:171], a[160:163]
    v_accvgpr_read_b32 v234, a192
    v_accvgpr_read_b32 v235, a193
    v_lshlrev_b32 v224, 16, v72
    v_and_b32 v225, s62, v72
    v_fma_f32 v224, v224, v244, v245
    v_fma_f32 v225, v225, v244, v245
    v_mfma_f32_32x32x16_bf16 v[144:159], a[20:23], v[64:67], v[144:159]
    ds_read_b64_tr_b16 a[44:45], v237 offset:35840
    ds_read_b64_tr_b16 a[46:47], v237 offset:36352
    s_add_u32 m0, s50, 0x6000
    s_add_u32 s49, s81, 0x48000
    buffer_load_dwordx4 v241, s[20:23], s49 offen lds
    v_cvt_pk_bf16_f32 v72, v224, v225
    v_mfma_f32_32x32x16_bf16 v[160:175], a[24:27], v[68:71], v[160:175]
    ds_read_b64_tr_b16 a[0:1], v236 offset:7168
    ds_read_b64_tr_b16 a[2:3], v236 offset:7680
    v_lshlrev_b32 v226, 16, v73
    v_and_b32 v227, s62, v73
    v_fma_f32 v226, v226, v244, v245
    v_fma_f32 v227, v227, v244, v245
    s_waitcnt lgkmcnt(2)
    v_mfma_f32_32x32x16_bf16 v[176:191], a[28:31], v[68:71], v[176:191]
    ds_read_b64_tr_b16 a[4:5], v237 offset:7168
    ds_read_b64_tr_b16 a[6:7], v237 offset:7680
    s_add_u32 m0, s50, 0x6400
    s_add_u32 s49, s81, 0x4c000
    buffer_load_dwordx4 v241, s[20:23], s49 offen lds
    v_mfma_f32_16x16x32_bf16 a[164:167], a[168:171], a[180:183], a[164:167]
    v_cvt_pk_bf16_f32 v73, v226, v227
    v_lshlrev_b32 v228, 16, v74
    v_and_b32 v229, s62, v74
    v_mfma_f32_32x32x16_bf16 v[192:207], v[68:71], a[32:35], v[192:207]
    ds_read_b64_tr_b16 a[8:9], v236 offset:8192
    ds_read_b64_tr_b16 a[10:11], v236 offset:8704
    v_fma_f32 v228, v228, v244, v245
    v_fma_f32 v229, v229, v244, v245
    v_cvt_pk_bf16_f32 v74, v228, v229
    v_lshlrev_b32 v230, 16, v75
    v_and_b32 v231, s62, v75
    s_add_u32 m0, s50, 0x6800
    s_add_u32 s49, s81, 0x50000
    v_mfma_f32_32x32x16_bf16 v[208:223], v[68:71], a[36:39], v[208:223]
    ds_read_b64_tr_b16 a[12:13], v237 offset:8192
    ds_read_b64_tr_b16 a[14:15], v237 offset:8704
    buffer_load_dwordx4 v241, s[20:23], s49 offen lds
    v_fma_f32 v230, v230, v244, v245
    v_mfma_f32_32x32x16_bf16 v[128:143], a[40:43], v[68:71], v[128:143]
    ds_read_b64_tr_b16 a[16:17], v236 offset:6144
    ds_read_b64_tr_b16 a[18:19], v236 offset:6656
    v_fma_f32 v231, v231, v244, v245
    v_cvt_pk_bf16_f32 v75, v230, v231
    ds_read_b128 a[172:175], v247 offset:9216
    ds_read_b64_tr_b16 a[184:185], v246 offset:7168
    ds_read_b64_tr_b16 a[186:187], v246 offset:7680
    s_add_u32 s53, s53, 0x18000
    v_mfma_f32_32x32x16_bf16 v[144:159], a[44:47], v[68:71], v[144:159]
    ds_read_b64_tr_b16 a[20:21], v237 offset:6144
    ds_read_b64_tr_b16 a[22:23], v237 offset:6656
    ds_read_b64_tr_b16 a[188:189], v246 offset:8192
    ds_read_b64_tr_b16 a[190:191], v246 offset:8704
    v_lshlrev_b32 v224, 16, v76
    s_waitcnt lgkmcnt(6)
    v_mfma_f32_32x32x16_bf16 v[160:175], a[0:3], v[72:75], v[160:175]
    ds_read_b64_tr_b16 a[24:25], v236 offset:39936
    ds_read_b64_tr_b16 a[26:27], v236 offset:40448
    v_and_b32 v225, s62, v76
    v_fma_f32 v224, v224, v244, v245
    v_fma_f32 v225, v225, v244, v245
    v_cvt_pk_bf16_f32 v76, v224, v225
    v_lshlrev_b32 v226, 16, v77
    v_mfma_f32_32x32x16_bf16 v[176:191], a[4:7], v[72:75], v[176:191]
    ds_read_b64_tr_b16 a[28:29], v237 offset:39936
    ds_read_b64_tr_b16 a[30:31], v237 offset:40448
    v_and_b32 v227, s62, v77
    v_fma_f32 v226, v226, v244, v245
    v_fma_f32 v227, v227, v244, v245
    v_cvt_pk_bf16_f32 v77, v226, v227
    v_lshlrev_b32 v228, 16, v78
    v_mfma_f32_32x32x16_bf16 v[192:207], v[72:75], a[8:11], v[192:207]
    ds_read_b64_tr_b16 a[32:33], v236 offset:40960
    ds_read_b64_tr_b16 a[34:35], v236 offset:41472
    v_and_b32 v229, s62, v78
    v_fma_f32 v228, v228, v244, v245
    v_fma_f32 v229, v229, v244, v245
    v_cvt_pk_bf16_f32 v78, v228, v229
    v_lshlrev_b32 v230, 16, v79
    v_mfma_f32_32x32x16_bf16 v[208:223], v[72:75], a[12:15], v[208:223]
    ds_read_b64_tr_b16 a[36:37], v237 offset:40960
    ds_read_b64_tr_b16 a[38:39], v237 offset:41472
    v_and_b32 v231, s62, v79
    v_fma_f32 v230, v230, v244, v245
    v_fma_f32 v231, v231, v244, v245
    v_cvt_pk_bf16_f32 v79, v230, v231
    s_waitcnt lgkmcnt(2)
    v_mfma_f32_16x16x32_bf16 a[160:163], a[184:187], a[172:175], a[160:163]
    v_lshlrev_b32 v224, 16, v80
    v_and_b32 v225, s62, v80
    v_mfma_f32_32x32x16_bf16 v[128:143], a[16:19], v[72:75], v[128:143]
    ds_read_b64_tr_b16 a[40:41], v236 offset:38912
    ds_read_b64_tr_b16 a[42:43], v236 offset:39424
    v_fma_f32 v224, v224, v244, v245
    v_fma_f32 v225, v225, v244, v245
    v_cvt_pk_bf16_f32 v80, v224, v225
    v_lshlrev_b32 v226, 16, v81
    v_and_b32 v227, s62, v81
    v_mfma_f32_32x32x16_bf16 v[144:159], a[20:23], v[72:75], v[144:159]
    ds_read_b64_tr_b16 a[44:45], v237 offset:38912
    ds_read_b64_tr_b16 a[46:47], v237 offset:39424
    v_fma_f32 v226, v226, v244, v245
    v_fma_f32 v227, v227, v244, v245
    v_cvt_pk_bf16_f32 v81, v226, v227
    s_waitcnt vmcnt(12)
    s_barrier
    v_mfma_f32_32x32x16_bf16 v[160:175], a[24:27], v[76:79], v[160:175]
    ds_read_b64_tr_b16 a[0:1], v236 offset:10240
    ds_read_b64_tr_b16 a[2:3], v236 offset:10752
    s_add_u32 m0, s50, 0
    v_lshlrev_b32 v228, 16, v82
    buffer_load_dwordx4 v240, s[28:31], s53 offen lds
    v_and_b32 v229, s62, v82
    v_mfma_f32_32x32x16_bf16 v[176:191], a[28:31], v[76:79], v[176:191]
    ds_read_b64_tr_b16 a[4:5], v237 offset:10240
    ds_read_b64_tr_b16 a[6:7], v237 offset:10752
    buffer_load_dwordx4 v240, s[28:31], s53 offen offset:1024 lds
    v_mfma_f32_16x16x32_bf16 a[164:167], a[172:175], a[188:191], a[164:167]
    v_fma_f32 v228, v228, v244, v245
    v_fma_f32 v229, v229, v244, v245
    v_cvt_pk_bf16_f32 v82, v228, v229
    v_lshlrev_b32 v230, 16, v83
    v_and_b32 v231, s62, v83
    v_mfma_f32_32x32x16_bf16 v[192:207], v[76:79], a[32:35], v[192:207]
    ds_read_b64_tr_b16 a[8:9], v236 offset:11264
    ds_read_b64_tr_b16 a[10:11], v236 offset:11776
    buffer_load_dwordx4 v240, s[28:31], s53 offen offset:2048 lds
    v_fma_f32 v230, v230, v244, v245
    v_fma_f32 v231, v231, v244, v245
    s_waitcnt lgkmcnt(2)
    v_mfma_f32_32x32x16_bf16 v[208:223], v[76:79], a[36:39], v[208:223]
    ds_read_b64_tr_b16 a[12:13], v237 offset:11264
    ds_read_b64_tr_b16 a[14:15], v237 offset:11776
    s_add_u32 s53, s53, 0x18000
    s_add_u32 m0, s50, 0xc00
    v_cvt_pk_bf16_f32 v83, v230, v231
    buffer_load_dwordx4 v240, s[28:31], s53 offen lds
    v_mfma_f32_32x32x16_bf16 v[128:143], a[40:43], v[76:79], v[128:143]
    ds_read_b64_tr_b16 a[16:17], v236 offset:9216
    ds_read_b64_tr_b16 a[18:19], v236 offset:9728
    buffer_load_dwordx4 v240, s[28:31], s53 offen offset:1024 lds
    ds_read_b128 a[168:171], v247 offset:10240
    ds_read_b64_tr_b16 a[176:177], v246 offset:10240
    ds_read_b64_tr_b16 a[178:179], v246 offset:10752
    v_mfma_f32_32x32x16_bf16 v[144:159], a[44:47], v[76:79], v[144:159]
    ds_read_b64_tr_b16 a[20:21], v237 offset:9216
    ds_read_b64_tr_b16 a[22:23], v237 offset:9728
    ds_read_b64_tr_b16 a[180:181], v246 offset:11264
    ds_read_b64_tr_b16 a[182:183], v246 offset:11776
    v_lshlrev_b32 v224, 16, v84
    v_and_b32 v225, s62, v84
    v_fma_f32 v224, v224, v244, v245
    buffer_load_dwordx4 v240, s[28:31], s53 offen offset:2048 lds
    v_mfma_f32_32x32x16_bf16 v[160:175], a[0:3], v[80:83], v[160:175]
    ds_read_b64_tr_b16 a[24:25], v236 offset:43008
    ds_read_b64_tr_b16 a[26:27], v236 offset:43520
    v_fma_f32 v225, v225, v244, v245
    v_cvt_pk_bf16_f32 v84, v224, v225
    v_lshlrev_b32 v226, 16, v85
    v_mfma_f32_32x32x16_bf16 v[176:191], a[4:7], v[80:83], v[176:191]
    ds_read_b64_tr_b16 a[28:29], v237 offset:43008
    ds_read_b64_tr_b16 a[30:31], v237 offset:43520
    s_add_u32 m0, s50, 0x6c00
    s_add_u32 s49, s81, 0x54000
    buffer_load_dwordx4 v241, s[20:23], s49 offen lds
    s_waitcnt lgkmcnt(2)
    v_mfma_f32_32x32x16_bf16 v[192:207], v[80:83], a[8:11], v[192:207]
    ds_read_b64_tr_b16 a[32:33], v236 offset:44032
    ds_read_b64_tr_b16 a[34:35], v236 offset:44544
    v_and_b32 v227, s62, v85
    v_fma_f32 v226, v226, v244, v245
    v_fma_f32 v227, v227, v244, v245
    v_cvt_pk_bf16_f32 v85, v226, v227
    v_lshlrev_b32 v228, 16, v86
    v_mfma_f32_32x32x16_bf16 v[208:223], v[80:83], a[12:15], v[208:223]
    ds_read_b64_tr_b16 a[36:37], v237 offset:44032
    ds_read_b64_tr_b16 a[38:39], v237 offset:44544
    s_add_u32 m0, s50, 0x7000
    s_add_u32 s49, s81, 0x58000
    buffer_load_dwordx4 v241, s[20:23], s49 offen lds
    v_and_b32 v229, s62, v86
    v_mfma_f32_32x32x16_bf16 v[128:143], a[16:19], v[80:83], v[128:143]
    ds_read_b64_tr_b16 a[40:41], v236 offset:41984
    ds_read_b64_tr_b16 a[42:43], v236 offset:42496
    v_fma_f32 v228, v228, v244, v245
    v_fma_f32 v229, v229, v244, v245
    v_cvt_pk_bf16_f32 v86, v228, v229
    v_lshlrev_b32 v230, 16, v87
    v_and_b32 v231, s62, v87
    v_mfma_f32_32x32x16_bf16 v[144:159], a[20:23], v[80:83], v[144:159]
    ds_read_b64_tr_b16 a[44:45], v237 offset:41984
    ds_read_b64_tr_b16 a[46:47], v237 offset:42496
    s_add_u32 m0, s50, 0x7400
    s_add_u32 s49, s81, 0x5c000
    buffer_load_dwordx4 v241, s[20:23], s49 offen lds
    v_fma_f32 v230, v230, v244, v245
    v_fma_f32 v231, v231, v244, v245
    v_cvt_pk_bf16_f32 v87, v230, v231
    s_nop 1
    v_mfma_f32_32x32x16_bf16 v[160:175], a[24:27], v[84:87], v[160:175]
    ds_read_b64_tr_b16 a[0:1], v236 offset:13312
    ds_read_b64_tr_b16 a[2:3], v236 offset:13824
    s_add_u32 m0, s50, 0x7800
    s_add_u32 s49, s0, 0x40000
    buffer_load_dwordx4 v241, s[20:23], s49 offen lds
    s_waitcnt lgkmcnt(2)
    v_mfma_f32_32x32x16_bf16 v[176:191], a[28:31], v[84:87], v[176:191]
    ds_read_b64_tr_b16 a[4:5], v237 offset:13312
    ds_read_b64_tr_b16 a[6:7], v237 offset:13824
    s_add_u32 m0, s50, 0x7c00
    s_add_u32 s49, s0, 0x44000
    buffer_load_dwordx4 v241, s[20:23], s49 offen lds
    v_mfma_f32_16x16x32_bf16 a[160:163], a[176:179], a[168:171], a[160:163]
    v_mfma_f32_16x16x32_bf16 a[164:167], a[168:171], a[180:183], a[164:167]
    v_lshlrev_b32 v224, 16, v88
    v_and_b32 v225, s62, v88
    v_fma_f32 v224, v224, v244, v245
    v_mfma_f32_32x32x16_bf16 v[192:207], v[84:87], a[32:35], v[192:207]
    ds_read_b64_tr_b16 a[8:9], v236 offset:14336
    ds_read_b64_tr_b16 a[10:11], v236 offset:14848
    v_fma_f32 v225, v225, v244, v245
    v_cvt_pk_bf16_f32 v88, v224, v225
    v_lshlrev_b32 v226, 16, v89
    v_and_b32 v227, s62, v89
    v_fma_f32 v226, v226, v244, v245
    v_mfma_f32_32x32x16_bf16 v[208:223], v[84:87], a[36:39], v[208:223]
    ds_read_b64_tr_b16 a[12:13], v237 offset:14336
    ds_read_b64_tr_b16 a[14:15], v237 offset:14848
    v_fma_f32 v227, v227, v244, v245
    v_cvt_pk_bf16_f32 v89, v226, v227
    v_lshlrev_b32 v228, 16, v90
    v_and_b32 v229, s62, v90
    v_fma_f32 v228, v228, v244, v245
    v_mfma_f32_32x32x16_bf16 v[128:143], a[40:43], v[84:87], v[128:143]
    ds_read_b64_tr_b16 a[16:17], v236 offset:12288
    ds_read_b64_tr_b16 a[18:19], v236 offset:12800
    v_fma_f32 v229, v229, v244, v245
    v_cvt_pk_bf16_f32 v90, v228, v229
    v_lshlrev_b32 v230, 16, v91
    v_and_b32 v231, s62, v91
    v_fma_f32 v230, v230, v244, v245
    v_mfma_f32_32x32x16_bf16 v[144:159], a[44:47], v[84:87], v[144:159]
    ds_read_b64_tr_b16 a[20:21], v237 offset:12288
    ds_read_b64_tr_b16 a[22:23], v237 offset:12800
    v_fma_f32 v231, v231, v244, v245
    v_cvt_pk_bf16_f32 v91, v230, v231
    ds_read_b128 a[172:175], v247 offset:11264
    ds_read_b64_tr_b16 a[184:185], v246 offset:13312
    s_waitcnt lgkmcnt(4)
    v_mfma_f32_32x32x16_bf16 v[160:175], a[0:3], v[88:91], v[160:175]
    ds_read_b64_tr_b16 a[24:25], v236 offset:46080
    ds_read_b64_tr_b16 a[26:27], v236 offset:46592
    ds_read_b64_tr_b16 a[186:187], v246 offset:13824
    ds_read_b64_tr_b16 a[188:189], v246 offset:14336
    ds_read_b64_tr_b16 a[190:191], v246 offset:14848
    v_lshlrev_b32 v224, 16, v92
    v_and_b32 v225, s62, v92
    v_mfma_f32_32x32x16_bf16 v[176:191], a[4:7], v[88:91], v[176:191]
    ds_read_b64_tr_b16 a[28:29], v237 offset:46080
    ds_read_b64_tr_b16 a[30:31], v237 offset:46592
    v_fma_f32 v224, v224, v244, v245
    v_fma_f32 v225, v225, v244, v245
    v_cvt_pk_bf16_f32 v92, v224, v225
    v_lshlrev_b32 v226, 16, v93
    v_and_b32 v227, s62, v93
    v_mfma_f32_32x32x16_bf16 v[192:207], v[88:91], a[8:11], v[192:207]
    ds_read_b64_tr_b16 a[32:33], v236 offset:47104
    ds_read_b64_tr_b16 a[34:35], v236 offset:47616
    v_fma_f32 v226, v226, v244, v245
    v_fma_f32 v227, v227, v244, v245
    v_cvt_pk_bf16_f32 v93, v226, v227
    v_lshlrev_b32 v228, 16, v94
    v_and_b32 v229, s62, v94
    v_mfma_f32_32x32x16_bf16 v[208:223], v[88:91], a[12:15], v[208:223]
    ds_read_b64_tr_b16 a[36:37], v237 offset:47104
    ds_read_b64_tr_b16 a[38:39], v237 offset:47616
    v_fma_f32 v228, v228, v244, v245
    v_fma_f32 v229, v229, v244, v245
    v_cvt_pk_bf16_f32 v94, v228, v229
    v_lshlrev_b32 v230, 16, v95
    v_and_b32 v231, s62, v95
    v_mfma_f32_32x32x16_bf16 v[128:143], a[16:19], v[88:91], v[128:143]
    ds_read_b64_tr_b16 a[40:41], v236 offset:45056
    ds_read_b64_tr_b16 a[42:43], v236 offset:45568
    v_fma_f32 v230, v230, v244, v245
    v_fma_f32 v231, v231, v244, v245
    v_cvt_pk_bf16_f32 v95, v230, v231
    s_waitcnt lgkmcnt(2)
    v_mfma_f32_16x16x32_bf16 a[160:163], a[184:187], a[172:175], a[160:163]
    v_lshlrev_b32 v224, 16, v96
    v_and_b32 v225, s62, v96
    v_mfma_f32_32x32x16_bf16 v[144:159], a[20:23], v[88:91], v[144:159]
    ds_read_b64_tr_b16 a[44:45], v237 offset:45056
    ds_read_b64_tr_b16 a[46:47], v237 offset:45568
    v_fma_f32 v224, v224, v244, v245
    v_fma_f32 v225, v225, v244, v245
    v_cvt_pk_bf16_f32 v96, v224, v225
    s_waitcnt vmcnt(11)
    s_barrier
    v_mfma_f32_32x32x16_bf16 v[160:175], a[24:27], v[92:95], v[160:175]
    ds_read_b64_tr_b16 a[0:1], v236 offset:16384
    ds_read_b64_tr_b16 a[2:3], v236 offset:16896
    s_add_u32 m0, s50, 0x1800
    s_add_u32 s55, s54, 0xdc00
    buffer_load_dwordx4 v238, s[44:47], s54 offen lds
    v_lshlrev_b32 v226, 16, v97
    v_mfma_f32_32x32x16_bf16 v[176:191], a[28:31], v[92:95], v[176:191]
    ds_read_b64_tr_b16 a[4:5], v237 offset:16384
    ds_read_b64_tr_b16 a[6:7], v237 offset:16896
    buffer_load_dwordx4 v238, s[44:47], s55 offen offset:1024 lds
    v_mfma_f32_16x16x32_bf16 a[164:167], a[172:175], a[188:191], a[164:167]
    v_and_b32 v227, s62, v97
    v_fma_f32 v226, v226, v244, v245
    v_fma_f32 v227, v227, v244, v245
    v_cvt_pk_bf16_f32 v97, v226, v227
    v_lshlrev_b32 v228, 16, v98
    v_mfma_f32_32x32x16_bf16 v[192:207], v[92:95], a[32:35], v[192:207]
    ds_read_b64_tr_b16 a[8:9], v236 offset:17408
    ds_read_b64_tr_b16 a[10:11], v236 offset:17920
    s_add_u32 s54, s54, 0x38000
    s_add_u32 m0, s50, 0x2000
    s_add_u32 s55, s54, 0xdc00
    buffer_load_dwordx4 v238, s[44:47], s54 offen lds
    v_mfma_f32_32x32x16_bf16 v[208:223], v[92:95], a[36:39], v[208:223]
    ds_read_b64_tr_b16 a[12:13], v237 offset:17408
    ds_read_b64_tr_b16 a[14:15], v237 offset:17920
    buffer_load_dwordx4 v238, s[44:47], s55 offen offset:1024 lds
    v_and_b32 v229, s62, v98
    v_fma_f32 v228, v228, v244, v245
    s_waitcnt lgkmcnt(2)
    v_mfma_f32_32x32x16_bf16 v[128:143], a[40:43], v[92:95], v[128:143]
    ds_read_b64_tr_b16 a[16:17], v236 offset:15360
    ds_read_b64_tr_b16 a[18:19], v236 offset:15872
    s_add_u32 s54, s54, 0x38000
    s_cmp_eq_u32 s76, 3
    s_cselect_b32 s55, 0x1c0000, 0
    s_sub_u32 s54, s54, s55
    s_add_u32 m0, s50, 0x2800
    s_add_u32 s55, s54, 0xdc00
    buffer_load_dwordx4 v238, s[44:47], s54 offen lds
    v_fma_f32 v229, v229, v244, v245
    v_cvt_pk_bf16_f32 v98, v228, v229
    v_mfma_f32_32x32x16_bf16 v[144:159], a[44:47], v[92:95], v[144:159]
    ds_read_b64_tr_b16 a[20:21], v237 offset:15360
    ds_read_b64_tr_b16 a[22:23], v237 offset:15872
    buffer_load_dwordx4 v238, s[44:47], s55 offen offset:1024 lds
    v_lshlrev_b32 v230, 16, v99
    v_and_b32 v231, s62, v99
    v_fma_f32 v230, v230, v244, v245
    v_fma_f32 v231, v231, v244, v245
    v_cvt_pk_bf16_f32 v99, v230, v231
    s_nop 1
    v_mfma_f32_32x32x16_bf16 v[160:175], a[0:3], v[96:99], v[160:175]
    ds_read_b64_tr_b16 a[24:25], v236 offset:49152
    ds_read_b64_tr_b16 a[26:27], v236 offset:49664
    ds_read_b128 a[168:171], v247 offset:12288
    ds_read_b64_tr_b16 a[176:177], v246 offset:16384
    ds_read_b64_tr_b16 a[178:179], v246 offset:16896
    v_mfma_f32_32x32x16_bf16 v[176:191], a[4:7], v[96:99], v[176:191]
    ds_read_b64_tr_b16 a[28:29], v237 offset:49152
    ds_read_b64_tr_b16 a[30:31], v237 offset:49664
    s_add_u32 s54, s54, 0x38000
    buffer_load_dword v248, off, s[24:27], 0 sc1
    ds_read_b64_tr_b16 a[180:181], v246 offset:17408
    ds_read_b64_tr_b16 a[182:183], v246 offset:17920
    v_mfma_f32_32x32x16_bf16 v[192:207], v[96:99], a[8:11], v[192:207]
    ds_read_b64_tr_b16 a[32:33], v236 offset:50176
    ds_read_b64_tr_b16 a[34:35], v236 offset:50688
    v_lshlrev_b32 v224, 16, v100
    v_and_b32 v225, s62, v100
    v_fma_f32 v224, v224, v244, v245
    v_fma_f32 v225, v225, v244, v245
    v_cvt_pk_bf16_f32 v100, v224, v225
    s_waitcnt lgkmcnt(3)
    v_mfma_f32_32x32x16_bf16 v[208:223], v[96:99], a[12:15], v[208:223]
    ds_read_b64_tr_b16 a[36:37], v237 offset:50176
    ds_read_b64_tr_b16 a[38:39], v237 offset:50688
    v_lshlrev_b32 v226, 16, v101
    v_and_b32 v227, s62, v101
    v_fma_f32 v226, v226, v244, v245
    v_fma_f32 v227, v227, v244, v245
    v_cvt_pk_bf16_f32 v101, v226, v227
    v_mfma_f32_32x32x16_bf16 v[128:143], a[16:19], v[96:99], v[128:143]
    ds_read_b64_tr_b16 a[40:41], v236 offset:48128
    ds_read_b64_tr_b16 a[42:43], v236 offset:48640
    v_lshlrev_b32 v228, 16, v102
    v_and_b32 v229, s62, v102
    v_fma_f32 v228, v228, v244, v245
    v_fma_f32 v229, v229, v244, v245
    v_cvt_pk_bf16_f32 v102, v228, v229
    v_mfma_f32_32x32x16_bf16 v[144:159], a[20:23], v[96:99], v[144:159]
    ds_read_b64_tr_b16 a[44:45], v237 offset:48128
    ds_read_b64_tr_b16 a[46:47], v237 offset:48640
    v_lshlrev_b32 v230, 16, v103
    v_and_b32 v231, s62, v103
    v_fma_f32 v230, v230, v244, v245
    v_fma_f32 v231, v231, v244, v245
    v_cvt_pk_bf16_f32 v103, v230, v231
    s_nop 1
    v_mfma_f32_32x32x16_bf16 v[160:175], a[24:27], v[100:103], v[160:175]
    ds_read_b64_tr_b16 a[0:1], v236 offset:19456
    ds_read_b64_tr_b16 a[2:3], v236 offset:19968
    v_mfma_f32_16x16x32_bf16 a[160:163], a[176:179], a[168:171], a[160:163]
    v_lshlrev_b32 v224, 16, v104
    v_and_b32 v225, s62, v104
    v_fma_f32 v224, v224, v244, v245
    v_fma_f32 v225, v225, v244, v245
    v_cvt_pk_bf16_f32 v104, v224, v225
    v_mfma_f32_32x32x16_bf16 v[176:191], a[28:31], v[100:103], v[176:191]
    ds_read_b64_tr_b16 a[4:5], v237 offset:19456
    ds_read_b64_tr_b16 a[6:7], v237 offset:19968
    s_waitcnt lgkmcnt(2)
    v_mfma_f32_16x16x32_bf16 a[164:167], a[168:171], a[180:183], a[164:167]
    v_lshlrev_b32 v226, 16, v105
    v_and_b32 v227, s62, v105
    v_fma_f32 v226, v226, v244, v245
    v_fma_f32 v227, v227, v244, v245
    v_cvt_pk_bf16_f32 v105, v226, v227
    v_mfma_f32_32x32x16_bf16 v[192:207], v[100:103], a[32:35], v[192:207]
    ds_read_b64_tr_b16 a[8:9], v236 offset:20480
    ds_read_b64_tr_b16 a[10:11], v236 offset:20992
    v_lshlrev_b32 v228, 16, v106
    v_and_b32 v229, s62, v106
    v_fma_f32 v228, v228, v244, v245
    v_fma_f32 v229, v229, v244, v245
    v_cvt_pk_bf16_f32 v106, v228, v229
    v_mfma_f32_32x32x16_bf16 v[208:223], v[100:103], a[36:39], v[208:223]
    ds_read_b64_tr_b16 a[12:13], v237 offset:20480
    ds_read_b64_tr_b16 a[14:15], v237 offset:20992
    v_lshlrev_b32 v230, 16, v107
    v_and_b32 v231, s62, v107
    v_fma_f32 v230, v230, v244, v245
    v_fma_f32 v231, v231, v244, v245
    v_cvt_pk_bf16_f32 v107, v230, v231
    v_mfma_f32_32x32x16_bf16 v[128:143], a[40:43], v[100:103], v[128:143]
    ds_read_b64_tr_b16 a[16:17], v236 offset:18432
    ds_read_b64_tr_b16 a[18:19], v236 offset:18944
    ds_read_b64_tr_b16 a[200:201], v234 offset:22528
    ds_read_b64_tr_b16 a[202:203], v234 offset:55296
    ds_read_b64_tr_b16 a[204:205], v235 offset:22528
    ds_read_b64_tr_b16 a[206:207], v235 offset:55296
    ds_read_b64_tr_b16 a[208:209], v234 offset:23552
    ds_read_b64_tr_b16 a[210:211], v234 offset:56320
    v_mfma_f32_32x32x16_bf16 v[144:159], a[44:47], v[100:103], v[144:159]
    ds_read_b64_tr_b16 a[20:21], v237 offset:18432
    ds_read_b64_tr_b16 a[22:23], v237 offset:18944
    ds_read_b64_tr_b16 a[212:213], v235 offset:23552
    ds_read_b64_tr_b16 a[214:215], v235 offset:56320
    ds_read_b64_tr_b16 a[216:217], v234 offset:24576
    ds_read_b64_tr_b16 a[218:219], v234 offset:57344
    v_mfma_f32_32x32x16_bf16 v[160:175], a[0:3], v[104:107], v[160:175]
    ds_read_b64_tr_b16 a[24:25], v236 offset:52224
    ds_read_b64_tr_b16 a[26:27], v236 offset:52736
    ds_read_b64_tr_b16 a[220:221], v235 offset:24576
    ds_read_b64_tr_b16 a[222:223], v235 offset:57344
    ds_read_b64_tr_b16 a[224:225], v234 offset:25600
    ds_read_b64_tr_b16 a[226:227], v234 offset:58368
    s_waitcnt lgkmcnt(8)
    v_mfma_f32_32x32x16_bf16 v[176:191], a[4:7], v[104:107], v[176:191]
    ds_read_b64_tr_b16 a[28:29], v237 offset:52224
    ds_read_b64_tr_b16 a[30:31], v237 offset:52736
    ds_read_b64_tr_b16 a[228:229], v235 offset:25600
    ds_read_b64_tr_b16 a[230:231], v235 offset:58368
    ds_read_b64_tr_b16 a[232:233], v234 offset:26624
    ds_read_b64_tr_b16 a[234:235], v234 offset:59392
    ds_read_b64_tr_b16 a[236:237], v235 offset:26624
    ds_read_b64_tr_b16 a[238:239], v235 offset:59392
    v_mfma_f32_32x32x16_bf16 v[192:207], v[104:107], a[8:11], v[192:207]
    ds_read_b64_tr_b16 a[32:33], v236 offset:53248
    ds_read_b64_tr_b16 a[34:35], v236 offset:53760
    ds_read_b128 a[172:175], v247 offset:13312
    ds_read_b64_tr_b16 a[184:185], v246 offset:19456
    ds_read_b64_tr_b16 a[186:187], v246 offset:19968
    ds_read_b64_tr_b16 a[188:189], v246 offset:20480
    v_lshlrev_b32 v224, 16, v108
    v_and_b32 v225, s62, v108
    v_fma_f32 v224, v224, v244, v245
    v_fma_f32 v225, v225, v244, v245
    v_cvt_pk_bf16_f32 v108, v224, v225
    v_mfma_f32_32x32x16_bf16 v[208:223], v[104:107], a[12:15], v[208:223]
L_padA_3:
    s_cbranch_execz L_backA
    ds_read_b64_tr_b16 a[36:37], v237 offset:53248
    ds_read_b64_tr_b16 a[38:39], v237 offset:53760
    ds_read_b64_tr_b16 a[190:191], v246 offset:20992
    v_lshlrev_b32 v226, 16, v109
    v_and_b32 v227, s62, v109
    v_fma_f32 v226, v226, v244, v245
    v_fma_f32 v227, v227, v244, v245
    v_cvt_pk_bf16_f32 v109, v226, v227
    v_mfma_f32_32x32x16_bf16 v[128:143], a[16:19], v[104:107], v[128:143]
    ds_read_b64_tr_b16 a[40:41], v236 offset:51200
    ds_read_b64_tr_b16 a[42:43], v236 offset:51712
    v_lshlrev_b32 v228, 16, v110
    v_and_b32 v229, s62, v110
    v_fma_f32 v228, v228, v244, v245
    v_fma_f32 v229, v229, v244, v245
    v_cvt_pk_bf16_f32 v110, v228, v229
    v_mfma_f32_32x32x16_bf16 v[144:159], a[20:23], v[104:107], v[144:159]
    ds_read_b64_tr_b16 a[44:45], v237 offset:51200
    ds_read_b64_tr_b16 a[46:47], v237 offset:51712
    v_lshlrev_b32 v230, 16, v111
    v_and_b32 v231, s62, v111
    v_fma_f32 v230, v230, v244, v245
    v_fma_f32 v231, v231, v244, v245
    v_cvt_pk_bf16_f32 v111, v230, v231
    s_waitcnt vmcnt(7) lgkmcnt(2)
    s_barrier
    v_mfma_f32_32x32x16_bf16 v[160:175], a[24:27], v[108:111], v[160:175]
    ds_read_b64_tr_b16 a[0:1], v236 offset:1024
    ds_read_b64_tr_b16 a[2:3], v236 offset:1536
    s_add_u32 m0, s50, 0x3000
    s_add_u32 s55, s54, 0xdc00
    buffer_load_dwordx4 v238, s[44:47], s54 offen lds
    v_mfma_f32_32x32x16_bf16 v[176:191], a[28:31], v[108:111], v[176:191]
    ds_read_b64_tr_b16 a[4:5], v236 offset:33792
    ds_read_b64_tr_b16 a[6:7], v236 offset:34304
    buffer_load_dwordx4 v238, s[44:47], s55 offen offset:1024 lds
    v_mfma_f32_16x16x32_bf16 a[160:163], a[184:187], a[172:175], a[160:163]
    v_mfma_f32_16x16x32_bf16 a[164:167], a[172:175], a[188:191], a[164:167]
    v_lshlrev_b32 v224, 16, v112
    v_and_b32 v225, s62, v112
    v_fma_f32 v224, v224, v244, v245
    v_fma_f32 v225, v225, v244, v245
    v_cvt_pk_bf16_f32 v112, v224, v225
    v_lshlrev_b32 v226, 16, v113
    v_mfma_f32_32x32x16_bf16 v[192:207], v[108:111], a[32:35], v[192:207]
    ds_read_b64_tr_b16 a[8:9], v236 offset:4096
    ds_read_b64_tr_b16 a[10:11], v236 offset:4608
    s_add_u32 s54, s54, 0x38000
    s_cmp_eq_u32 s76, 2
    s_cselect_b32 s55, 0x1c0000, 0
    s_sub_u32 s54, s54, s55
    s_add_u32 m0, s50, 0x3800
    s_add_u32 s55, s54, 0xdc00
    buffer_load_dwordx4 v238, s[44:47], s54 offen lds
    v_mfma_f32_32x32x16_bf16 v[208:223], v[108:111], a[36:39], v[208:223]
    ds_read_b64_tr_b16 a[12:13], v236 offset:36864
    ds_read_b64_tr_b16 a[14:15], v236 offset:37376
    buffer_load_dwordx4 v238, s[44:47], s55 offen offset:1024 lds
    v_and_b32 v227, s62, v113
    v_fma_f32 v226, v226, v244, v245
    v_fma_f32 v227, v227, v244, v245
    v_cvt_pk_bf16_f32 v113, v226, v227
    v_mfma_f32_32x32x16_bf16 v[128:143], a[40:43], v[108:111], v[128:143]
    ds_read_b64_tr_b16 a[16:17], v237 offset:1024
    ds_read_b64_tr_b16 a[18:19], v237 offset:1536
    s_add_u32 s54, s54, 0x38000
    s_add_u32 m0, s50, 0x4000
    s_add_u32 s55, s54, 0xdc00
    buffer_load_dwordx4 v238, s[44:47], s54 offen lds
    v_lshlrev_b32 v228, 16, v114
    v_and_b32 v229, s62, v114
    v_fma_f32 v228, v228, v244, v245
    v_fma_f32 v229, v229, v244, v245
    v_cvt_pk_bf16_f32 v114, v228, v229
    s_waitcnt lgkmcnt(0)
    v_mfma_f32_32x32x16_bf16 v[144:159], a[44:47], v[108:111], v[144:159]
    ds_read_b64_tr_b16 a[20:21], v237 offset:33792
    ds_read_b64_tr_b16 a[22:23], v237 offset:34304
    buffer_load_dwordx4 v238, s[44:47], s55 offen offset:1024 lds
    v_lshlrev_b32 v230, 16, v115
    v_and_b32 v231, s62, v115
    v_fma_f32 v230, v230, v244, v245
    v_fma_f32 v231, v231, v244, v245
    v_cvt_pk_bf16_f32 v115, v230, v231
    v_lshlrev_b32 v224, 16, v116
    v_and_b32 v225, s62, v116
    v_fma_f32 v224, v224, v244, v245
    v_fma_f32 v225, v225, v244, v245
    v_cvt_pk_bf16_f32 v116, v224, v225
    v_lshlrev_b32 v226, 16, v117
    v_and_b32 v227, s62, v117
    v_fma_f32 v226, v226, v244, v245
    v_fma_f32 v227, v227, v244, v245
    v_cvt_pk_bf16_f32 v117, v226, v227
    v_lshlrev_b32 v228, 16, v118
    v_and_b32 v229, s62, v118
    v_fma_f32 v228, v228, v244, v245
    v_fma_f32 v229, v229, v244, v245
    v_cvt_pk_bf16_f32 v118, v228, v229
    v_mfma_f32_32x32x16_bf16 v[160:175], a[0:3], v[112:115], v[160:175]
    ds_read_b64_tr_b16 a[24:25], v237 offset:4096
    ds_read_b64_tr_b16 a[26:27], v237 offset:4608
    s_add_u32 s54, s54, 0x38000
    s_cmp_eq_u32 s76, 1
    s_cselect_b32 s55, 0x1c0000, 0
    s_sub_u32 s54, s54, s55
    s_add_u32 m0, s50, 0x5800
    s_add_u32 s49, s0, 0x48000
    buffer_load_dwordx4 v241, s[20:23], s49 offen lds
    v_lshlrev_b32 v230, 16, v119
    v_and_b32 v231, s62, v119
    v_fma_f32 v230, v230, v244, v245
    v_fma_f32 v231, v231, v244, v245
    v_cvt_pk_bf16_f32 v119, v230, v231
    v_lshlrev_b32 v224, 16, v120
    v_and_b32 v225, s62, v120
    v_fma_f32 v224, v224, v244, v245
    v_fma_f32 v225, v225, v244, v245
    v_cvt_pk_bf16_f32 v120, v224, v225
    v_lshlrev_b32 v226, 16, v121
    v_and_b32 v227, s62, v121
    v_fma_f32 v226, v226, v244, v245
    v_fma_f32 v227, v227, v244, v245
    v_cvt_pk_bf16_f32 v121, v226, v227
    v_lshlrev_b32 v228, 16, v122
    v_and_b32 v229, s62, v122
    v_fma_f32 v228, v228, v244, v245
    v_fma_f32 v229, v229, v244, v245
    v_cvt_pk_bf16_f32 v122, v228, v229
    v_mfma_f32_32x32x16_bf16 v[160:175], a[4:7], v[116:119], v[160:175]
    ds_read_b64_tr_b16 a[28:29], v237 offset:36864
    ds_read_b64_tr_b16 a[30:31], v237 offset:37376
    s_add_u32 m0, s50, 0x5c00
    s_add_u32 s49, s0, 0x4c000
    buffer_load_dwordx4 v241, s[20:23], s49 offen lds
    v_lshlrev_b32 v230, 16, v123
    v_and_b32 v231, s62, v123
    v_fma_f32 v230, v230, v244, v245
    v_fma_f32 v231, v231, v244, v245
    v_cvt_pk_bf16_f32 v123, v230, v231
    v_lshlrev_b32 v224, 16, v124
    v_and_b32 v225, s62, v124
    v_fma_f32 v224, v224, v244, v245
    v_fma_f32 v225, v225, v244, v245
    v_cvt_pk_bf16_f32 v124, v224, v225
    v_lshlrev_b32 v226, 16, v125
    v_and_b32 v227, s62, v125
    v_fma_f32 v226, v226, v244, v245
    v_fma_f32 v227, v227, v244, v245
    v_cvt_pk_bf16_f32 v125, v226, v227
    v_lshlrev_b32 v228, 16, v126
    v_and_b32 v229, s62, v126
    v_fma_f32 v228, v228, v244, v245
    v_fma_f32 v229, v229, v244, v245
    v_cvt_pk_bf16_f32 v126, v228, v229
    v_mfma_f32_32x32x16_bf16 v[160:175], a[8:11], v[120:123], v[160:175]
    ds_read_b64_tr_b16 a[32:33], v236 offset:2048
    ds_read_b64_tr_b16 a[34:35], v236 offset:2560
    s_add_u32 m0, s50, 0x6000
    s_add_u32 s49, s0, 0x50000
    buffer_load_dwordx4 v241, s[20:23], s49 offen lds
    v_lshlrev_b32 v230, 16, v127
    v_and_b32 v231, s62, v127
    v_fma_f32 v230, v230, v244, v245
    v_fma_f32 v231, v231, v244, v245
    v_cvt_pk_bf16_f32 v127, v230, v231
    s_nop 1
    v_mfma_f32_32x32x16_bf16 v[160:175], a[12:15], v[124:127], v[160:175]
    ds_read_b64_tr_b16 a[36:37], v236 offset:34816
    ds_read_b64_tr_b16 a[38:39], v236 offset:35328
    s_add_u32 m0, s50, 0x6400
    s_add_u32 s49, s0, 0x54000
    buffer_load_dwordx4 v241, s[20:23], s49 offen lds
    ds_read_b128 a[168:171], v247 offset:14336
    ds_read_b64_tr_b16 a[176:177], v246 offset:1024
    ds_read_b64_tr_b16 a[178:179], v246 offset:1536
    ds_read_b64_tr_b16 a[180:181], v246 offset:2048
    ds_read_b64_tr_b16 a[182:183], v246 offset:2560
    v_mfma_f32_32x32x16_bf16 v[176:191], a[16:19], v[112:115], v[176:191]
    ds_read_b64_tr_b16 a[40:41], v236 offset:5120
    ds_read_b64_tr_b16 a[42:43], v236 offset:5632
    s_add_u32 m0, s50, 0x6800
    s_add_u32 s49, s0, 0x58000
    buffer_load_dwordx4 v241, s[20:23], s49 offen lds
    ds_read_b64_tr_b16 a[240:241], v234 offset:27648
    ds_read_b64_tr_b16 a[242:243], v234 offset:60416
    ds_read_b64_tr_b16 a[244:245], v235 offset:27648
    ds_read_b64_tr_b16 a[246:247], v235 offset:60416
    s_waitcnt lgkmcnt(6)
    v_mfma_f32_32x32x16_bf16 v[176:191], a[20:23], v[116:119], v[176:191]
    ds_read_b64_tr_b16 a[44:45], v236 offset:37888
    ds_read_b64_tr_b16 a[46:47], v236 offset:38400
    v_mfma_f32_16x16x32_bf16 a[160:163], a[176:179], a[168:171], a[160:163]
    ds_read_b64_tr_b16 a[248:249], v234 offset:28672
    ds_read_b64_tr_b16 a[250:251], v234 offset:61440
    ds_read_b64_tr_b16 a[252:253], v235 offset:28672
    ds_read_b64_tr_b16 a[254:255], v235 offset:61440
    ds_read_b64_tr_b16 a[80:81], v234 offset:29696
    ds_read_b64_tr_b16 a[82:83], v234 offset:62464
    ds_read_b64_tr_b16 a[84:85], v235 offset:29696
    ds_read_b64_tr_b16 a[86:87], v235 offset:62464
    ds_read_b64_tr_b16 a[88:89], v234 offset:30720
    ds_read_b64_tr_b16 a[90:91], v234 offset:63488
    ds_read_b64_tr_b16 a[92:93], v235 offset:30720
    ds_read_b64_tr_b16 a[94:95], v235 offset:63488
    v_mfma_f32_32x32x16_bf16 v[176:191], a[24:27], v[120:123], v[176:191]
    ds_read_b64_tr_b16 a[0:1], v237 offset:2048
    ds_read_b64_tr_b16 a[2:3], v237 offset:2560
    ds_read_b64_tr_b16 a[96:97], v234 offset:31744
    ds_read_b64_tr_b16 a[98:99], v234 offset:64512
    ds_read_b64_tr_b16 a[100:101], v235 offset:31744
    ds_read_b64_tr_b16 a[102:103], v235 offset:64512
    v_cvt_pk_bf16_f32 v160, v160, v161
    v_cvt_pk_bf16_f32 v161, v162, v163
    v_cvt_pk_bf16_f32 v162, v164, v165
    v_cvt_pk_bf16_f32 v163, v166, v167
    v_cvt_pk_bf16_f32 v164, v168, v169
    v_cvt_pk_bf16_f32 v165, v170, v171
    v_mfma_f32_32x32x16_bf16 v[176:191], a[28:31], v[124:127], v[176:191]
    ds_read_b64_tr_b16 a[4:5], v237 offset:34816
    ds_read_b64_tr_b16 a[6:7], v237 offset:35328
    v_mfma_f32_16x16x32_bf16 a[164:167], a[168:171], a[180:183], a[164:167]
    ds_read_b128 a[172:175], v247 offset:15360
    ds_read_b64_tr_b16 a[184:185], v246 offset:4096
    ds_read_b64_tr_b16 a[186:187], v246 offset:4608
    ds_read_b64_tr_b16 a[188:189], v246 offset:5120
    ds_read_b64_tr_b16 a[190:191], v246 offset:5632
    v_cvt_pk_bf16_f32 v166, v172, v173
    v_cvt_pk_bf16_f32 v167, v174, v175
    v_mfma_f32_32x32x16_bf16 v[192:207], v[112:115], a[32:35], v[192:207]
    ds_read_b64_tr_b16 a[8:9], v237 offset:5120
    ds_read_b64_tr_b16 a[10:11], v237 offset:5632
    v_cvt_pk_bf16_f32 v168, v176, v177
    v_cvt_pk_bf16_f32 v169, v178, v179
    v_cvt_pk_bf16_f32 v170, v180, v181
    v_cvt_pk_bf16_f32 v171, v182, v183
    v_cvt_pk_bf16_f32 v172, v184, v185
    v_cvt_pk_bf16_f32 v173, v186, v187
    s_waitcnt lgkmcnt(2)
    v_mfma_f32_16x16x32_bf16 a[160:163], a[184:187], a[172:175], a[160:163]
    v_cvt_pk_bf16_f32 v174, v188, v189
    v_cvt_pk_bf16_f32 v175, v190, v191
    ds_write_b128 v251, v[160:163] offset:6144
    v_mfma_f32_32x32x16_bf16 v[192:207], v[116:119], a[36:39], v[192:207]
    ds_read_b64_tr_b16 a[12:13], v237 offset:37888
    ds_read_b64_tr_b16 a[14:15], v237 offset:38400
    ds_write_b128 v251, v[164:167] offset:7168
    ds_write_b128 v251, v[168:171] offset:8192
    ds_write_b128 v251, v[172:175] offset:9216
    v_mfma_f32_32x32x16_bf16 v[192:207], v[120:123], a[40:43], v[192:207]
    ds_read_b64_tr_b16 a[16:17], v236 offset:0
    ds_read_b64_tr_b16 a[18:19], v236 offset:512
    v_mfma_f32_32x32x16_bf16 v[192:207], v[124:127], a[44:47], v[192:207]
    ds_read_b64_tr_b16 a[20:21], v236 offset:32768
    ds_read_b64_tr_b16 a[22:23], v236 offset:33280
    v_mfma_f32_32x32x16_bf16 v[208:223], v[112:115], a[0:3], v[208:223]
    ds_read_b64_tr_b16 a[24:25], v236 offset:3072
    ds_read_b64_tr_b16 a[26:27], v236 offset:3584
    v_mfma_f32_32x32x16_bf16 v[208:223], v[116:119], a[4:7], v[208:223]
    ds_read_b64_tr_b16 a[28:29], v236 offset:35840
    ds_read_b64_tr_b16 a[30:31], v236 offset:36352
    s_waitcnt lgkmcnt(6)
    v_mfma_f32_32x32x16_bf16 v[208:223], v[120:123], a[8:11], v[208:223]
    ds_read_b64_tr_b16 a[32:33], v237 offset:0
    ds_read_b64_tr_b16 a[34:35], v237 offset:512
    v_cvt_pk_bf16_f32 v192, v192, v193
    v_cvt_pk_bf16_f32 v193, v194, v195
    v_cvt_pk_bf16_f32 v194, v196, v197
    v_cvt_pk_bf16_f32 v195, v198, v199
    v_cvt_pk_bf16_f32 v196, v200, v201
    v_cvt_pk_bf16_f32 v197, v202, v203
    v_cvt_pk_bf16_f32 v198, v204, v205
    v_cvt_pk_bf16_f32 v199, v206, v207
    v_mfma_f32_32x32x16_bf16 v[208:223], v[124:127], a[12:15], v[208:223]
    ds_read_b64_tr_b16 a[36:37], v237 offset:32768
    ds_read_b64_tr_b16 a[38:39], v237 offset:33280
    v_mfma_f32_32x32x16_bf16 v[128:143], a[16:19], v[112:115], v[128:143]
    ds_read_b64_tr_b16 a[40:41], v237 offset:3072
    ds_read_b64_tr_b16 a[42:43], v237 offset:3584
    s_waitcnt vmcnt(11)
    v_readfirstlane_b32 s56, v248
    s_nop 2
    s_cmp_eq_u32 s56, 0
    s_cbranch_scc1 L_tagspin_5
L_tagok_4:
    v_cvt_pk_bf16_f32 v200, v208, v209
    v_cvt_pk_bf16_f32 v201, v210, v211
    s_waitcnt lgkmcnt(0)
    v_mfma_f32_32x32x16_bf16 v[128:143], a[20:23], v[116:119], v[128:143]
    ds_read_b64_tr_b16 a[44:45], v237 offset:35840
    ds_read_b64_tr_b16 a[46:47], v237 offset:36352
    v_cvt_pk_bf16_f32 v202, v212, v213
    v_cvt_pk_bf16_f32 v203, v214, v215
    v_cvt_pk_bf16_f32 v204, v216, v217
    v_cvt_pk_bf16_f32 v205, v218, v219
    v_cvt_pk_bf16_f32 v206, v220, v221
    v_cvt_pk_bf16_f32 v207, v222, v223
    s_waitcnt vmcnt(9)
    s_barrier
    v_mfma_f32_32x32x16_bf16 v[128:143], a[24:27], v[120:123], v[128:143]
    ds_read_b64_tr_b16 a[0:1], v232 offset:6144
    ds_read_b64_tr_b16 a[2:3], v232 offset:6400
    s_add_u32 m0, s50, 0x4800
    s_add_u32 s55, s54, 0xdc00
    buffer_load_dwordx4 v238, s[44:47], s54 offen lds
    v_mfma_f32_32x32x16_bf16 v[128:143], a[28:31], v[124:127], v[128:143]
    ds_read_b64_tr_b16 a[4:5], v233 offset:6144
    ds_read_b64_tr_b16 a[6:7], v233 offset:6400
    buffer_load_dwordx4 v238, s[44:47], s55 offen offset:1024 lds
    v_mfma_f32_16x16x32_bf16 a[164:167], a[172:175], a[188:191], a[164:167]
    v_mfma_f32_32x32x16_bf16 v[144:159], a[32:35], v[112:115], v[144:159]
    ds_read_b64_tr_b16 a[8:9], v232 offset:7168
    ds_read_b64_tr_b16 a[10:11], v232 offset:7424
    s_add_u32 s54, s54, 0x38000
    s_add_u32 m0, s50, 0x5000
    s_add_u32 s55, s54, 0xdc00
    buffer_load_dwordx4 v238, s[44:47], s54 offen lds
    v_mfma_f32_32x32x16_bf16 v[144:159], a[36:39], v[116:119], v[144:159]
    ds_read_b64_tr_b16 a[12:13], v233 offset:7168
    ds_read_b64_tr_b16 a[14:15], v233 offset:7424
    buffer_load_dwordx4 v238, s[44:47], s55 offen offset:1024 lds
    v_mfma_f32_32x32x16_bf16 v[144:159], a[40:43], v[120:123], v[144:159]
    ds_read_b64_tr_b16 a[16:17], v232 offset:38912
    ds_read_b64_tr_b16 a[18:19], v232 offset:39168
    s_add_u32 m0, s50, 0x6c00
    s_add_u32 s49, s0, 0x5c000
    buffer_load_dwordx4 v241, s[20:23], s49 offen lds
    s_waitcnt lgkmcnt(4)
    v_mfma_f32_32x32x16_bf16 v[144:159], a[44:47], v[124:127], v[144:159]
    ds_read_b64_tr_b16 a[20:21], v233 offset:38912
    ds_read_b64_tr_b16 a[22:23], v233 offset:39168
    ds_write_b128 v251, v[196:199] offset:10240
    ds_write_b128 v251, v[204:207] offset:11264
    v_accvgpr_read_b32 v224, a160
    v_accvgpr_read_b32 v225, a161
    v_mfma_f32_32x32x16_bf16 a[48:63], a[0:3], v[0:3], 0
    ds_read_b64_tr_b16 a[24:25], v232 offset:39936
    ds_read_b64_tr_b16 a[26:27], v232 offset:40192
    s_add_u32 m0, s50, 0x7000
    s_add_u32 s49, s1, 0x40000
    buffer_load_dwordx4 v241, s[20:23], s49 offen lds
    v_accvgpr_read_b32 v226, a162
    v_mfma_f32_32x32x16_bf16 a[64:79], a[4:7], v[0:3], 0
    ds_read_b64_tr_b16 a[28:29], v233 offset:39936
    ds_read_b64_tr_b16 a[30:31], v233 offset:40192
    v_accvgpr_read_b32 v227, a163
    v_accvgpr_read_b32 v228, a164
    v_accvgpr_read_b32 v229, a165
    v_accvgpr_read_b32 v230, a166
    v_accvgpr_read_b32 v231, a167
    v_cvt_pk_bf16_f32 v224, v224, v225
    v_mfma_f32_32x32x16_bf16 a[48:63], a[8:11], v[4:7], a[48:63]
    ds_read_b64_tr_b16 a[32:33], v232 offset:8192
    ds_read_b64_tr_b16 a[34:35], v232 offset:8448
    s_add_u32 m0, s50, 0x7400
    s_add_u32 s49, s1, 0x44000
    buffer_load_dwordx4 v241, s[20:23], s49 offen lds
    s_waitcnt lgkmcnt(2)
    v_mfma_f32_32x32x16_bf16 a[64:79], a[12:15], v[4:7], a[64:79]
    ds_read_b64_tr_b16 a[36:37], v233 offset:8192
    ds_read_b64_tr_b16 a[38:39], v233 offset:8448
    v_cvt_pk_bf16_f32 v225, v226, v227
    v_cvt_pk_bf16_f32 v228, v228, v229
    v_cvt_pk_bf16_f32 v229, v230, v231
    s_lshl_b32 s51, s3, 10
    s_add_u32 s51, s51, 0x100
    v_add_u32 v226, s51, v252
    v_mfma_f32_32x32x16_bf16 a[48:63], a[16:19], v[8:11], a[48:63]
    ds_read_b64_tr_b16 a[40:41], v232 offset:9216
    ds_read_b64_tr_b16 a[42:43], v232 offset:9472
    s_add_u32 m0, s50, 0x7800
    s_add_u32 s49, s1, 0x48000
    buffer_load_dwordx4 v241, s[20:23], s49 offen lds
    s_lshr_b32 s51, s3, 1
    v_mfma_f32_32x32x16_bf16 a[64:79], a[20:23], v[8:11], a[64:79]
    ds_read_b64_tr_b16 a[44:45], v233 offset:9216
    ds_read_b64_tr_b16 a[46:47], v233 offset:9472
    s_lshl_b32 s51, s51, 10
    s_and_b32 s52, s3, 1
    s_lshl_b32 s52, s52, 8
    s_add_u32 s51, s51, s52
    v_add_u32 v227, s51, v252
    ds_write_b64 v226, v[224:225] offset:0
    v_mfma_f32_32x32x16_bf16 a[48:63], a[24:27], v[12:15], a[48:63]
    ds_read_b64_tr_b16 a[0:1], v232 offset:40960
    ds_read_b64_tr_b16 a[2:3], v232 offset:41216
    s_add_u32 m0, s50, 0x7c00
    s_add_u32 s49, s1, 0x4c000
    buffer_load_dwordx4 v241, s[20:23], s49 offen lds
    v_mfma_f32_32x32x16_bf16 a[64:79], a[28:31], v[12:15], a[64:79]
    ds_read_b64_tr_b16 a[4:5], v233 offset:40960
    ds_read_b64_tr_b16 a[6:7], v233 offset:41216
    ds_write_b64 v227, v[228:229] offset:4096
    v_cvt_pk_bf16_f32 v128, v128, v129
    v_cvt_pk_bf16_f32 v129, v130, v131
    v_cvt_pk_bf16_f32 v130, v132, v133
    s_waitcnt lgkmcnt(3)
    v_mfma_f32_32x32x16_bf16 a[48:63], a[32:35], v[16:19], a[48:63]
    ds_read_b64_tr_b16 a[8:9], v232 offset:41984
    ds_read_b64_tr_b16 a[10:11], v232 offset:42240
    v_cvt_pk_bf16_f32 v131, v134, v135
    v_cvt_pk_bf16_f32 v132, v136, v137
    v_cvt_pk_bf16_f32 v133, v138, v139
    v_cvt_pk_bf16_f32 v134, v140, v141
    v_cvt_pk_bf16_f32 v135, v142, v143
    v_mfma_f32_32x32x16_bf16 a[64:79], a[36:39], v[16:19], a[64:79]
    ds_read_b64_tr_b16 a[12:13], v233 offset:41984
    ds_read_b64_tr_b16 a[14:15], v233 offset:42240
    v_cvt_pk_bf16_f32 v136, v144, v145
    v_cvt_pk_bf16_f32 v137, v146, v147
    v_cvt_pk_bf16_f32 v138, v148, v149
    v_cvt_pk_bf16_f32 v139, v150, v151
    v_cvt_pk_bf16_f32 v140, v152, v153
    v_cvt_pk_bf16_f32 v141, v154, v155
    v_mfma_f32_32x32x16_bf16 a[48:63], a[40:43], v[20:23], a[48:63]
    ds_read_b64_tr_b16 a[16:17], v232 offset:10240
    ds_read_b64_tr_b16 a[18:19], v232 offset:10496
    v_cvt_pk_bf16_f32 v142, v156, v157
    v_cvt_pk_bf16_f32 v143, v158, v159
    v_accvgpr_read_b32 v244, a196
    v_accvgpr_read_b32 v245, a197
    s_mov_b32 s63, 0xf149f2ca
    v_mfma_f32_32x32x16_bf16 a[64:79], a[44:47], v[20:23], a[64:79]
    ds_read_b64_tr_b16 a[20:21], v233 offset:10240
    ds_read_b64_tr_b16 a[22:23], v233 offset:10496
    v_bfe_i32 v208, v245, 0, 1
    v_and_b32 v208, s63, v208
    v_bfe_i32 v209, v245, 1, 1
    v_and_b32 v209, s63, v209
    s_waitcnt lgkmcnt(2)
    s_barrier
    v_mfma_f32_32x32x16_bf16 a[48:63], a[0:3], v[24:27], a[48:63]
    ds_read_b64_tr_b16 a[24:25], v232 offset:11264
    ds_read_b64_tr_b16 a[26:27], v232 offset:11520
    v_bfe_i32 v210, v245, 2, 1
    v_and_b32 v210, s63, v210
    v_bfe_i32 v211, v245, 3, 1
    v_and_b32 v211, s63, v211
    v_bfe_i32 v212, v245, 8, 1
    v_mfma_f32_32x32x16_bf16 a[64:79], a[4:7], v[24:27], a[64:79]
    ds_read_b64_tr_b16 a[28:29], v233 offset:11264
    ds_read_b64_tr_b16 a[30:31], v233 offset:11520
    v_and_b32 v212, s63, v212
    v_bfe_i32 v213, v245, 9, 1
    v_and_b32 v213, s63, v213
    v_bfe_i32 v214, v245, 10, 1
    v_and_b32 v214, s63, v214
    v_bfe_i32 v215, v245, 11, 1
    v_mfma_f32_32x32x16_bf16 a[48:63], a[8:11], v[28:31], a[48:63]
    ds_read_b64_tr_b16 a[32:33], v232 offset:43008
    ds_read_b64_tr_b16 a[34:35], v232 offset:43264
    v_and_b32 v215, s63, v215
    v_bfe_i32 v216, v245, 16, 1
    v_and_b32 v216, s63, v216
    v_bfe_i32 v217, v245, 17, 1
    v_and_b32 v217, s63, v217
    v_mfma_f32_32x32x16_bf16 a[64:79], a[12:15], v[28:31], a[64:79]
    ds_read_b64_tr_b16 a[36:37], v233 offset:43008
    ds_read_b64_tr_b16 a[38:39], v233 offset:43264
    v_bfe_i32 v218, v245, 18, 1
    v_and_b32 v218, s63, v218
    v_bfe_i32 v219, v245, 19, 1
    v_and_b32 v219, s63, v219
    v_bfe_i32 v220, v245, 24, 1
    v_and_b32 v220, s63, v220
    v_mfma_f32_32x32x16_bf16 a[48:63], a[16:19], v[32:35], a[48:63]
    ds_read_b64_tr_b16 a[40:41], v232 offset:44032
    ds_read_b64_tr_b16 a[42:43], v232 offset:44288
    v_bfe_i32 v221, v245, 25, 1
    v_and_b32 v221, s63, v221
    v_bfe_i32 v222, v245, 26, 1
    v_and_b32 v222, s63, v222
    s_waitcnt lgkmcnt(2)
    v_mfma_f32_32x32x16_bf16 a[64:79], a[20:23], v[32:35], a[64:79]
    ds_read_b64_tr_b16 a[44:45], v233 offset:44032
    ds_read_b64_tr_b16 a[46:47], v233 offset:44288
    v_bfe_i32 v223, v245, 27, 1
    v_and_b32 v223, s63, v223
    v_bfe_i32 v224, v244, 16, 1
    v_and_b32 v224, s63, v224
    v_bfe_i32 v225, v244, 17, 1
    v_and_b32 v225, s63, v225
    v_mfma_f32_32x32x16_bf16 a[48:63], a[24:27], v[36:39], a[48:63]
    ds_read_b64_tr_b16 a[0:1], v232 offset:12288
    ds_read_b64_tr_b16 a[2:3], v232 offset:12544
    v_bfe_i32 v226, v244, 18, 1
    v_and_b32 v226, s63, v226
    v_bfe_i32 v227, v244, 19, 1
    v_and_b32 v227, s63, v227
    v_bfe_i32 v228, v244, 24, 1
    v_mfma_f32_32x32x16_bf16 a[64:79], a[28:31], v[36:39], a[64:79]
    ds_read_b64_tr_b16 a[4:5], v233 offset:12288
    ds_read_b64_tr_b16 a[6:7], v233 offset:12544
    v_and_b32 v228, s63, v228
    v_bfe_i32 v229, v244, 25, 1
    v_and_b32 v229, s63, v229
    v_bfe_i32 v230, v244, 26, 1
    v_and_b32 v230, s63, v230
    v_bfe_i32 v231, v244, 27, 1
    v_mfma_f32_32x32x16_bf16 a[48:63], a[32:35], v[40:43], a[48:63]
    ds_read_b64_tr_b16 a[8:9], v232 offset:13312
    ds_read_b64_tr_b16 a[10:11], v232 offset:13568
    v_and_b32 v231, s63, v231
    v_mfma_f32_32x32x16_bf16 v[176:191], v[160:163], v[128:131], v[208:223]
    ds_read_b128 a[136:139], v251 offset:0
    ds_read_b128 a[140:143], v251 offset:1024
    ds_read_b128 a[144:147], v251 offset:2048
    ds_read_b128 a[148:151], v251 offset:3072
    ds_read_b128 a[152:155], v251 offset:4096
    ds_read_b128 a[156:159], v251 offset:5120
    v_mfma_f32_32x32x16_bf16 a[64:79], a[36:39], v[40:43], a[64:79]
    ds_read_b64_tr_b16 a[12:13], v233 offset:13312
    ds_read_b64_tr_b16 a[14:15], v233 offset:13568
    v_accvgpr_read_b32 v42, a194
    v_accvgpr_read_b32 v43, a195
    s_waitcnt lgkmcnt(6)
    v_mfma_f32_32x32x16_bf16 a[48:63], a[40:43], v[44:47], a[48:63]
    ds_read_b64_tr_b16 a[16:17], v232 offset:45056
    ds_read_b64_tr_b16 a[18:19], v232 offset:45312
    v_mfma_f32_32x32x16_bf16 v[0:15], a[136:139], v[128:131], v[216:231]
    v_max_f32 v16, v176, v177
    v_max_f32 v17, v178, v179
    v_max_f32 v18, v180, v181
    v_max_f32 v19, v182, v183
    v_mfma_f32_32x32x16_bf16 a[64:79], a[44:47], v[44:47], a[64:79]
    ds_read_b64_tr_b16 a[20:21], v233 offset:45056
    ds_read_b64_tr_b16 a[22:23], v233 offset:45312
    v_add_u32 v46, s50, v243
    v_mfma_f32_32x32x16_bf16 a[48:63], a[0:3], v[48:51], a[48:63]
    ds_read_b64_tr_b16 a[24:25], v232 offset:46080
    ds_read_b64_tr_b16 a[26:27], v232 offset:46336
    v_mfma_f32_32x32x16_bf16 a[64:79], a[4:7], v[48:51], a[64:79]
    ds_read_b64_tr_b16 a[28:29], v233 offset:46080
    ds_read_b64_tr_b16 a[30:31], v233 offset:46336
    v_max3_f32 v20, v184, v185, v8
    v_max3_f32 v21, v186, v187, v10
    v_max3_f32 v22, v188, v189, v12
    v_max3_f32 v23, v190, v191, v14
    s_waitcnt vmcnt(5)
    s_barrier
    v_mfma_f32_32x32x16_bf16 a[48:63], a[8:11], v[52:55], a[48:63]
    ds_read_b64_tr_b16 a[32:33], v232 offset:14336
    ds_read_b64_tr_b16 a[34:35], v232 offset:14592
    s_add_u32 m0, s50, 0
    s_add_u32 s49, s1, 0x50000
    buffer_load_dwordx4 v241, s[20:23], s49 offen lds
    s_waitcnt lgkmcnt(2)
    v_mfma_f32_32x32x16_bf16 a[64:79], a[12:15], v[52:55], a[64:79]
    ds_read_b64_tr_b16 a[36:37], v233 offset:14336
    ds_read_b64_tr_b16 a[38:39], v233 offset:14592
    s_add_u32 m0, s50, 0x400
    s_add_u32 s49, s1, 0x54000
    buffer_load_dwordx4 v241, s[20:23], s49 offen lds
    v_mfma_f32_32x32x16_bf16 v[176:191], v[164:167], v[132:135], v[208:223]
    v_max_f32 v20, v20, v9
    v_max_f32 v21, v21, v11
    v_max_f32 v22, v22, v13
    v_max_f32 v23, v23, v15
    v_max3_f32 v244, v16, v17, v18
    v_max3_f32 v245, v19, v20, v21
    v_mfma_f32_32x32x16_bf16 v[0:15], a[140:143], v[132:135], v[216:231]
    v_max3_f32 v244, v244, v22, v23
    v_max_f32 v244, v244, v245
    v_mov_b32 v245, v244
    v_mfma_f32_32x32x16_bf16 a[48:63], a[16:19], v[56:59], a[48:63]
    ds_read_b64_tr_b16 a[40:41], v232 offset:15360
    ds_read_b64_tr_b16 a[42:43], v232 offset:15616
    s_add_u32 m0, s50, 0x800
L_padA_4:
    s_cbranch_execz L_backA
    s_add_u32 s49, s1, 0x58000
    buffer_load_dwordx4 v241, s[20:23], s49 offen lds
    v_permlane32_swap_b32 v244, v245
    v_max_f32 v244, v244, v245
    v_mfma_f32_32x32x16_bf16 a[64:79], a[20:23], v[56:59], a[64:79]
    ds_read_b64_tr_b16 a[44:45], v233 offset:15360
    ds_read_b64_tr_b16 a[46:47], v233 offset:15616
    s_add_u32 m0, s50, 0xc00
    s_add_u32 s49, s1, 0x5c000
    buffer_load_dwordx4 v241, s[20:23], s49 offen lds
    v_mul_f32 v246, -v244, s71
    v_mfma_f32_32x32x16_bf16 a[48:63], a[24:27], v[60:63], a[48:63]
    ds_read_b64_tr_b16 a[0:1], v232 offset:47104
    ds_read_b64_tr_b16 a[2:3], v232 offset:47360
    s_add_u32 m0, s50, 0x1000
    s_add_u32 s49, s5, 0x40000
    buffer_load_dwordx4 v241, s[20:23], s49 offen lds
    v_fma_f32 v16, v16, s71, v246
    v_fma_f32 v17, v17, s71, v246
    v_mfma_f32_32x32x16_bf16 a[64:79], a[28:31], v[60:63], a[64:79]
    ds_read_b64_tr_b16 a[4:5], v233 offset:47104
    ds_read_b64_tr_b16 a[6:7], v233 offset:47360
    s_add_u32 m0, s50, 0x1400
    s_add_u32 s49, s5, 0x44000
    buffer_load_dwordx4 v241, s[20:23], s49 offen lds
    s_waitcnt lgkmcnt(2)
    v_mfma_f32_32x32x16_bf16 a[48:63], a[32:35], v[64:67], a[48:63]
    ds_read_b64_tr_b16 a[8:9], v232 offset:48128
    ds_read_b64_tr_b16 a[10:11], v232 offset:48384
    v_fma_f32 v18, v18, s71, v246
    v_fma_f32 v19, v19, s71, v246
    v_fma_f32 v20, v20, s71, v246
    v_fma_f32 v21, v21, s71, v246
    v_fma_f32 v22, v22, s71, v246
    v_fma_f32 v23, v23, s71, v246
    v_mfma_f32_32x32x16_bf16 a[64:79], a[36:39], v[64:67], a[64:79]
    ds_read_b64_tr_b16 a[12:13], v233 offset:48128
    ds_read_b64_tr_b16 a[14:15], v233 offset:48384
    s_add_u32 m0, s50, 0x1800
    s_add_u32 s49, s5, 0x48000
    buffer_load_dwordx4 v241, s[20:23], s49 offen lds
    v_exp_f32 v16, v16
    v_mfma_f32_32x32x16_bf16 a[48:63], a[40:43], v[68:71], a[48:63]
    ds_read_b64_tr_b16 a[16:17], v232 offset:16384
    ds_read_b64_tr_b16 a[18:19], v232 offset:16640
    v_exp_f32 v17, v17
    v_exp_f32 v18, v18
    v_exp_f32 v19, v19
    v_mfma_f32_32x32x16_bf16 a[64:79], a[44:47], v[68:71], a[64:79]
    ds_read_b64_tr_b16 a[20:21], v233 offset:16384
    ds_read_b64_tr_b16 a[22:23], v233 offset:16640
    s_add_u32 m0, s50, 0x1c00
    s_add_u32 s49, s5, 0x4c000
    buffer_load_dwordx4 v241, s[20:23], s49 offen lds
    v_mfma_f32_32x32x16_bf16 a[48:63], a[0:3], v[72:75], a[48:63]
    ds_read_b64_tr_b16 a[24:25], v232 offset:17408
    ds_read_b64_tr_b16 a[26:27], v232 offset:17664
    v_exp_f32 v20, v20
    v_exp_f32 v21, v21
    v_exp_f32 v22, v22
    s_waitcnt lgkmcnt(2)
    v_mfma_f32_32x32x16_bf16 a[64:79], a[4:7], v[72:75], a[64:79]
    ds_read_b64_tr_b16 a[28:29], v233 offset:17408
    ds_read_b64_tr_b16 a[30:31], v233 offset:17664
    s_add_u32 m0, s50, 0x2000
    s_add_u32 s49, s5, 0x50000
    buffer_load_dwordx4 v241, s[20:23], s49 offen lds
    v_mfma_f32_32x32x16_bf16 a[48:63], a[8:11], v[76:79], a[48:63]
    ds_read_b64_tr_b16 a[32:33], v232 offset:49152
    ds_read_b64_tr_b16 a[34:35], v232 offset:49408
    v_exp_f32 v23, v23
    v_cvt_pk_bf16_f32 v24, v16, v16
    v_and_b32 v24, v253, v24
    v_cvt_pk_bf16_f32 v25, v17, v17
    v_and_b32 v25, v253, v25
    v_mfma_f32_32x32x16_bf16 a[64:79], a[12:15], v[76:79], a[64:79]
    ds_read_b64_tr_b16 a[36:37], v233 offset:49152
    ds_read_b64_tr_b16 a[38:39], v233 offset:49408
    s_add_u32 m0, s50, 0x2400
    s_add_u32 s49, s5, 0x54000
    buffer_load_dwordx4 v241, s[20:23], s49 offen lds
    v_cvt_pk_bf16_f32 v26, v18, v18
    v_mfma_f32_32x32x16_bf16 a[48:63], a[16:19], v[80:83], a[48:63]
    ds_read_b64_tr_b16 a[40:41], v232 offset:50176
    ds_read_b64_tr_b16 a[42:43], v232 offset:50432
    v_and_b32 v26, v253, v26
    v_cvt_pk_bf16_f32 v27, v19, v19
    v_and_b32 v27, v253, v27
    v_add_f32 v247, v16, v17
    v_add_f32 v245, v18, v19
    v_mfma_f32_32x32x16_bf16 v[144:159], v[192:195], v[24:27], 0
    v_cvt_pk_bf16_f32 v32, v20, v20
    v_and_b32 v28, v254, v32
    v_cvt_pk_bf16_f32 v33, v21, v21
    s_add_u32 m0, s50, 0x2800
    s_add_u32 s49, s5, 0x58000
    buffer_load_dwordx4 v241, s[20:23], s49 offen lds
    v_and_b32 v29, v254, v33
    v_mfma_f32_32x32x16_bf16 a[64:79], a[20:23], v[80:83], a[64:79]
    ds_read_b64_tr_b16 a[44:45], v233 offset:50176
    ds_read_b64_tr_b16 a[46:47], v233 offset:50432
    v_cvt_pk_bf16_f32 v34, v22, v22
    v_and_b32 v30, v254, v34
    v_cvt_pk_bf16_f32 v35, v23, v23
    v_and_b32 v31, v254, v35
    v_add_f32 v236, v20, v21
    s_waitcnt lgkmcnt(2)
    v_mfma_f32_32x32x16_bf16 a[48:63], a[24:27], v[84:87], a[48:63]
    ds_read_b64_tr_b16 a[0:1], v232 offset:18432
    ds_read_b64_tr_b16 a[2:3], v232 offset:18688
    s_add_u32 m0, s50, 0x2c00
    s_add_u32 s49, s5, 0x5c000
    buffer_load_dwordx4 v241, s[20:23], s49 offen lds
    v_add_f32 v247, v247, v245
    v_mfma_f32_32x32x16_bf16 a[64:79], a[28:31], v[84:87], a[64:79]
    ds_read_b64_tr_b16 a[4:5], v232 offset:19456
    ds_read_b64_tr_b16 a[6:7], v232 offset:19712
    v_mfma_f32_32x32x16_bf16 v[144:159], v[196:199], v[28:31], v[144:159]
    v_and_b32 v32, v255, v32
    v_and_b32 v33, v255, v33
    v_and_b32 v34, v255, v34
    v_and_b32 v35, v255, v35
    v_add_f32 v245, v22, v23
    v_add_f32 v236, v236, v245
    v_mfma_f32_32x32x16_bf16 v[144:159], a[152:155], v[32:35], v[144:159]
    v_add_f32 v247, v247, v236
    v_mov_b32 v245, v247
    v_mfma_f32_32x32x16_bf16 a[48:63], a[32:35], v[88:91], a[48:63]
    ds_read_b64_tr_b16 a[8:9], v232 offset:51200
    ds_read_b64_tr_b16 a[10:11], v232 offset:51456
    v_permlane32_swap_b32 v247, v245
    v_add_f32 v247, v247, v245
    v_max_f32 v16, v176, v177
    v_max_f32 v17, v178, v179
    v_max_f32 v18, v180, v181
    v_max_f32 v19, v182, v183
    v_mfma_f32_32x32x16_bf16 a[64:79], a[36:39], v[88:91], a[64:79]
    ds_read_b64_tr_b16 a[12:13], v232 offset:52224
    ds_read_b64_tr_b16 a[14:15], v232 offset:52480
    v_max3_f32 v20, v184, v185, v8
    v_max3_f32 v21, v186, v187, v10
    v_max3_f32 v22, v188, v189, v12
    v_max3_f32 v23, v190, v191, v14
    v_mfma_f32_32x32x16_bf16 v[176:191], v[168:171], v[136:139], v[208:223]
    v_max_f32 v20, v20, v9
    v_max_f32 v21, v21, v11
    v_max_f32 v22, v22, v13
    v_max_f32 v23, v23, v15
    v_max3_f32 v244, v16, v17, v18
    v_max3_f32 v245, v19, v20, v21
    v_mfma_f32_32x32x16_bf16 v[0:15], a[144:147], v[136:139], v[216:231]
    v_max3_f32 v244, v244, v22, v23
    v_max_f32 v244, v244, v245
    v_mov_b32 v245, v244
    v_rcp_f32 v247, v247
    v_mfma_f32_32x32x16_bf16 a[48:63], a[40:43], v[92:95], a[48:63]
    ds_read_b64_tr_b16 a[16:17], v232 offset:20480
    ds_read_b64_tr_b16 a[18:19], v232 offset:20736
    v_mul_f32 v144, v144, v247
    v_mul_f32 v145, v145, v247
    v_permlane32_swap_b32 v244, v245
    v_max_f32 v244, v244, v245
    v_mul_f32 v246, -v244, s71
    s_waitcnt lgkmcnt(2)
    v_mfma_f32_32x32x16_bf16 a[64:79], a[44:47], v[92:95], a[64:79]
    ds_read_b64_tr_b16 a[20:21], v232 offset:21504
    ds_read_b64_tr_b16 a[22:23], v232 offset:21760
    v_mul_f32 v146, v146, v247
    v_mul_f32 v147, v147, v247
    v_mul_f32 v148, v148, v247
    v_mul_f32 v149, v149, v247
    v_mul_f32 v150, v150, v247
    v_mfma_f32_32x32x16_bf16 a[48:63], a[0:3], v[96:99], a[48:63]
    ds_read_b64_tr_b16 a[24:25], v232 offset:53248
    ds_read_b64_tr_b16 a[26:27], v232 offset:53504
    v_mul_f32 v151, v151, v247
    v_cvt_pk_bf16_f32 v144, v144, v145
    v_cvt_pk_bf16_f32 v145, v146, v147
    v_cvt_pk_bf16_f32 v146, v148, v149
    v_cvt_pk_bf16_f32 v147, v150, v151
    buffer_store_dwordx4 v[144:147], v242, s[40:43], s59 offen sc1
    v_mfma_f32_32x32x16_bf16 a[48:63], a[4:7], v[100:103], a[48:63]
    ds_read_b64_tr_b16 a[28:29], v232 offset:54272
    ds_read_b64_tr_b16 a[30:31], v232 offset:54528
    v_fma_f32 v16, v16, s71, v246
    v_fma_f32 v17, v17, s71, v246
    v_fma_f32 v18, v18, s71, v246
    v_fma_f32 v19, v19, s71, v246
    v_mfma_f32_32x32x16_bf16 a[48:63], a[8:11], v[104:107], a[48:63]
    ds_read_b64_tr_b16 a[32:33], v233 offset:18432
    ds_read_b64_tr_b16 a[34:35], v233 offset:18688
    v_fma_f32 v20, v20, s71, v246
    v_fma_f32 v21, v21, s71, v246
    v_fma_f32 v22, v22, s71, v246
    v_fma_f32 v23, v23, s71, v246
    v_exp_f32 v16, v16
    v_mfma_f32_32x32x16_bf16 a[48:63], a[12:15], v[108:111], a[48:63]
    ds_read_b64_tr_b16 a[36:37], v233 offset:19456
    ds_read_b64_tr_b16 a[38:39], v233 offset:19712
    v_exp_f32 v17, v17
    v_exp_f32 v18, v18
    s_waitcnt lgkmcnt(2)
    v_mfma_f32_32x32x16_bf16 a[48:63], a[16:19], v[112:115], a[48:63]
    ds_read_b64_tr_b16 a[40:41], v233 offset:51200
    ds_read_b64_tr_b16 a[42:43], v233 offset:51456
    v_exp_f32 v19, v19
    v_exp_f32 v20, v20
    v_exp_f32 v21, v21
    v_mfma_f32_32x32x16_bf16 a[48:63], a[20:23], v[116:119], a[48:63]
    ds_read_b64_tr_b16 a[44:45], v233 offset:52224
    ds_read_b64_tr_b16 a[46:47], v233 offset:52480
    v_exp_f32 v22, v22
    v_exp_f32 v23, v23
    v_cvt_pk_bf16_f32 v24, v16, v16
    v_mfma_f32_32x32x16_bf16 a[48:63], a[24:27], v[120:123], a[48:63]
    ds_read_b64_tr_b16 a[0:1], v233 offset:20480
    ds_read_b64_tr_b16 a[2:3], v233 offset:20736
    v_and_b32 v24, v253, v24
    v_cvt_pk_bf16_f32 v25, v17, v17
    v_and_b32 v25, v253, v25
    v_cvt_pk_bf16_f32 v26, v18, v18
    v_and_b32 v26, v253, v26
    v_cvt_pk_bf16_f32 v27, v19, v19
    v_mfma_f32_32x32x16_bf16 a[48:63], a[28:31], v[124:127], a[48:63]
    ds_read_b64_tr_b16 a[4:5], v233 offset:21504
    ds_read_b64_tr_b16 a[6:7], v233 offset:21760
    v_and_b32 v27, v253, v27
    v_add_f32 v240, v16, v17
    v_add_f32 v245, v18, v19
    v_mfma_f32_32x32x16_bf16 v[144:159], v[192:195], v[24:27], 0
    v_cvt_pk_bf16_f32 v32, v20, v20
    v_and_b32 v28, v254, v32
    v_cvt_pk_bf16_f32 v33, v21, v21
    v_and_b32 v29, v254, v33
    v_cvt_pk_bf16_f32 v34, v22, v22
    v_and_b32 v30, v254, v34
    v_accvgpr_read_b32 v48, a48
    v_accvgpr_read_b32 v49, a49
    v_accvgpr_read_b32 v50, a50
    v_accvgpr_read_b32 v51, a51
    v_mfma_f32_32x32x16_bf16 a[64:79], a[32:35], v[96:99], a[64:79]
    ds_read_b64_tr_b16 a[8:9], v233 offset:53248
    ds_read_b64_tr_b16 a[10:11], v233 offset:53504
    v_accvgpr_read_b32 v52, a52
    v_accvgpr_read_b32 v53, a53
    v_accvgpr_read_b32 v54, a54
    v_accvgpr_read_b32 v55, a55
    s_waitcnt lgkmcnt(2)
    v_mfma_f32_32x32x16_bf16 a[64:79], a[36:39], v[100:103], a[64:79]
    ds_read_b64_tr_b16 a[12:13], v233 offset:54272
    ds_read_b64_tr_b16 a[14:15], v233 offset:54528
    v_accvgpr_read_b32 v56, a56
    v_accvgpr_read_b32 v57, a57
    v_accvgpr_read_b32 v58, a58
    v_accvgpr_read_b32 v59, a59
    s_barrier
    v_mfma_f32_32x32x16_bf16 a[64:79], a[40:43], v[104:107], a[64:79]
    v_accvgpr_read_b32 v60, a60
    v_accvgpr_read_b32 v61, a61
    v_accvgpr_read_b32 v62, a62
    v_accvgpr_read_b32 v63, a63
    v_mul_f32 v48, v48, v56
    v_mul_f32 v49, v49, v57
    v_mul_f32 v50, v50, v58
    v_mul_f32 v51, v51, v59
    v_mfma_f32_32x32x16_bf16 a[64:79], a[44:47], v[108:111], a[64:79]
    v_mul_f32 v52, v52, v60
    v_mul_f32 v53, v53, v61
    v_mul_f32 v54, v54, v62
    v_mul_f32 v55, v55, v63
    v_cvt_pk_bf16_f32 v48, v48, v49
    v_cvt_pk_bf16_f32 v49, v50, v51
    v_cvt_pk_bf16_f32 v50, v52, v53
    v_mfma_f32_32x32x16_bf16 a[64:79], a[0:3], v[112:115], a[64:79]
    v_cvt_pk_bf16_f32 v51, v54, v55
    buffer_store_dwordx4 v[48:51], v242, s[40:43], s61 offen sc1
    s_add_u32 m0, s73, 0
    s_add_u32 s49, s82, 0
    buffer_load_dwordx4 v241, s[20:23], s49 offen lds
    v_cvt_pk_bf16_f32 v35, v23, v23
    v_mfma_f32_32x32x16_bf16 a[64:79], a[4:7], v[116:119], a[64:79]
    s_add_u32 m0, s73, 0x1000
    s_add_u32 s49, s82, 0x4000
    buffer_load_dwordx4 v241, s[20:23], s49 offen lds
    v_and_b32 v31, v254, v35
    v_add_f32 v236, v20, v21
    s_waitcnt lgkmcnt(0)
    v_mfma_f32_32x32x16_bf16 a[64:79], a[8:11], v[120:123], a[64:79]
    s_add_u32 m0, s73, 0x2000
    s_add_u32 s49, s82, 0x8000
    buffer_load_dwordx4 v241, s[20:23], s49 offen lds
    v_add_f32 v240, v240, v245
    v_mfma_f32_32x32x16_bf16 v[144:159], v[196:199], v[28:31], v[144:159]
    v_and_b32 v32, v255, v32
    v_and_b32 v33, v255, v33
    v_and_b32 v34, v255, v34
    v_and_b32 v35, v255, v35
    v_add_f32 v245, v22, v23
    v_add_f32 v236, v236, v245
    v_mfma_f32_32x32x16_bf16 v[144:159], a[152:155], v[32:35], v[144:159]
    v_add_f32 v240, v240, v236
    v_mov_b32 v245, v240
    v_mfma_f32_32x32x16_bf16 a[64:79], a[12:15], v[124:127], a[64:79]
    s_nop 11
    v_accvgpr_read_b32 v48, a64
    v_accvgpr_read_b32 v49, a65
    v_accvgpr_read_b32 v50, a66
    v_accvgpr_read_b32 v51, a67
    s_add_u32 m0, s73, 0x3000
    s_add_u32 s49, s82, 0xc000
    buffer_load_dwordx4 v241, s[20:23], s49 offen lds
    v_accvgpr_read_b32 v52, a68
    v_accvgpr_read_b32 v53, a69
    v_accvgpr_read_b32 v54, a70
    v_accvgpr_read_b32 v55, a71
    v_accvgpr_read_b32 v56, a72
    v_accvgpr_read_b32 v57, a73
    v_accvgpr_read_b32 v58, a74
    v_accvgpr_read_b32 v59, a75
    v_accvgpr_read_b32 v60, a76
    v_accvgpr_read_b32 v61, a77
    v_accvgpr_read_b32 v62, a78
    v_accvgpr_read_b32 v63, a79
    v_mul_f32 v48, v48, v56
    v_mul_f32 v49, v49, v57
    v_mul_f32 v50, v50, v58
    v_mul_f32 v51, v51, v59
    s_add_u32 m0, s73, 0x4000
    s_add_u32 s49, s82, 0x10000
    buffer_load_dwordx4 v241, s[20:23], s49 offen lds
    v_mul_f32 v52, v52, v60
    v_mul_f32 v53, v53, v61
    v_mul_f32 v54, v54, v62
    v_mul_f32 v55, v55, v63
    v_cvt_pk_bf16_f32 v48, v48, v49
    v_cvt_pk_bf16_f32 v49, v50, v51
    v_cvt_pk_bf16_f32 v50, v52, v53
    v_cvt_pk_bf16_f32 v51, v54, v55
    buffer_store_dwordx4 v[48:51], v242, s[40:43], s61 offen offset:1024 sc1
    v_permlane32_swap_b32 v240, v245
    v_add_f32 v240, v240, v245
    v_max_f32 v16, v176, v177
    v_max_f32 v17, v178, v179
    v_max_f32 v18, v180, v181
    v_max_f32 v19, v182, v183
    v_max3_f32 v20, v184, v185, v8
    s_add_u32 m0, s73, 0x5000
    s_add_u32 s49, s82, 0x14000
    buffer_load_dwordx4 v241, s[20:23], s49 offen lds
    v_max3_f32 v21, v186, v187, v10
    v_max3_f32 v22, v188, v189, v12
    v_max3_f32 v23, v190, v191, v14
    v_mfma_f32_32x32x16_bf16 v[176:191], v[172:175], v[140:143], v[208:223]
    v_max_f32 v20, v20, v9
    v_max_f32 v21, v21, v11
    v_max_f32 v22, v22, v13
    v_max_f32 v23, v23, v15
    v_max3_f32 v244, v16, v17, v18
    v_max3_f32 v245, v19, v20, v21
    v_mfma_f32_32x32x16_bf16 v[0:15], a[148:151], v[140:143], v[216:231]
    v_max3_f32 v244, v244, v22, v23
    v_max_f32 v244, v244, v245
    v_mov_b32 v245, v244
    v_rcp_f32 v240, v240
    s_nop 0
    v_mul_f32 v152, v152, v240
    s_add_u32 m0, s73, 0x6000
    s_add_u32 s49, s82, 0x18000
    buffer_load_dwordx4 v241, s[20:23], s49 offen lds
    v_mul_f32 v153, v153, v240
    v_permlane32_swap_b32 v244, v245
    v_max_f32 v244, v244, v245
    v_mul_f32 v246, -v244, s71
    v_mul_f32 v154, v154, v240
    v_mul_f32 v155, v155, v240
    v_mul_f32 v156, v156, v240
    v_mul_f32 v157, v157, v240
    v_mul_f32 v158, v158, v240
    v_mul_f32 v159, v159, v240
    v_cvt_pk_bf16_f32 v152, v152, v153
    v_cvt_pk_bf16_f32 v153, v154, v155
    v_cvt_pk_bf16_f32 v154, v156, v157
    v_cvt_pk_bf16_f32 v155, v158, v159
    buffer_store_dwordx4 v[152:155], v242, s[40:43], s59 offen offset:1024 sc1
    v_fma_f32 v16, v16, s71, v246
    s_add_u32 m0, s73, 0x7000
    s_add_u32 s49, s82, 0x1c000
    buffer_load_dwordx4 v241, s[20:23], s49 offen lds
    v_fma_f32 v17, v17, s71, v246
    v_fma_f32 v18, v18, s71, v246
    v_fma_f32 v19, v19, s71, v246
    v_fma_f32 v20, v20, s71, v246
    v_fma_f32 v21, v21, s71, v246
    v_fma_f32 v22, v22, s71, v246
    v_fma_f32 v23, v23, s71, v246
    v_exp_f32 v16, v16
    buffer_load_dword v249, v250, s[40:43], s58 offen sc1
    v_exp_f32 v17, v17
    v_exp_f32 v18, v18
    v_exp_f32 v19, v19
    v_exp_f32 v20, v20
    v_exp_f32 v21, v21
    v_exp_f32 v22, v22
    v_exp_f32 v23, v23
    s_add_u32 m0, s50, 0x3000
    s_add_u32 s49, s83, 0
    buffer_load_dwordx4 v241, s[12:15], s49 offen lds
    v_cvt_pk_bf16_f32 v24, v16, v16
    v_and_b32 v24, v253, v24
    v_cvt_pk_bf16_f32 v25, v17, v17
    v_and_b32 v25, v253, v25
    v_cvt_pk_bf16_f32 v26, v18, v18
    v_and_b32 v26, v253, v26
    v_cvt_pk_bf16_f32 v27, v19, v19
    s_waitcnt vmcnt(6)
    buffer_store_dword v248, off, s[40:43], s57 offset:128 sc1
    v_and_b32 v27, v253, v27
    v_add_f32 v247, v16, v17
    v_add_f32 v245, v18, v19
    v_mfma_f32_32x32x16_bf16 v[144:159], v[200:203], v[24:27], 0
    v_cvt_pk_bf16_f32 v32, v20, v20
    v_and_b32 v28, v254, v32
    v_cvt_pk_bf16_f32 v33, v21, v21
    s_add_u32 m0, s50, 0x3400
    s_add_u32 s49, s83, 0x4000
    buffer_load_dwordx4 v241, s[12:15], s49 offen lds
    v_and_b32 v29, v254, v33
    v_cvt_pk_bf16_f32 v34, v22, v22
    v_and_b32 v30, v254, v34
    v_cvt_pk_bf16_f32 v35, v23, v23
    v_and_b32 v31, v254, v35
    v_add_f32 v236, v20, v21
    v_add_f32 v247, v247, v245
    v_mfma_f32_32x32x16_bf16 v[144:159], v[204:207], v[28:31], v[144:159]
    v_and_b32 v32, v255, v32
    v_and_b32 v33, v255, v33
    v_and_b32 v34, v255, v34
    v_and_b32 v35, v255, v35
    v_add_f32 v245, v22, v23
    v_add_f32 v236, v236, v245
    v_mfma_f32_32x32x16_bf16 v[144:159], a[156:159], v[32:35], v[144:159]
    v_add_f32 v247, v247, v236
    s_add_u32 m0, s50, 0x3800
    s_add_u32 s49, s83, 0x8000
    buffer_load_dwordx4 v241, s[12:15], s49 offen lds
    v_mov_b32 v245, v247
    s_nop 1
    v_permlane32_swap_b32 v247, v245
    v_add_f32 v247, v247, v245
    v_max_f32 v16, v176, v177
    v_max_f32 v17, v178, v179
    v_max_f32 v18, v180, v181
    v_max_f32 v19, v182, v183
    v_max3_f32 v20, v184, v185, v8
    v_max3_f32 v21, v186, v187, v10
    v_max3_f32 v22, v188, v189, v12
    v_max3_f32 v23, v190, v191, v14
    v_max_f32 v20, v20, v9
    v_max_f32 v21, v21, v11
    v_max_f32 v22, v22, v13
    s_add_u32 m0, s50, 0x3c00
    s_add_u32 s49, s83, 0xc000
    buffer_load_dwordx4 v241, s[12:15], s49 offen lds
    v_max_f32 v23, v23, v15
    v_max3_f32 v244, v16, v17, v18
    v_max3_f32 v245, v19, v20, v21
    v_max3_f32 v244, v244, v22, v23
    v_max_f32 v244, v244, v245
    v_mov_b32 v245, v244
    v_rcp_f32 v247, v247
    s_nop 0
    v_mul_f32 v144, v144, v247
    v_mul_f32 v145, v145, v247
    v_permlane32_swap_b32 v244, v245
    v_max_f32 v244, v244, v245
    v_mul_f32 v246, -v244, s71
    v_mul_f32 v146, v146, v247
    v_mul_f32 v147, v147, v247
    v_mul_f32 v148, v148, v247
    s_add_u32 m0, s50, 0x4000
    s_add_u32 s49, s6, 0
    buffer_load_dwordx4 v241, s[12:15], s49 offen lds
    v_mul_f32 v149, v149, v247
    v_mul_f32 v150, v150, v247
    v_mul_f32 v151, v151, v247
    v_cvt_pk_bf16_f32 v144, v144, v145
    v_cvt_pk_bf16_f32 v145, v146, v147
    v_cvt_pk_bf16_f32 v146, v148, v149
    v_cvt_pk_bf16_f32 v147, v150, v151
    buffer_store_dwordx4 v[144:147], v242, s[40:43], s59 offen offset:2048 sc1
    v_fma_f32 v16, v16, s71, v246
    v_fma_f32 v17, v17, s71, v246
    v_fma_f32 v18, v18, s71, v246
    v_fma_f32 v19, v19, s71, v246
    v_fma_f32 v20, v20, s71, v246
    v_fma_f32 v21, v21, s71, v246
    v_fma_f32 v22, v22, s71, v246
    v_fma_f32 v23, v23, s71, v246
    s_add_u32 m0, s50, 0x4400
    s_add_u32 s49, s6, 0x4000
    buffer_load_dwordx4 v241, s[12:15], s49 offen lds
    v_exp_f32 v16, v16
    s_waitcnt vmcnt(8)
    v_cmp_ne_u32 vcc, s56, v249
    s_cbranch_vccnz L_gatespin_7
L_gateok_6:
    v_exp_f32 v17, v17
    v_exp_f32 v18, v18
    v_exp_f32 v19, v19
    v_exp_f32 v20, v20
    v_exp_f32 v21, v21
    v_exp_f32 v22, v22
    v_exp_f32 v23, v23
    v_cvt_pk_bf16_f32 v24, v16, v16
    v_and_b32 v24, v253, v24
    v_cvt_pk_bf16_f32 v25, v17, v17
    v_and_b32 v25, v253, v25
    v_cvt_pk_bf16_f32 v26, v18, v18
    s_lshr_b32 s48, s81, 4
    s_add_u32 s48, s48, s78
    s_add_u32 s48, s48, 0x4000
    buffer_load_dwordx4 a[192:195], v242, s[40:43], s48 offen sc1
    v_and_b32 v26, v253, v26
    v_cvt_pk_bf16_f32 v27, v19, v19
    v_and_b32 v27, v253, v27
    v_add_f32 v240, v16, v17
    v_add_f32 v245, v18, v19
    v_mfma_f32_32x32x16_bf16 v[144:159], v[200:203], v[24:27], 0
    v_cvt_pk_bf16_f32 v32, v20, v20
    v_and_b32 v28, v254, v32
    v_cvt_pk_bf16_f32 v33, v21, v21
    v_and_b32 v29, v254, v33
    v_cvt_pk_bf16_f32 v34, v22, v22
    v_and_b32 v30, v254, v34
    v_cvt_pk_bf16_f32 v35, v23, v23
    v_and_b32 v31, v254, v35
    v_add_f32 v236, v20, v21
    v_add_f32 v240, v240, v245
    buffer_load_dwordx4 a[160:163], v242, s[40:43], s48 offen offset:1024 sc1
    v_mfma_f32_32x32x16_bf16 v[144:159], v[204:207], v[28:31], v[144:159]
    v_and_b32 v32, v255, v32
    v_and_b32 v33, v255, v33
    v_and_b32 v34, v255, v34
    v_and_b32 v35, v255, v35
    v_add_f32 v245, v22, v23
    v_add_f32 v236, v236, v245
    v_mfma_f32_32x32x16_bf16 v[144:159], a[156:159], v[32:35], v[144:159]
    v_add_f32 v240, v240, v236
    v_mov_b32 v245, v240
    s_nop 1
    v_permlane32_swap_b32 v240, v245
    v_add_f32 v240, v240, v245
    v_rcp_f32 v240, v240
    s_nop 4
    v_mul_f32 v152, v152, v240
    buffer_load_dwordx4 a[164:167], v242, s[40:43], s48 offen offset:2048 sc1
    v_mul_f32 v153, v153, v240
    v_mul_f32 v154, v154, v240
    v_mul_f32 v155, v155, v240
    v_mul_f32 v156, v156, v240
    v_mul_f32 v157, v157, v240
    v_mul_f32 v158, v158, v240
    v_mul_f32 v159, v159, v240
    v_cvt_pk_bf16_f32 v152, v152, v153
    v_cvt_pk_bf16_f32 v153, v154, v155
    v_cvt_pk_bf16_f32 v154, v156, v157
    v_cvt_pk_bf16_f32 v155, v158, v159
    buffer_store_dwordx4 v[152:155], v242, s[40:43], s59 offen offset:3072 sc1
    buffer_load_dwordx4 a[168:171], v242, s[40:43], s48 offen offset:3072 sc1
    s_lshr_b32 s48, s81, 4
    s_add_u32 s48, s48, s78
    s_add_u32 s48, s48, 0x5000
    buffer_load_dwordx4 a[172:175], v242, s[40:43], s48 offen sc1
    buffer_load_dwordx4 a[176:179], v242, s[40:43], s48 offen offset:1024 sc1
    buffer_load_dwordx4 a[180:183], v242, s[40:43], s48 offen offset:2048 sc1
    buffer_load_dwordx4 a[184:187], v242, s[40:43], s48 offen offset:3072 sc1
    s_lshr_b32 s48, s0, 4
    s_add_u32 s48, s48, s78
    s_add_u32 s48, s48, 0x4000
    buffer_load_dwordx4 a[188:191], v242, s[40:43], s48 offen sc1
    buffer_load_dwordx4 a[48:51], v242, s[40:43], s48 offen offset:1024 sc1
    buffer_load_dwordx4 a[52:55], v242, s[40:43], s48 offen offset:2048 sc1
    buffer_load_dwordx4 a[56:59], v242, s[40:43], s48 offen offset:3072 sc1
    s_waitcnt vmcnt(9)
    buffer_store_dword v248, off, s[40:43], s57 offset:512 sc1
    v_mfma_f32_32x32x16_bf16 v[64:79], a[200:203], a[192:195], 0
    s_lshr_b32 s48, s0, 4
    s_add_u32 s48, s48, s78
    s_add_u32 s48, s48, 0x5000
    buffer_load_dwordx4 a[60:63], v242, s[40:43], s48 offen sc1
    v_mfma_f32_32x32x16_bf16 v[80:95], a[204:207], a[192:195], 0
    buffer_load_dwordx4 a[64:67], v242, s[40:43], s48 offen offset:1024 sc1
    v_mfma_f32_32x32x16_bf16 v[64:79], a[208:211], a[160:163], v[64:79]
    buffer_load_dwordx4 a[68:71], v242, s[40:43], s48 offen offset:2048 sc1
    v_mfma_f32_32x32x16_bf16 v[80:95], a[212:215], a[160:163], v[80:95]
    buffer_load_dwordx4 a[72:75], v242, s[40:43], s48 offen offset:3072 sc1
    v_mfma_f32_32x32x16_bf16 v[64:79], a[216:219], a[164:167], v[64:79]
    s_lshr_b32 s48, s1, 4
    s_add_u32 s48, s48, s78
    s_add_u32 s48, s48, 0x4000
    buffer_load_dwordx4 a[192:195], v242, s[40:43], s48 offen sc1
    v_mfma_f32_32x32x16_bf16 v[80:95], a[220:223], a[164:167], v[80:95]
    buffer_load_dwordx4 a[76:79], v242, s[40:43], s48 offen offset:1024 sc1
    s_waitcnt vmcnt(15)
    v_mfma_f32_32x32x16_bf16 v[64:79], a[224:227], a[168:171], v[64:79]
    buffer_load_dwordx4 a[160:163], v242, s[40:43], s48 offen offset:2048 sc1
    v_mfma_f32_32x32x16_bf16 v[80:95], a[228:231], a[168:171], v[80:95]
    buffer_load_dwordx4 a[136:139], v242, s[40:43], s48 offen offset:3072 sc1
    s_waitcnt vmcnt(16)
    v_mfma_f32_32x32x16_bf16 v[64:79], a[232:235], a[172:175], v[64:79]
    s_lshr_b32 s48, s1, 4
    s_add_u32 s48, s48, s78
    s_add_u32 s48, s48, 0x5000
    buffer_load_dwordx4 a[164:167], v242, s[40:43], s48 offen sc1
    v_mfma_f32_32x32x16_bf16 v[80:95], a[236:239], a[172:175], v[80:95]
    buffer_load_dwordx4 a[168:171], v242, s[40:43], s48 offen offset:1024 sc1
    s_barrier
    s_waitcnt vmcnt(17)
    v_mfma_f32_32x32x16_bf16 v[64:79], a[240:243], a[176:179], v[64:79]
    buffer_load_dword v36, v250, s[40:43], s58 offen offset:128 sc1
    v_mfma_f32_32x32x16_bf16 v[80:95], a[244:247], a[176:179], v[80:95]
    buffer_load_dwordx4 a[140:143], v242, s[40:43], s48 offen offset:2048 sc1
    s_waitcnt vmcnt(18)
    v_mfma_f32_32x32x16_bf16 v[64:79], a[248:251], a[180:183], v[64:79]
    buffer_load_dwordx4 a[172:175], v242, s[40:43], s48 offen offset:3072 sc1
    v_mfma_f32_32x32x16_bf16 v[80:95], a[252:255], a[180:183], v[80:95]
    s_lshr_b32 s48, s5, 4
    s_add_u32 s48, s48, s78
    s_add_u32 s48, s48, 0x4000
    buffer_load_dwordx4 a[176:179], v242, s[40:43], s48 offen sc1
    s_waitcnt vmcnt(19)
    v_mfma_f32_32x32x16_bf16 v[64:79], a[80:83], a[184:187], v[64:79]
    ds_read_b64_tr_b16 a[0:1], v234 offset:22528
    ds_read_b64_tr_b16 a[2:3], v234 offset:55296
    buffer_load_dwordx4 a[180:183], v242, s[40:43], s48 offen offset:1024 sc1
    v_mfma_f32_32x32x16_bf16 v[80:95], a[84:87], a[184:187], v[80:95]
    ds_read_b64_tr_b16 a[4:5], v235 offset:22528
    ds_read_b64_tr_b16 a[6:7], v235 offset:55296
    buffer_load_dwordx4 a[144:147], v242, s[40:43], s48 offen offset:2048 sc1
L_padA_5:
    s_cbranch_execz L_backA
    s_waitcnt vmcnt(20)
    v_mfma_f32_32x32x16_bf16 v[64:79], a[88:91], a[188:191], v[64:79]
    ds_read_b64_tr_b16 a[8:9], v234 offset:23552
    ds_read_b64_tr_b16 a[10:11], v234 offset:56320
    buffer_load_dwordx4 a[148:151], v242, s[40:43], s48 offen offset:3072 sc1
    v_mfma_f32_32x32x16_bf16 v[80:95], a[92:95], a[188:191], v[80:95]
    ds_read_b64_tr_b16 a[12:13], v235 offset:23552
    ds_read_b64_tr_b16 a[14:15], v235 offset:56320
    s_lshr_b32 s48, s5, 4
    s_add_u32 s48, s48, s78
    s_add_u32 s48, s48, 0x5000
    buffer_load_dwordx4 a[184:187], v242, s[40:43], s48 offen sc1
    s_waitcnt vmcnt(21)
    v_mfma_f32_32x32x16_bf16 v[64:79], a[96:99], a[48:51], v[64:79]
    ds_read_b64_tr_b16 a[16:17], v234 offset:24576
    ds_read_b64_tr_b16 a[18:19], v234 offset:57344
    buffer_load_dwordx4 a[188:191], v242, s[40:43], s48 offen offset:1024 sc1
    v_mfma_f32_32x32x16_bf16 v[80:95], a[100:103], a[48:51], v[80:95]
    ds_read_b64_tr_b16 a[20:21], v235 offset:24576
    ds_read_b64_tr_b16 a[22:23], v235 offset:57344
    buffer_load_dwordx4 a[152:155], v242, s[40:43], s48 offen offset:2048 sc1
    s_waitcnt vmcnt(22) lgkmcnt(4)
    v_mfma_f32_32x32x16_bf16 v[64:79], a[0:3], a[52:55], v[64:79]
    ds_read_b64_tr_b16 a[24:25], v234 offset:25600
    ds_read_b64_tr_b16 a[26:27], v234 offset:58368
    buffer_load_dwordx4 a[156:159], v242, s[40:43], s48 offen offset:3072 sc1
    v_mfma_f32_32x32x16_bf16 v[80:95], a[4:7], a[52:55], v[80:95]
    ds_read_b64_tr_b16 a[28:29], v235 offset:25600
    ds_read_b64_tr_b16 a[30:31], v235 offset:58368
    s_add_u32 m0, s50, 0x4800
    s_add_u32 s49, s6, 0x8000
    buffer_load_dwordx4 v241, s[12:15], s49 offen lds
    s_waitcnt vmcnt(23)
    v_mfma_f32_32x32x16_bf16 v[64:79], a[8:11], a[56:59], v[64:79]
    ds_read_b64_tr_b16 a[32:33], v234 offset:26624
    ds_read_b64_tr_b16 a[34:35], v234 offset:59392
    s_add_u32 m0, s50, 0x4c00
    s_add_u32 s49, s6, 0xc000
    buffer_load_dwordx4 v241, s[12:15], s49 offen lds
    v_mfma_f32_32x32x16_bf16 v[80:95], a[12:15], a[56:59], v[80:95]
    ds_read_b64_tr_b16 a[36:37], v235 offset:26624
    ds_read_b64_tr_b16 a[38:39], v235 offset:59392
    s_add_u32 m0, s50, 0x5000
    s_add_u32 s49, s7, 0
    buffer_load_dwordx4 v241, s[12:15], s49 offen lds
    s_waitcnt vmcnt(23) lgkmcnt(2)
    v_mfma_f32_32x32x16_bf16 v[64:79], a[16:19], a[60:63], v[64:79]
    ds_read_b64_tr_b16 a[40:41], v234 offset:27648
    ds_read_b64_tr_b16 a[42:43], v234 offset:60416
    s_add_u32 m0, s50, 0x5400
    s_add_u32 s49, s7, 0x4000
    buffer_load_dwordx4 v241, s[12:15], s49 offen lds
    v_mfma_f32_32x32x16_bf16 v[80:95], a[20:23], a[60:63], v[80:95]
    ds_read_b64_tr_b16 a[44:45], v235 offset:27648
    ds_read_b64_tr_b16 a[46:47], v235 offset:60416
    s_barrier
    s_waitcnt vmcnt(23)
    v_mfma_f32_32x32x16_bf16 v[64:79], a[24:27], a[64:67], v[64:79]
    ds_read_b64_tr_b16 a[0:1], v234 offset:28672
    ds_read_b64_tr_b16 a[2:3], v234 offset:61440
    buffer_load_dword v47, v250, s[40:43], s58 offen offset:512 sc1
    v_mfma_f32_32x32x16_bf16 v[80:95], a[28:31], a[64:67], v[80:95]
    ds_read_b64_tr_b16 a[4:5], v235 offset:28672
    ds_read_b64_tr_b16 a[6:7], v235 offset:61440
    s_add_u32 m0, s50, 0x5800
    s_add_u32 s49, s7, 0x8000
    buffer_load_dwordx4 v241, s[12:15], s49 offen lds
    s_waitcnt vmcnt(24)
    v_mfma_f32_32x32x16_bf16 v[64:79], a[32:35], a[68:71], v[64:79]
    ds_read_b64_tr_b16 a[8:9], v234 offset:29696
    ds_read_b64_tr_b16 a[10:11], v234 offset:62464
    s_add_u32 m0, s50, 0x5c00
    s_add_u32 s49, s7, 0xc000
    buffer_load_dwordx4 v241, s[12:15], s49 offen lds
    s_waitcnt lgkmcnt(2)
    v_mfma_f32_32x32x16_bf16 v[80:95], a[36:39], a[68:71], v[80:95]
    ds_read_b64_tr_b16 a[12:13], v235 offset:29696
    ds_read_b64_tr_b16 a[14:15], v235 offset:62464
    s_add_u32 m0, s50, 0x6000
    s_add_u32 s49, s69, 0
    buffer_load_dwordx4 v241, s[12:15], s49 offen lds
    s_waitcnt vmcnt(25)
    v_mfma_f32_32x32x16_bf16 v[64:79], a[40:43], a[72:75], v[64:79]
    ds_read_b64_tr_b16 a[16:17], v234 offset:30720
    ds_read_b64_tr_b16 a[18:19], v234 offset:63488
    v_lshrrev_b32 v32, 4, v243
    v_and_b32 v33, 31, v32
    v_lshrrev_b32 v34, 5, v32
    v_lshlrev_b32 v34, 3, v34
    s_lshr_b32 s51, s50, 3
    v_mfma_f32_32x32x16_bf16 v[80:95], a[44:47], a[72:75], v[80:95]
    ds_read_b64_tr_b16 a[20:21], v235 offset:30720
    ds_read_b64_tr_b16 a[22:23], v235 offset:63488
    s_add_u32 s51, s51, 0x20000
    v_add_u32 v232, s51, v243
    v_xor_b32 v233, 0x2000, v232
    s_and_b32 s51, s3, 1
    s_waitcnt vmcnt(24)
    v_mfma_f32_32x32x16_bf16 v[64:79], a[0:3], a[192:195], v[64:79]
    ds_read_b64_tr_b16 a[24:25], v234 offset:31744
    ds_read_b64_tr_b16 a[26:27], v234 offset:64512
    s_lshl_b32 s52, s51, 12
    s_add_u32 s52, s52, 0x24000
    v_lshlrev_b32 v35, 7, v33
    v_add3_u32 v238, v35, v34, s52
    v_and_b32 v35, 7, v32
    v_mfma_f32_32x32x16_bf16 v[80:95], a[4:7], a[192:195], v[80:95]
    ds_read_b64_tr_b16 a[28:29], v235 offset:31744
    ds_read_b64_tr_b16 a[30:31], v235 offset:64512
    v_lshlrev_b32 v35, 4, v35
    s_lshl_b32 s52, s70, 6
    v_xor_b32 v35, s52, v35
    v_add_u32 v238, v238, v35
    s_waitcnt vmcnt(23) lgkmcnt(2)
    v_mfma_f32_32x32x16_bf16 v[64:79], a[8:11], a[76:79], v[64:79]
    ds_read_b64_tr_b16 a[32:33], v234 offset:0
    ds_read_b64_tr_b16 a[34:35], v234 offset:32768
    s_mul_i32 s51, s51, 0x1200
    s_add_u32 s51, s51, s52
    s_add_u32 s51, s51, 0x20000
    v_mul_u32_u24 v33, 0x90, v33
    v_add3_u32 v244, v33, v34, s51
    v_mfma_f32_32x32x16_bf16 v[80:95], a[12:15], a[76:79], v[80:95]
    ds_read_b64_tr_b16 a[36:37], v235 offset:0
    ds_read_b64_tr_b16 a[38:39], v235 offset:32768
    v_lshrrev_b32 v33, 3, v32
    v_and_b32 v34, 0x70, v243
    v_lshl_add_u32 v236, v33, 10, v34
    v_lshlrev_b32 v35, 4, v33
    s_waitcnt vmcnt(22)
    v_mfma_f32_32x32x16_bf16 v[64:79], a[16:19], a[160:163], v[64:79]
    ds_read_b64_tr_b16 a[40:41], v234 offset:1024
    ds_read_b64_tr_b16 a[42:43], v234 offset:33792
    s_waitcnt vmcnt(18)
    v_cmp_ne_u32 vcc, s56, v36
    s_cbranch_vccnz L_gatespin_9
L_gateok_8:
    s_add_u32 s48, s79, 0
    buffer_load_dwordx4 a[192:195], v242, s[40:43], s48 offen sc1
    v_mfma_f32_32x32x16_bf16 v[80:95], a[20:23], a[160:163], v[80:95]
    ds_read_b64_tr_b16 a[44:45], v235 offset:1024
    ds_read_b64_tr_b16 a[46:47], v235 offset:33792
    buffer_load_dwordx4 a[48:51], v242, s[40:43], s48 offen offset:1024 sc1
    v_xor_b32 v237, v236, v35
    s_mul_i32 s51, s3, 0x900
    v_mfma_f32_32x32x16_bf16 v[64:79], a[24:27], a[136:139], v[64:79]
    ds_read_b64_tr_b16 a[0:1], v234 offset:2048
    ds_read_b64_tr_b16 a[2:3], v234 offset:34816
    buffer_load_dwordx4 a[160:163], v242, s[40:43], s48 offen offset:2048 sc1
    s_add_u32 s51, s51, 0x20000
    v_mul_u32_u24 v33, 0x90, v33
    s_waitcnt lgkmcnt(2)
    v_mfma_f32_32x32x16_bf16 v[80:95], a[28:31], a[136:139], v[80:95]
    ds_read_b64_tr_b16 a[4:5], v235 offset:2048
    ds_read_b64_tr_b16 a[6:7], v235 offset:34816
    buffer_load_dwordx4 a[52:55], v242, s[40:43], s48 offen offset:3072 sc1
    v_add3_u32 v245, v33, v34, s51
    v_mfma_f32_32x32x16_bf16 v[64:79], a[32:35], a[164:167], v[64:79]
    ds_read_b64_tr_b16 a[8:9], v234 offset:3072
    ds_read_b64_tr_b16 a[10:11], v234 offset:35840
    s_add_u32 s48, s79, 0x1000
    buffer_load_dwordx4 a[56:59], v242, s[40:43], s48 offen sc1
    v_mfma_f32_32x32x16_bf16 v[80:95], a[36:39], a[164:167], v[80:95]
    ds_read_b64_tr_b16 a[12:13], v235 offset:3072
    ds_read_b64_tr_b16 a[14:15], v235 offset:35840
    buffer_load_dwordx4 a[60:63], v242, s[40:43], s48 offen offset:1024 sc1
    s_barrier
    v_mfma_f32_32x32x16_bf16 v[64:79], a[40:43], a[168:171], v[64:79]
    ds_read_b64_tr_b16 a[16:17], v234 offset:4096
    ds_read_b64_tr_b16 a[18:19], v234 offset:36864
    buffer_load_dwordx4 a[64:67], v242, s[40:43], s48 offen offset:2048 sc1
    v_mfma_f32_32x32x16_bf16 v[80:95], a[44:47], a[168:171], v[80:95]
    ds_read_b64_tr_b16 a[20:21], v235 offset:4096
    ds_read_b64_tr_b16 a[22:23], v235 offset:36864
    buffer_load_dwordx4 a[164:167], v242, s[40:43], s48 offen offset:3072 sc1
    s_waitcnt vmcnt(25) lgkmcnt(4)
    v_mfma_f32_32x32x16_bf16 v[64:79], a[0:3], a[140:143], v[64:79]
    ds_read_b64_tr_b16 a[24:25], v234 offset:5120
    ds_read_b64_tr_b16 a[26:27], v234 offset:37888
    s_add_u32 m0, s50, 0x6400
    s_add_u32 s49, s69, 0x4000
    buffer_load_dwordx4 v241, s[12:15], s49 offen lds
    v_mfma_f32_32x32x16_bf16 v[80:95], a[4:7], a[140:143], v[80:95]
    ds_read_b64_tr_b16 a[28:29], v235 offset:5120
    ds_read_b64_tr_b16 a[30:31], v235 offset:37888
    s_add_u32 m0, s50, 0x6800
    s_add_u32 s49, s69, 0x8000
    buffer_load_dwordx4 v241, s[12:15], s49 offen lds
    s_waitcnt vmcnt(26)
    v_mfma_f32_32x32x16_bf16 v[64:79], a[8:11], a[172:175], v[64:79]
    ds_read_b64_tr_b16 a[32:33], v234 offset:6144
    ds_read_b64_tr_b16 a[34:35], v234 offset:38912
    s_lshl_b32 s75, s3, 11
    s_add_u32 s75, s75, 0x24000
    s_add_u32 s72, s66, 0x2000
    buffer_load_dwordx4 v[224:227], v237, s[8:11], s66 offen
    v_mfma_f32_32x32x16_bf16 v[80:95], a[12:15], a[172:175], v[80:95]
    ds_read_b64_tr_b16 a[36:37], v235 offset:6144
    ds_read_b64_tr_b16 a[38:39], v235 offset:38912
    s_waitcnt vmcnt(26) lgkmcnt(4)
    v_mfma_f32_32x32x16_bf16 v[64:79], a[16:19], a[176:179], v[64:79]
    ds_read_b64_tr_b16 a[40:41], v234 offset:7168
    ds_read_b64_tr_b16 a[42:43], v234 offset:39936
    buffer_load_dwordx4 v[228:231], v237, s[8:11], s72 offen
    v_add_u32 v237, s75, v243
    v_mfma_f32_32x32x16_bf16 v[80:95], a[20:23], a[176:179], v[80:95]
    ds_read_b64_tr_b16 a[44:45], v235 offset:7168
    ds_read_b64_tr_b16 a[46:47], v235 offset:39936
    s_waitcnt vmcnt(26)
    v_mfma_f32_32x32x16_bf16 v[64:79], a[24:27], a[180:183], v[64:79]
    ds_read_b64_tr_b16 a[0:1], v234 offset:8192
    ds_read_b64_tr_b16 a[2:3], v234 offset:40960
    buffer_load_dword v37, v250, s[40:43], s58 offen offset:256 sc1
    v_mfma_f32_32x32x16_bf16 v[80:95], a[28:31], a[180:183], v[80:95]
    ds_read_b64_tr_b16 a[4:5], v235 offset:8192
    ds_read_b64_tr_b16 a[6:7], v235 offset:40960
    s_add_u32 m0, s50, 0x6c00
    s_add_u32 s49, s69, 0xc000
    buffer_load_dwordx4 v241, s[12:15], s49 offen lds
    s_waitcnt vmcnt(27) lgkmcnt(4)
    v_mfma_f32_32x32x16_bf16 v[64:79], a[32:35], a[144:147], v[64:79]
    ds_read_b64_tr_b16 a[8:9], v234 offset:9216
    ds_read_b64_tr_b16 a[10:11], v234 offset:41984
    s_waitcnt vmcnt(17)
    v_cmp_ne_u32 vcc, s56, v47
    s_cbranch_vccnz L_gatespin_11
L_gateok_10:
    s_lshr_b32 s48, s83, 4
    s_add_u32 s48, s48, s80
    s_add_u32 s48, s48, 0x1c000
    buffer_load_dwordx4 a[168:171], v242, s[40:43], s48 offen sc1
    v_mfma_f32_32x32x16_bf16 v[80:95], a[36:39], a[144:147], v[80:95]
    ds_read_b64_tr_b16 a[12:13], v235 offset:9216
    ds_read_b64_tr_b16 a[14:15], v235 offset:41984
    buffer_load_dwordx4 a[172:175], v242, s[40:43], s48 offen offset:1024 sc1
    v_mfma_f32_32x32x16_bf16 v[64:79], a[40:43], a[148:151], v[64:79]
    ds_read_b64_tr_b16 a[16:17], v234 offset:10240
    ds_read_b64_tr_b16 a[18:19], v234 offset:43008
    buffer_load_dwordx4 a[176:179], v242, s[40:43], s48 offen offset:2048 sc1
    v_mfma_f32_32x32x16_bf16 v[80:95], a[44:47], a[148:151], v[80:95]
    ds_read_b64_tr_b16 a[20:21], v235 offset:10240
    ds_read_b64_tr_b16 a[22:23], v235 offset:43008
    s_waitcnt lgkmcnt(5)
    v_mfma_f32_32x32x16_bf16 v[64:79], a[0:3], a[184:187], v[64:79]
    ds_read_b64_tr_b16 a[24:25], v234 offset:11264
    ds_read_b64_tr_b16 a[26:27], v234 offset:44032
    buffer_load_dwordx4 a[180:183], v242, s[40:43], s48 offen offset:3072 sc1
    v_mfma_f32_32x32x16_bf16 v[80:95], a[4:7], a[184:187], v[80:95]
    ds_read_b64_tr_b16 a[28:29], v235 offset:11264
    ds_read_b64_tr_b16 a[30:31], v235 offset:44032
    s_barrier
    v_mfma_f32_32x32x16_bf16 v[64:79], a[8:11], a[188:191], v[64:79]
    ds_read_b64_tr_b16 a[32:33], v42 offset:0
    ds_read_b64_tr_b16 a[34:35], v42 offset:1024
    s_lshr_b32 s48, s6, 4
    s_add_u32 s48, s48, s80
    s_add_u32 s48, s48, 0x1c000
    buffer_load_dwordx4 a[184:187], v242, s[40:43], s48 offen sc1
    s_waitcnt lgkmcnt(3)
    v_mfma_f32_32x32x16_bf16 v[80:95], a[12:15], a[188:191], v[80:95]
    ds_read_b64_tr_b16 a[36:37], v43 offset:0
    ds_read_b64_tr_b16 a[38:39], v43 offset:1024
    v_mfma_f32_32x32x16_bf16 v[64:79], a[16:19], a[152:155], v[64:79]
    ds_read_b64_tr_b16 a[40:41], v42 offset:4096
    ds_read_b64_tr_b16 a[42:43], v42 offset:5120
    buffer_load_dwordx4 a[68:71], v242, s[40:43], s48 offen offset:1024 sc1
    v_mfma_f32_32x32x16_bf16 v[80:95], a[20:23], a[152:155], v[80:95]
    ds_read_b64_tr_b16 a[44:45], v43 offset:4096
    ds_read_b64_tr_b16 a[46:47], v43 offset:5120
    v_mfma_f32_32x32x16_bf16 v[64:79], a[24:27], a[156:159], v[64:79]
    ds_read_b64_tr_b16 a[0:1], v42 offset:8192
    ds_read_b64_tr_b16 a[2:3], v42 offset:9216
    buffer_load_dwordx4 a[188:191], v242, s[40:43], s48 offen offset:2048 sc1
    s_waitcnt lgkmcnt(5)
    v_mfma_f32_32x32x16_bf16 v[80:95], a[28:31], a[156:159], v[80:95]
    ds_read_b64_tr_b16 a[4:5], v43 offset:8192
    ds_read_b64_tr_b16 a[6:7], v43 offset:9216
    s_waitcnt vmcnt(20)
    v_mfma_f32_32x32x16_bf16 v[64:79], a[32:35], a[192:195], v[64:79]
    ds_read_b64_tr_b16 a[8:9], v42 offset:12288
    ds_read_b64_tr_b16 a[10:11], v42 offset:13312
    buffer_load_dwordx4 a[72:75], v242, s[40:43], s48 offen offset:3072 sc1
    v_mfma_f32_32x32x16_bf16 v[80:95], a[36:39], a[192:195], v[80:95]
    ds_read_b64_tr_b16 a[12:13], v43 offset:12288
    ds_read_b64_tr_b16 a[14:15], v43 offset:13312
    s_waitcnt vmcnt(20) lgkmcnt(5)
    v_mfma_f32_32x32x16_bf16 v[64:79], a[40:43], a[48:51], v[64:79]
    ds_read_b64_tr_b16 a[16:17], v42 offset:16384
    ds_read_b64_tr_b16 a[18:19], v42 offset:17408
    s_lshr_b32 s48, s7, 4
    s_add_u32 s48, s48, s80
    s_add_u32 s48, s48, 0x1c000
    buffer_load_dwordx4 a[192:195], v242, s[40:43], s48 offen sc1
    v_mfma_f32_32x32x16_bf16 v[80:95], a[44:47], a[48:51], v[80:95]
    ds_read_b64_tr_b16 a[20:21], v43 offset:16384
    ds_read_b64_tr_b16 a[22:23], v43 offset:17408
    buffer_load_dwordx4 a[76:79], v242, s[40:43], s48 offen offset:1024 sc1
    s_waitcnt vmcnt(21)
    v_mfma_f32_32x32x16_bf16 v[64:79], a[0:3], a[160:163], v[64:79]
    ds_read_b64_tr_b16 a[24:25], v42 offset:20480
    ds_read_b64_tr_b16 a[26:27], v42 offset:21504
    s_add_u32 m0, s50, 0x7000
    s_add_u32 s49, s81, 0x60000
    buffer_load_dwordx4 v241, s[20:23], s49 offen lds
    s_waitcnt lgkmcnt(3)
    v_mfma_f32_32x32x16_bf16 v[80:95], a[4:7], a[160:163], v[80:95]
    ds_read_b64_tr_b16 a[28:29], v43 offset:20480
    ds_read_b64_tr_b16 a[30:31], v43 offset:21504
    s_waitcnt vmcnt(21)
    v_mfma_f32_32x32x16_bf16 v[64:79], a[8:11], a[52:55], v[64:79]
    ds_read_b64_tr_b16 a[32:33], v42 offset:24576
    ds_read_b64_tr_b16 a[34:35], v42 offset:25600
    buffer_load_dwordx4 a[48:51], v242, s[40:43], s48 offen offset:2048 sc1
    v_mfma_f32_32x32x16_bf16 v[80:95], a[12:15], a[52:55], v[80:95]
    ds_read_b64_tr_b16 a[36:37], v43 offset:24576
    ds_read_b64_tr_b16 a[38:39], v43 offset:25600
    s_add_u32 m0, s50, 0x7400
    s_add_u32 s49, s81, 0x64000
    buffer_load_dwordx4 v241, s[20:23], s49 offen lds
    s_waitcnt vmcnt(22)
    v_mfma_f32_32x32x16_bf16 v[64:79], a[16:19], a[56:59], v[64:79]
    ds_read_b64_tr_b16 a[40:41], v42 offset:28672
    ds_read_b64_tr_b16 a[42:43], v42 offset:29696
    buffer_load_dwordx4 a[160:163], v242, s[40:43], s48 offen offset:3072 sc1
    s_waitcnt lgkmcnt(3)
    v_mfma_f32_32x32x16_bf16 v[80:95], a[20:23], a[56:59], v[80:95]
    ds_read_b64_tr_b16 a[44:45], v43 offset:28672
    ds_read_b64_tr_b16 a[46:47], v43 offset:29696
    s_add_u32 m0, s50, 0x7800
    s_add_u32 s49, s0, 0x60000
    buffer_load_dwordx4 v241, s[20:23], s49 offen lds
    s_barrier
    s_waitcnt vmcnt(23)
    v_mfma_f32_32x32x16_bf16 v[64:79], a[24:27], a[60:63], v[64:79]
    ds_read_b64_tr_b16 a[0:1], v234 offset:12288
    ds_read_b64_tr_b16 a[2:3], v234 offset:45056
    s_lshr_b32 s48, s69, 4
    s_add_u32 s48, s48, s80
    s_add_u32 s48, s48, 0x1c000
    buffer_load_dwordx4 a[52:55], v242, s[40:43], s48 offen sc1
    v_mfma_f32_32x32x16_bf16 v[80:95], a[28:31], a[60:63], v[80:95]
    ds_read_b64_tr_b16 a[4:5], v235 offset:12288
    ds_read_b64_tr_b16 a[6:7], v235 offset:45056
    s_add_u32 m0, s50, 0x7c00
    s_add_u32 s49, s0, 0x64000
    buffer_load_dwordx4 v241, s[20:23], s49 offen lds
    s_waitcnt vmcnt(24)
    v_mfma_f32_32x32x16_bf16 v[64:79], a[32:35], a[64:67], v[64:79]
    ds_read_b64_tr_b16 a[8:9], v234 offset:13312
    ds_read_b64_tr_b16 a[10:11], v234 offset:46080
    buffer_load_dwordx4 a[56:59], v242, s[40:43], s48 offen offset:1024 sc1
    buffer_load_dwordx4 a[60:63], v242, s[40:43], s48 offen offset:2048 sc1
    buffer_load_dwordx4 a[136:139], v242, s[40:43], s48 offen offset:3072 sc1
    s_waitcnt vmcnt(21)
    v_cmp_ne_u32 vcc, s56, v37
    s_cbranch_vccnz L_gatespin_13
L_gateok_12:
    s_waitcnt lgkmcnt(2)
    v_mfma_f32_32x32x16_bf16 v[80:95], a[36:39], a[64:67], v[80:95]
    ds_read_b64_tr_b16 a[12:13], v235 offset:13312
    ds_read_b64_tr_b16 a[14:15], v235 offset:46080
    s_add_u32 m0, s50, 0
    s_add_u32 s49, s1, 0x60000
    buffer_load_dwordx4 v241, s[20:23], s49 offen lds
    buffer_load_dword v239, v250, s[40:43], s58 offen offset:640 sc1
    v_mfma_f32_32x32x16_bf16 v[64:79], a[40:43], a[164:167], v[64:79]
    ds_read_b64_tr_b16 a[16:17], v234 offset:14336
    ds_read_b64_tr_b16 a[18:19], v234 offset:47104
    s_add_u32 m0, s50, 0x400
    s_add_u32 s49, s1, 0x64000
    buffer_load_dwordx4 v241, s[20:23], s49 offen lds
    v_mfma_f32_32x32x16_bf16 v[80:95], a[44:47], a[164:167], v[80:95]
    ds_read_b64_tr_b16 a[20:21], v235 offset:14336
    ds_read_b64_tr_b16 a[22:23], v235 offset:47104
    s_waitcnt vmcnt(22)
    v_mfma_f32_32x32x16_bf16 v[96:111], a[0:3], a[168:171], 0
    ds_read_b64_tr_b16 a[24:25], v234 offset:15360
    ds_read_b64_tr_b16 a[26:27], v234 offset:48128
    s_add_u32 m0, s50, 0x800
    s_add_u32 s49, s5, 0x60000
    buffer_load_dwordx4 v241, s[20:23], s49 offen lds
    v_mfma_f32_32x32x16_bf16 v[112:127], a[4:7], a[168:171], 0
    ds_read_b64_tr_b16 a[28:29], v235 offset:15360
    ds_read_b64_tr_b16 a[30:31], v235 offset:48128
    s_waitcnt vmcnt(22) lgkmcnt(4)
    v_mfma_f32_32x32x16_bf16 v[96:111], a[8:11], a[172:175], v[96:111]
    ds_read_b64_tr_b16 a[32:33], v234 offset:16384
    ds_read_b64_tr_b16 a[34:35], v234 offset:49152
    s_lshr_b32 s48, s81, 4
    s_add_u32 s48, s48, s78
    s_add_u32 s48, s48, 0x6000
    buffer_load_dwordx4 a[164:167], v242, s[40:43], s48 offen sc1
    v_mfma_f32_32x32x16_bf16 v[112:127], a[12:15], a[172:175], v[112:127]
    ds_read_b64_tr_b16 a[36:37], v235 offset:16384
    ds_read_b64_tr_b16 a[38:39], v235 offset:49152
    s_add_u32 m0, s50, 0xc00
    s_add_u32 s49, s5, 0x64000
    buffer_load_dwordx4 v241, s[20:23], s49 offen lds
    s_waitcnt vmcnt(23)
    v_mfma_f32_32x32x16_bf16 v[96:111], a[16:19], a[176:179], v[96:111]
    ds_read_b64_tr_b16 a[40:41], v234 offset:17408
    ds_read_b64_tr_b16 a[42:43], v234 offset:50176
    buffer_load_dwordx4 a[168:171], v242, s[40:43], s48 offen offset:1024 sc1
    v_mfma_f32_32x32x16_bf16 v[112:127], a[20:23], a[176:179], v[112:127]
    ds_read_b64_tr_b16 a[44:45], v235 offset:17408
    ds_read_b64_tr_b16 a[46:47], v235 offset:50176
    s_add_u32 m0, s50, 0x1000
    s_add_u32 s49, s81, 0x68000
    buffer_load_dwordx4 v241, s[20:23], s49 offen lds
    s_waitcnt vmcnt(24) lgkmcnt(4)
    v_mfma_f32_32x32x16_bf16 v[96:111], a[24:27], a[180:183], v[96:111]
    ds_read_b64_tr_b16 a[0:1], v234 offset:18432
    ds_read_b64_tr_b16 a[2:3], v234 offset:51200
    s_lshr_b32 s48, s0, 4
    s_add_u32 s48, s48, s78
    s_add_u32 s48, s48, 0x6000
    buffer_load_dwordx4 a[172:175], v242, s[40:43], s48 offen sc1
    v_mfma_f32_32x32x16_bf16 v[112:127], a[28:31], a[180:183], v[112:127]
    ds_read_b64_tr_b16 a[4:5], v235 offset:18432
    ds_read_b64_tr_b16 a[6:7], v235 offset:51200
    s_add_u32 m0, s50, 0x1400
    s_add_u32 s49, s81, 0x6c000
    buffer_load_dwordx4 v241, s[20:23], s49 offen lds
    s_waitcnt vmcnt(25)
    v_mfma_f32_32x32x16_bf16 v[96:111], a[32:35], a[184:187], v[96:111]
    ds_read_b64_tr_b16 a[8:9], v234 offset:19456
    ds_read_b64_tr_b16 a[10:11], v234 offset:52224
    buffer_load_dwordx4 a[176:179], v242, s[40:43], s48 offen offset:1024 sc1
    v_mfma_f32_32x32x16_bf16 v[112:127], a[36:39], a[184:187], v[112:127]
    ds_read_b64_tr_b16 a[12:13], v235 offset:19456
    ds_read_b64_tr_b16 a[14:15], v235 offset:52224
    s_add_u32 m0, s50, 0x1800
    s_add_u32 s49, s0, 0x68000
    buffer_load_dwordx4 v241, s[20:23], s49 offen lds
    s_barrier
    s_waitcnt vmcnt(26) lgkmcnt(3)
    v_mfma_f32_32x32x16_bf16 v[96:111], a[40:43], a[68:71], v[96:111]
    ds_read_b64_tr_b16 a[16:17], v234 offset:20480
    ds_read_b64_tr_b16 a[18:19], v234 offset:53248
    s_lshr_b32 s48, s1, 4
    s_add_u32 s48, s48, s78
    s_add_u32 s48, s48, 0x6000
    buffer_load_dwordx4 a[180:183], v242, s[40:43], s48 offen sc1
    v_mfma_f32_32x32x16_bf16 v[112:127], a[44:47], a[68:71], v[112:127]
    ds_read_b64_tr_b16 a[20:21], v235 offset:20480
    ds_read_b64_tr_b16 a[22:23], v235 offset:53248
    s_add_u32 m0, s50, 0x1c00
    s_add_u32 s49, s0, 0x6c000
    buffer_load_dwordx4 v241, s[20:23], s49 offen lds
    s_waitcnt vmcnt(27)
    v_mfma_f32_32x32x16_bf16 v[96:111], a[0:3], a[188:191], v[96:111]
    ds_read_b64_tr_b16 a[24:25], v234 offset:21504
    ds_read_b64_tr_b16 a[26:27], v234 offset:54272
    buffer_load_dwordx4 a[184:187], v242, s[40:43], s48 offen offset:1024 sc1
    ds_write_b128 v237, v[224:227] offset:0
    v_mfma_f32_32x32x16_bf16 v[112:127], a[4:7], a[188:191], v[112:127]
    ds_read_b64_tr_b16 a[28:29], v235 offset:21504
    ds_read_b64_tr_b16 a[30:31], v235 offset:54272
    s_add_u32 m0, s50, 0x2000
    s_add_u32 s49, s1, 0x68000
    buffer_load_dwordx4 v241, s[20:23], s49 offen lds
    s_waitcnt vmcnt(28) lgkmcnt(4)
    v_mfma_f32_32x32x16_bf16 v[96:111], a[8:11], a[72:75], v[96:111]
    ds_read_b64_tr_b16 a[32:33], v234 offset:22528
    ds_read_b64_tr_b16 a[34:35], v234 offset:55296
    s_lshr_b32 s48, s5, 4
    s_add_u32 s48, s48, s78
    s_add_u32 s48, s48, 0x6000
    buffer_load_dwordx4 a[188:191], v242, s[40:43], s48 offen sc1
    v_mfma_f32_32x32x16_bf16 v[112:127], a[12:15], a[72:75], v[112:127]
    ds_read_b64_tr_b16 a[36:37], v235 offset:22528
    ds_read_b64_tr_b16 a[38:39], v235 offset:55296
    s_add_u32 m0, s50, 0x2400
    s_add_u32 s49, s1, 0x6c000
    buffer_load_dwordx4 v241, s[20:23], s49 offen lds
    s_waitcnt vmcnt(29)
    v_mfma_f32_32x32x16_bf16 v[96:111], a[16:19], a[192:195], v[96:111]
    ds_read_b64_tr_b16 a[40:41], v234 offset:23552
    ds_read_b64_tr_b16 a[42:43], v234 offset:56320
    buffer_load_dwordx4 a[64:67], v242, s[40:43], s48 offen offset:1024 sc1
    ds_write_b128 v237, v[228:231] offset:1024
    v_mfma_f32_32x32x16_bf16 v[112:127], a[20:23], a[192:195], v[112:127]
    ds_read_b64_tr_b16 a[44:45], v235 offset:23552
    ds_read_b64_tr_b16 a[46:47], v235 offset:56320
    s_add_u32 m0, s50, 0x2800
    s_add_u32 s49, s5, 0x68000
    buffer_load_dwordx4 v241, s[20:23], s49 offen lds
    s_waitcnt vmcnt(30) lgkmcnt(4)
    v_mfma_f32_32x32x16_bf16 v[96:111], a[24:27], a[76:79], v[96:111]
    ds_read_b64_tr_b16 a[0:1], v234 offset:24576
    ds_read_b64_tr_b16 a[2:3], v234 offset:57344
    s_add_u32 m0, s50, 0x2c00
    s_add_u32 s49, s5, 0x6c000
    buffer_load_dwordx4 v241, s[20:23], s49 offen lds
    v_mfma_f32_32x32x16_bf16 v[112:127], a[28:31], a[76:79], v[112:127]
    ds_read_b64_tr_b16 a[4:5], v235 offset:24576
    ds_read_b64_tr_b16 a[6:7], v235 offset:57344
    s_waitcnt vmcnt(29)
    v_mfma_f32_32x32x16_bf16 v[96:111], a[32:35], a[48:51], v[96:111]
    ds_read_b64_tr_b16 a[8:9], v234 offset:25600
    ds_read_b64_tr_b16 a[10:11], v234 offset:58368
    v_mfma_f32_32x32x16_bf16 v[112:127], a[36:39], a[48:51], v[112:127]
    ds_read_b64_tr_b16 a[12:13], v235 offset:25600
    ds_read_b64_tr_b16 a[14:15], v235 offset:58368
    s_waitcnt vmcnt(27) lgkmcnt(6)
    v_mfma_f32_32x32x16_bf16 v[96:111], a[40:43], a[160:163], v[96:111]
    ds_read_b64_tr_b16 a[16:17], v234 offset:26624
    ds_read_b64_tr_b16 a[18:19], v234 offset:59392
    s_waitcnt vmcnt(19)
    v_cmp_ne_u32 vcc, s56, v239
    s_cbranch_vccnz L_gatespin_15
L_gateok_14:
    s_lshr_b32 s48, s81, 4
    s_add_u32 s48, s48, s78
    s_add_u32 s48, s48, 0x6800
    buffer_load_dwordx4 a[192:195], v242, s[40:43], s48 offen sc1
    v_mfma_f32_32x32x16_bf16 v[112:127], a[44:47], a[160:163], v[112:127]
    ds_read_b64_tr_b16 a[20:21], v235 offset:26624
    ds_read_b64_tr_b16 a[22:23], v235 offset:59392
    buffer_load_dwordx4 a[48:51], v242, s[40:43], s48 offen offset:1024 sc1
    v_mfma_f32_32x32x16_bf16 v[96:111], a[0:3], a[52:55], v[96:111]
    ds_read_b64_tr_b16 a[24:25], v235 offset:27648
    ds_read_b64_tr_b16 a[26:27], v235 offset:60416
    s_lshr_b32 s48, s0, 4
    s_add_u32 s48, s48, s78
    s_add_u32 s48, s48, 0x6800
    buffer_load_dwordx4 a[160:163], v242, s[40:43], s48 offen sc1
    s_waitcnt lgkmcnt(3)
    v_mfma_f32_32x32x16_bf16 v[112:127], a[4:7], a[52:55], v[112:127]
    ds_read_b64_tr_b16 a[28:29], v234 offset:27648
    ds_read_b64_tr_b16 a[30:31], v234 offset:60416
    buffer_load_dwordx4 a[68:71], v242, s[40:43], s48 offen offset:1024 sc1
    s_waitcnt vmcnt(19)
    s_barrier
    v_mfma_f32_32x32x16_bf16 v[96:111], a[8:11], a[56:59], v[96:111]
    ds_read_b64_tr_b16 a[32:33], v234 offset:28672
    ds_read_b64_tr_b16 a[34:35], v234 offset:61440
    s_lshr_b32 s48, s1, 4
    s_add_u32 s48, s48, s78
    s_add_u32 s48, s48, 0x6800
    buffer_load_dwordx4 a[52:55], v242, s[40:43], s48 offen sc1
    v_mfma_f32_32x32x16_bf16 v[112:127], a[12:15], a[56:59], v[112:127]
    ds_read_b64_tr_b16 a[36:37], v235 offset:28672
    ds_read_b64_tr_b16 a[38:39], v235 offset:61440
    buffer_load_dwordx4 a[72:75], v242, s[40:43], s48 offen offset:1024 sc1
    v_xor_b32 v32, 0, v238
    ds_read_b64 v[224:225], v32 offset:0
    v_xor_b32 v33, 16, v238
    v_mfma_f32_32x32x16_bf16 v[96:111], a[16:19], a[60:63], v[96:111]
    ds_read_b64_tr_b16 a[40:41], v234 offset:29696
    ds_read_b64_tr_b16 a[42:43], v234 offset:62464
    s_lshr_b32 s48, s5, 4
    s_add_u32 s48, s48, s78
    s_add_u32 s48, s48, 0x6800
    buffer_load_dwordx4 a[56:59], v242, s[40:43], s48 offen sc1
    s_waitcnt lgkmcnt(3)
    v_mfma_f32_32x32x16_bf16 v[112:127], a[20:23], a[60:63], v[112:127]
    ds_read_b64_tr_b16 a[44:45], v235 offset:29696
    ds_read_b64_tr_b16 a[46:47], v235 offset:62464
    buffer_load_dwordx4 a[76:79], v242, s[40:43], s48 offen offset:1024 sc1
    ds_read_b64 v[226:227], v33 offset:0
    v_xor_b32 v34, 32, v238
    v_mfma_f32_32x32x16_bf16 v[112:127], a[24:27], a[136:139], v[112:127]
    ds_read_b64_tr_b16 a[0:1], v234 offset:30720
    ds_read_b64_tr_b16 a[2:3], v234 offset:63488
    ds_read_b64 v[228:229], v34 offset:0
    v_xor_b32 v35, 48, v238
    ds_read_b64 v[230:231], v35 offset:0
    v_mfma_f32_32x32x16_bf16 v[96:111], a[28:31], a[136:139], v[96:111]
    ds_read_b64_tr_b16 a[4:5], v235 offset:30720
    ds_read_b64_tr_b16 a[6:7], v235 offset:63488
    v_mfma_f32_32x32x16_bf16 v[64:79], a[32:35], a[164:167], v[64:79]
    ds_read_b64_tr_b16 a[8:9], v234 offset:31744
    ds_read_b64_tr_b16 a[10:11], v234 offset:64512
L_padA_6:
    s_cbranch_execz L_backA
    v_mfma_f32_32x32x16_bf16 v[80:95], a[36:39], a[164:167], v[80:95]
    ds_read_b64_tr_b16 a[12:13], v235 offset:31744
    ds_read_b64_tr_b16 a[14:15], v235 offset:64512
    ds_write_b128 v232, v[112:115] offset:0
    s_waitcnt vmcnt(22) lgkmcnt(7)
    v_mfma_f32_32x32x16_bf16 v[64:79], a[40:43], a[168:171], v[64:79]
    ds_read_b64_tr_b16 a[16:17], v234 offset:0
    ds_read_b64_tr_b16 a[18:19], v234 offset:32768
    ds_write_b128 v232, v[116:119] offset:1024
    ds_write_b128 v232, v[120:123] offset:2048
    v_mfma_f32_32x32x16_bf16 v[80:95], a[44:47], a[168:171], v[80:95]
    ds_read_b64_tr_b16 a[20:21], v235 offset:0
    ds_read_b64_tr_b16 a[22:23], v235 offset:32768
    ds_write_b128 v232, v[124:127] offset:3072
    s_waitcnt vmcnt(20)
    v_mfma_f32_32x32x16_bf16 v[64:79], a[0:3], a[172:175], v[64:79]
    ds_read_b64_tr_b16 a[24:25], v234 offset:1024
    ds_read_b64_tr_b16 a[26:27], v234 offset:33792
    v_lshlrev_b32 v48, 16, v224
    v_and_b32 v49, s62, v224
    s_waitcnt lgkmcnt(5)
    v_mfma_f32_32x32x16_bf16 v[80:95], a[4:7], a[172:175], v[80:95]
    ds_read_b64_tr_b16 a[28:29], v235 offset:1024
    ds_read_b64_tr_b16 a[30:31], v235 offset:33792
    v_lshlrev_b32 v50, 16, v225
    v_and_b32 v51, s62, v225
    v_lshlrev_b32 v52, 16, v226
    v_and_b32 v53, s62, v226
    s_waitcnt vmcnt(18)
    v_mfma_f32_32x32x16_bf16 v[64:79], a[8:11], a[176:179], v[64:79]
    ds_read_b64_tr_b16 a[32:33], v234 offset:2048
    ds_read_b64_tr_b16 a[34:35], v234 offset:34816
    v_lshlrev_b32 v54, 16, v227
    v_and_b32 v55, s62, v227
    v_lshlrev_b32 v56, 16, v228
    v_and_b32 v57, s62, v228
    v_lshlrev_b32 v58, 16, v229
    v_mfma_f32_32x32x16_bf16 v[80:95], a[12:15], a[176:179], v[80:95]
    ds_read_b64_tr_b16 a[36:37], v235 offset:2048
    ds_read_b64_tr_b16 a[38:39], v235 offset:34816
    v_and_b32 v59, s62, v229
    v_lshlrev_b32 v60, 16, v230
    v_and_b32 v61, s62, v230
    v_lshlrev_b32 v62, 16, v231
    s_waitcnt vmcnt(16)
    v_mfma_f32_32x32x16_bf16 v[64:79], a[16:19], a[180:183], v[64:79]
    ds_read_b64_tr_b16 a[40:41], v234 offset:3072
    ds_read_b64_tr_b16 a[42:43], v234 offset:35840
    v_and_b32 v63, s62, v231
    s_waitcnt lgkmcnt(2)
    v_mfma_f32_32x32x16_bf16 v[80:95], a[20:23], a[180:183], v[80:95]
    ds_read_b64_tr_b16 a[44:45], v235 offset:3072
    ds_read_b64_tr_b16 a[46:47], v235 offset:35840
    s_waitcnt vmcnt(8)
    s_barrier
    v_mfma_f32_32x32x16_bf16 v[64:79], a[24:27], a[184:187], v[64:79]
    ds_read_b64_tr_b16 a[0:1], v235 offset:4096
    ds_read_b64_tr_b16 a[2:3], v235 offset:36864
    ds_read_b128 v[16:19], v233 offset:0
    ds_read_b128 v[20:23], v233 offset:1024
    ds_read_b128 v[24:27], v233 offset:2048
    ds_read_b128 v[28:31], v233 offset:3072
    v_mfma_f32_32x32x16_bf16 v[80:95], a[28:31], a[184:187], v[80:95]
    ds_read_b64_tr_b16 a[4:5], v235 offset:5120
    ds_read_b64_tr_b16 a[6:7], v235 offset:37888
    v_mfma_f32_32x32x16_bf16 v[64:79], a[32:35], a[188:191], v[64:79]
    ds_read_b64_tr_b16 a[8:9], v235 offset:6144
    ds_read_b64_tr_b16 a[10:11], v235 offset:38912
    v_mfma_f32_32x32x16_bf16 v[80:95], a[36:39], a[188:191], v[80:95]
    ds_read_b64_tr_b16 a[12:13], v235 offset:7168
    ds_read_b64_tr_b16 a[14:15], v235 offset:39936
    s_waitcnt lgkmcnt(6)
    v_mfma_f32_32x32x16_bf16 v[64:79], a[40:43], a[64:67], v[64:79]
    ds_read_b64_tr_b16 a[16:17], v235 offset:8192
    ds_read_b64_tr_b16 a[18:19], v235 offset:40960
    v_add_f32 v16, v16, v96
    v_add_f32 v17, v17, v97
    v_add_f32 v18, v18, v98
    v_add_f32 v19, v19, v99
    v_add_f32 v20, v20, v100
    v_mfma_f32_32x32x16_bf16 v[80:95], a[44:47], a[64:67], v[80:95]
    ds_read_b64_tr_b16 a[20:21], v235 offset:9216
    ds_read_b64_tr_b16 a[22:23], v235 offset:41984
    v_add_f32 v21, v21, v101
    v_add_f32 v22, v22, v102
    v_add_f32 v23, v23, v103
    v_add_f32 v24, v24, v104
    s_waitcnt vmcnt(7)
    v_mfma_f32_32x32x16_bf16 v[80:95], a[0:3], a[192:195], v[80:95]
    ds_read_b64_tr_b16 a[24:25], v235 offset:10240
    ds_read_b64_tr_b16 a[26:27], v235 offset:43008
    v_add_f32 v25, v25, v105
    v_add_f32 v26, v26, v106
    v_add_f32 v27, v27, v107
    v_add_f32 v28, v28, v108
    s_waitcnt vmcnt(6) lgkmcnt(2)
    v_mfma_f32_32x32x16_bf16 v[80:95], a[4:7], a[48:51], v[80:95]
    ds_read_b64_tr_b16 a[28:29], v235 offset:11264
    ds_read_b64_tr_b16 a[30:31], v235 offset:44032
    v_add_f32 v29, v29, v109
    v_add_f32 v30, v30, v110
    v_add_f32 v31, v31, v111
    v_mov_b32 v38, 0xbfb8aa3b
    s_waitcnt vmcnt(5)
    v_mfma_f32_32x32x16_bf16 v[80:95], a[8:11], a[160:163], v[80:95]
    ds_read_b64_tr_b16 a[32:33], v234 offset:4096
    ds_read_b64_tr_b16 a[34:35], v234 offset:36864
    v_mov_b32 v39, 0xbfb8aa3b
    v_mov_b32 v40, 1.0
    v_mov_b32 v41, 1.0
    s_waitcnt vmcnt(4)
    v_mfma_f32_32x32x16_bf16 v[80:95], a[12:15], a[68:71], v[80:95]
    ds_read_b64_tr_b16 a[36:37], v234 offset:5120
    ds_read_b64_tr_b16 a[38:39], v234 offset:37888
    s_waitcnt vmcnt(3)
    v_mfma_f32_32x32x16_bf16 v[80:95], a[16:19], a[52:55], v[80:95]
    ds_read_b64_tr_b16 a[40:41], v234 offset:6144
    ds_read_b64_tr_b16 a[42:43], v234 offset:38912
    s_waitcnt vmcnt(2)
    v_mfma_f32_32x32x16_bf16 v[80:95], a[20:23], a[72:75], v[80:95]
    ds_read_b64_tr_b16 a[44:45], v234 offset:7168
    ds_read_b64_tr_b16 a[46:47], v234 offset:39936
    s_waitcnt vmcnt(1) lgkmcnt(5)
    v_mfma_f32_32x32x16_bf16 v[80:95], a[24:27], a[56:59], v[80:95]
    ds_read_b64_tr_b16 a[0:1], v234 offset:8192
    ds_read_b64_tr_b16 a[2:3], v234 offset:40960
    s_waitcnt vmcnt(0)
    v_mfma_f32_32x32x16_bf16 v[80:95], a[28:31], a[76:79], v[80:95]
    ds_read_b64_tr_b16 a[4:5], v234 offset:9216
    ds_read_b64_tr_b16 a[6:7], v234 offset:41984
    v_mfma_f32_32x32x16_bf16 v[64:79], a[32:35], a[192:195], v[64:79]
    ds_read_b64_tr_b16 a[8:9], v234 offset:10240
    ds_read_b64_tr_b16 a[10:11], v234 offset:43008
    s_waitcnt lgkmcnt(6)
    v_mfma_f32_32x32x16_bf16 v[64:79], a[36:39], a[48:51], v[64:79]
    ds_read_b64_tr_b16 a[12:13], v234 offset:11264
    ds_read_b64_tr_b16 a[14:15], v234 offset:44032
    v_mfma_f32_32x32x16_bf16 v[64:79], a[40:43], a[160:163], v[64:79]
    v_mfma_f32_32x32x16_bf16 v[64:79], a[44:47], a[68:71], v[64:79]
    s_waitcnt lgkmcnt(4)
    v_mfma_f32_32x32x16_bf16 v[64:79], a[0:3], a[52:55], v[64:79]
    ds_write_b128 v232, v[80:83] offset:16384
    ds_write_b128 v232, v[84:87] offset:17408
    ds_write_b128 v232, v[88:91] offset:18432
    v_mfma_f32_32x32x16_bf16 v[64:79], a[4:7], a[72:75], v[64:79]
    ds_write_b128 v232, v[92:95] offset:19456
    s_waitcnt lgkmcnt(4)
    v_mfma_f32_32x32x16_bf16 v[64:79], a[8:11], a[56:59], v[64:79]
    s_waitcnt lgkmcnt(0)
    s_barrier
    ds_read_b128 v[0:3], v233 offset:16384
    ds_read_b128 v[4:7], v233 offset:17408
    ds_read_b128 v[8:11], v233 offset:18432
    ds_read_b128 v[12:15], v233 offset:19456
    v_mfma_f32_32x32x16_bf16 v[64:79], a[12:15], a[76:79], v[64:79]
    s_waitcnt lgkmcnt(3)
    s_nop 10
    v_pk_add_f32 v[0:1], v[0:1], v[64:65]
    v_pk_add_f32 v[2:3], v[2:3], v[66:67]
    v_pk_mul_f32 v[112:113], v[0:1], v[38:39]
    v_pk_mul_f32 v[114:115], v[2:3], v[38:39]
    v_pk_mul_f32 v[0:1], v[0:1], v[16:17]
    v_pk_mul_f32 v[2:3], v[2:3], v[18:19]
    v_exp_f32 v112, v112
    v_exp_f32 v113, v113
    v_exp_f32 v114, v114
    v_exp_f32 v115, v115
    s_waitcnt lgkmcnt(0)
    v_pk_add_f32 v[4:5], v[4:5], v[68:69]
    v_pk_add_f32 v[6:7], v[6:7], v[70:71]
    v_pk_mul_f32 v[116:117], v[4:5], v[38:39]
    v_pk_mul_f32 v[118:119], v[6:7], v[38:39]
    v_pk_mul_f32 v[4:5], v[4:5], v[20:21]
    v_pk_mul_f32 v[6:7], v[6:7], v[22:23]
    v_exp_f32 v116, v116
    v_exp_f32 v117, v117
    v_exp_f32 v118, v118
    v_exp_f32 v119, v119
    v_pk_add_f32 v[8:9], v[8:9], v[72:73]
    v_pk_add_f32 v[10:11], v[10:11], v[74:75]
    v_pk_mul_f32 v[120:121], v[8:9], v[38:39]
    v_pk_mul_f32 v[122:123], v[10:11], v[38:39]
    v_pk_mul_f32 v[8:9], v[8:9], v[24:25]
    v_pk_mul_f32 v[10:11], v[10:11], v[26:27]
    v_exp_f32 v120, v120
    v_exp_f32 v121, v121
    v_exp_f32 v122, v122
    v_exp_f32 v123, v123
    v_pk_add_f32 v[12:13], v[12:13], v[76:77]
    v_pk_add_f32 v[14:15], v[14:15], v[78:79]
    v_pk_mul_f32 v[124:125], v[12:13], v[38:39]
    v_pk_mul_f32 v[126:127], v[14:15], v[38:39]
    v_pk_mul_f32 v[12:13], v[12:13], v[28:29]
    v_pk_mul_f32 v[14:15], v[14:15], v[30:31]
    v_exp_f32 v124, v124
    v_exp_f32 v125, v125
    v_exp_f32 v126, v126
    v_exp_f32 v127, v127
    v_pk_add_f32 v[112:113], v[112:113], v[40:41]
    v_pk_add_f32 v[114:115], v[114:115], v[40:41]
    v_rcp_f32 v112, v112
    v_rcp_f32 v113, v113
    v_rcp_f32 v114, v114
    v_rcp_f32 v115, v115
    v_pk_add_f32 v[116:117], v[116:117], v[40:41]
    v_pk_add_f32 v[118:119], v[118:119], v[40:41]
    v_rcp_f32 v116, v116
    v_rcp_f32 v117, v117
    v_rcp_f32 v118, v118
    v_rcp_f32 v119, v119
    v_pk_add_f32 v[120:121], v[120:121], v[40:41]
    v_pk_add_f32 v[122:123], v[122:123], v[40:41]
    v_rcp_f32 v120, v120
    v_rcp_f32 v121, v121
    v_rcp_f32 v122, v122
    v_rcp_f32 v123, v123
    v_pk_add_f32 v[124:125], v[124:125], v[40:41]
    v_pk_add_f32 v[126:127], v[126:127], v[40:41]
    v_rcp_f32 v124, v124
    v_rcp_f32 v125, v125
    v_rcp_f32 v126, v126
    v_rcp_f32 v127, v127
    v_pk_fma_f32 v[0:1], v[0:1], v[112:113], v[48:49]
    v_pk_fma_f32 v[2:3], v[2:3], v[114:115], v[50:51]
    v_cvt_pk_bf16_f32 v224, v0, v1
    v_cvt_pk_bf16_f32 v225, v2, v3
    ds_write_b64 v244, v[224:225] offset:0
    v_pk_fma_f32 v[4:5], v[4:5], v[116:117], v[52:53]
    v_pk_fma_f32 v[6:7], v[6:7], v[118:119], v[54:55]
    v_cvt_pk_bf16_f32 v226, v4, v5
    v_cvt_pk_bf16_f32 v227, v6, v7
    ds_write_b64 v244, v[226:227] offset:16
    v_pk_fma_f32 v[8:9], v[8:9], v[120:121], v[56:57]
    v_pk_fma_f32 v[10:11], v[10:11], v[122:123], v[58:59]
    v_cvt_pk_bf16_f32 v228, v8, v9
    v_cvt_pk_bf16_f32 v229, v10, v11
    ds_write_b64 v244, v[228:229] offset:32
    v_pk_fma_f32 v[12:13], v[12:13], v[124:125], v[60:61]
    v_pk_fma_f32 v[14:15], v[14:15], v[126:127], v[62:63]
    v_cvt_pk_bf16_f32 v230, v12, v13
    v_cvt_pk_bf16_f32 v231, v14, v15
    ds_write_b64 v244, v[230:231] offset:48
    s_waitcnt lgkmcnt(0)
    s_barrier
    ds_read_b128 v[112:115], v245 offset:0
    ds_read_b128 v[116:119], v245 offset:1152
    s_waitcnt lgkmcnt(1)
    buffer_store_dwordx4 v[112:115], v236, s[36:39], s66 offen
    s_waitcnt lgkmcnt(0)
    buffer_store_dwordx4 v[116:119], v236, s[36:39], s72 offen
    s_endpgm
L_tagspin_5:
    s_mov_b32 s64, 0
L_tagspin_5_l:
    buffer_load_dword v248, off, s[24:27], 0 sc1
    s_add_u32 s64, s64, 1
    s_waitcnt vmcnt(0)
    v_readfirstlane_b32 s56, v248
    s_cmp_ge_u32 s64, 65536
    s_cbranch_scc1 L_tagok_4
    s_cmp_eq_u32 s56, 0
    s_cbranch_scc1 L_tagspin_5_l
    s_branch L_tagok_4
L_gatespin_7:
    s_mov_b32 s64, 0
L_gatespin_7_l:
    buffer_load_dword v249, v250, s[40:43], s58 offen offset:0 sc1
    s_waitcnt vmcnt(0)
    v_cmp_ne_u32 vcc, s56, v249
    s_cbranch_vccz L_gateok_6
    s_add_u32 s64, s64, 1
    s_cmp_ge_u32 s64, 65536
    s_cbranch_scc0 L_gatespin_7_l
    s_branch L_gateok_6
L_gatespin_9:
    s_mov_b32 s64, 0
L_gatespin_9_l:
    buffer_load_dword v36, v250, s[40:43], s58 offen offset:128 sc1
    s_waitcnt vmcnt(0)
    v_cmp_ne_u32 vcc, s56, v36
    s_cbranch_vccz L_gateok_8
    s_add_u32 s64, s64, 1
    s_cmp_ge_u32 s64, 65536
    s_cbranch_scc0 L_gatespin_9_l
    s_branch L_gateok_8
L_gatespin_11:
    s_mov_b32 s64, 0
L_gatespin_11_l:
    buffer_load_dword v47, v250, s[40:43], s58 offen offset:512 sc1
    s_waitcnt vmcnt(0)
    v_cmp_ne_u32 vcc, s56, v47
    s_cbranch_vccz L_gateok_10
    s_add_u32 s64, s64, 1
    s_cmp_ge_u32 s64, 65536
    s_cbranch_scc0 L_gatespin_11_l
    s_branch L_gateok_10
L_gatespin_13:
    s_mov_b32 s64, 0
L_gatespin_13_l:
    buffer_load_dword v37, v250, s[40:43], s58 offen offset:256 sc1
    s_waitcnt vmcnt(0)
    v_cmp_ne_u32 vcc, s56, v37
    s_cbranch_vccz L_gateok_12
    s_add_u32 s64, s64, 1
    s_cmp_ge_u32 s64, 65536
    s_cbranch_scc0 L_gatespin_13_l
    s_branch L_gateok_12
L_gatespin_15:
    s_mov_b32 s64, 0
L_gatespin_15_l:
    buffer_load_dword v239, v250, s[40:43], s58 offen offset:640 sc1
    s_waitcnt vmcnt(0)
    v_cmp_ne_u32 vcc, s56, v239
    s_cbranch_vccz L_gateok_14
    s_add_u32 s64, s64, 1
    s_cmp_ge_u32 s64, 65536
    s_cbranch_scc0 L_gatespin_15_l
    s_branch L_gateok_14
L_typeB:
    v_and_b32 v200, 63, v0
    v_lshrrev_b32 v201, 6, v0
    s_and_b32 s7, s2, 7
    v_readfirstlane_b32 s3, v201
    s_and_b32 s4, s7, 1
    s_lshl_b32 s4, s4, 3
    s_and_b32 s51, s6, 7
    s_add_u32 s4, s4, s51
    s_and_b32 s5, s7, 6
    s_lshr_b32 s51, s6, 4
    s_add_u32 s5, s5, s51
    v_and_b32 v201, 7, v200
    v_lshrrev_b32 v202, 4, v200
    v_xor_b32 v201, v201, v202
    v_lshlrev_b32 v201, 4, v201
    v_lshrrev_b32 v202, 3, v200
    v_lshlrev_b32 v202, 10, v202
    v_or_b32 v204, v201, v202
    v_xor_b32 v203, 64, v204
    v_add_u32 v205, 0x1c00, v203
    v_add_u32 v206, 0x3800, v204
    v_add_u32 v207, 0x5400, v203
    s_lshl_b32 s50, s3, 15
    s_lshl_b32 s51, s4, 17
    s_add_u32 s74, s51, s50
    s_lshr_b32 s52, s6, 3
    s_add_u32 s52, s52, s6
    s_and_b32 s76, s52, 3
    s_lshl_b32 s75, s76, 8
    s_mov_b32 s42, 0x1f00000
    s_mov_b32 s43, 0x20000
    s_mul_i32 s65, s5, 12
    s_add_u32 s65, s65, 24
    s_lshl_b32 s53, s65, 5
    s_sub_u32 s53, s53, 0x100
    s_mov_b32 s34, 0x1c0400
    s_mov_b32 s35, 0x20000
    s_mov_b32 s30, 0x1c0780
    s_mov_b32 s31, 0x20000
    s_mov_b32 s46, 0x1c0b80
    s_mov_b32 s47, 0x20000
    s_mul_i32 s51, s76, 0x70000
    s_add_u32 s53, s53, s51
    v_and_b32 v201, 3, v200
    v_mul_u32_u24 v201, 0xe00, v201
    v_bfe_u32 v202, v200, 4, 1
    v_lshlrev_b32 v202, 7, v202
    v_add_u32 v242, v201, v202
    s_and_b32 s51, s6, 4
    s_and_b32 s52, s7, 1
    s_lshl_b32 s52, s52, 3
    s_add_u32 s51, s51, s52
    s_add_u32 s51, s51, s3
    s_mul_i32 s51, s51, 0x3800
    s_add_u32 s67, s51, s53
    v_and_b32 v201, 3, v200
    s_waitcnt lgkmcnt(0)
    s_mov_b32 s28, s10
    s_mov_b32 s29, s11
    s_mov_b32 s10, 0x200000
    s_mov_b32 s11, 0x20000
    s_add_u32 m0, s50, 0
    s_add_u32 s48, s74, s75
    buffer_load_dwordx4 v204, s[8:11], s48 offen lds
    buffer_load_dwordx4 v205, s[8:11], s48 offen offset:1024 lds
    buffer_load_dwordx4 v206, s[8:11], s48 offen offset:2048 lds
    buffer_load_dwordx4 v207, s[8:11], s48 offen offset:3072 lds
    s_add_u32 s75, s75, 0x80
    s_and_b32 s75, s75, 0x3ff
    s_add_u32 m0, s50, 0x1000
    s_add_u32 s48, s74, s75
    buffer_load_dwordx4 v204, s[8:11], s48 offen lds
    buffer_load_dwordx4 v205, s[8:11], s48 offen offset:1024 lds
    buffer_load_dwordx4 v206, s[8:11], s48 offen offset:2048 lds
    buffer_load_dwordx4 v207, s[8:11], s48 offen offset:3072 lds
    s_add_u32 s75, s75, 0x80
    s_and_b32 s75, s75, 0x3ff
    v_mul_u32_u24 v201, 0xc00, v201
    v_lshrrev_b32 v202, 4, v200
    v_min_u32 v202, 2, v202
    v_lshlrev_b32 v202, 10, v202
    v_add_u32 v255, v201, v202
    s_and_b32 s51, s4, 3
    s_lshl_b32 s51, s51, 5
    s_and_b32 s52, s4, 12
    s_add_u32 s51, s51, s52
    s_add_u32 s51, s51, s3
    s_mul_i32 s51, s51, 0x3000
    s_lshl_b32 s52, s5, 7
    s_add_u32 s72, s51, s52
    buffer_load_dword a199, v255, s[28:31], s72 offen
    s_sub_u32 s44, s18, 0xb80
    s_subb_u32 s45, s19, 0
    s_sub_u32 s28, s16, 0x780
    s_subb_u32 s29, s17, 0
    s_sub_u32 s32, s18, 0x400
    s_subb_u32 s33, s19, 0
    s_mov_b32 s18, 0x1c0000
    s_mov_b32 s19, 0x20000
    buffer_load_dword a199, v242, s[16:19], s67 offen
    buffer_load_dword a199, v242, s[32:35], s67 offen offset:1024
    v_and_b32 v190, 15, v200
    v_lshrrev_b32 v191, 4, v200
    v_lshrrev_b32 v193, 5, v200
    v_and_b32 v194, 1, v191
    v_lshrrev_b32 v192, 2, v190
    v_lshlrev_b32 v243, 4, v200
    s_mov_b32 s62, 0xffff0000
    s_mov_b32 s63, 0x3f803f80
    s_mov_b32 s77, 0x3b000000
    s_mov_b32 s71, 0x3eb8aa3b
    v_and_b32 v208, 31, v200
    v_lshlrev_b32 v209, 7, v208
    v_bfe_u32 v208, v200, 1, 3
    v_xor_b32 v208, v208, v193
    v_lshlrev_b32 v208, 4, v208
    v_add_u32 v209, s50, v209
    v_xor_b32 v210, 0, v208
    v_add_u32 v216, v209, v210
    v_xor_b32 v210, 32, v208
    v_add_u32 v217, v209, v210
    v_xor_b32 v210, 64, v208
    v_add_u32 v218, v209, v210
    v_xor_b32 v210, 0x60, v208
    v_add_u32 v219, v209, v210
    v_mov_b32 v220, 0
    v_mov_b32 v221, 0
    v_mov_b32 v222, 0
    v_mov_b32 v223, 0
    s_and_b32 s51, s3, 1
    s_lshl_b32 s51, s51, 4
    s_lshr_b32 s70, s3, 1
    s_lshl_b32 s52, s70, 3
    s_add_u32 s52, s52, s51
    v_lshrrev_b32 v208, 3, v200
    v_and_b32 v209, 2, v208
    v_lshlrev_b32 v209, 5, v209
    v_and_b32 v210, 7, v200
    v_lshlrev_b32 v210, 4, v210
    v_xor_b32 v210, v210, v209
    v_add_u32 v211, s52, v208
    v_mul_u32_u24 v212, 0xe00, v211
    v_add_u32 v238, v212, v210
    v_xor_b32 v213, 32, v210
    v_add_u32 v239, v212, v213
    s_mul_i32 s51, s51, 0xe00
    s_lshl_b32 s54, s65, 5
    s_add_u32 s54, s54, s51
    s_mul_i32 s51, s76, 0x70000
    s_add_u32 s54, s54, s51
    v_and_b32 v250, 3, v200
    v_lshlrev_b32 v250, 2, v250
    v_lshl_add_u32 v241, v208, 10, v210
    v_min_u32 v240, 13, v200
    v_lshlrev_b32 v240, 7, v240
    v_lshlrev_b32 v246, 5, v250
    v_and_b32 v247, 7, v200
    v_mul_u32_u24 v247, 0xe00, v247
    v_lshlrev_b32 v208, 7, v192
    v_and_b32 v209, 3, v200
    v_lshlrev_b32 v209, 3, v209
    v_add_u32 v208, v208, v209
    v_and_b32 v210, 2, v192
    v_or_b32 v211, v210, v194
    v_lshlrev_b32 v211, 5, v211
    v_lshlrev_b32 v212, 16, v193
    v_add_u32 v212, v212, v208
    v_lshlrev_b32 v213, 10, v194
    v_add_u32 v213, v213, v212
    v_xor_b32 v214, 0, v211
    v_add_u32 v232, v214, v213
    v_xor_b32 v214, 32, v211
    v_add_u32 v233, v214, v213
    v_xor_b32 v214, 64, v211
    v_add_u32 v234, v214, v213
    v_xor_b32 v214, 0x60, v211
    v_add_u32 v235, v214, v213
    v_lshlrev_b32 v212, 9, v193
    v_add_u32 v212, v212, v208
    s_lshl_b32 s51, s70, 6
    v_xor_b32 v214, s51, v211
    v_add_u32 v213, v214, v212
    v_xor_b32 v214, 64, v213
    s_lshl_b32 s51, s70, 16
    s_lshl_b32 s52, s70, 11
    s_add_u32 s52, s52, 0x20000
    v_add_u32 v251, s51, v213
    v_add_u32 v253, s52, v213
    v_add_u32 v252, s51, v214
    v_add_u32 v254, s52, v214
    s_mov_b64 exec, 0
    s_cmp_eq_u32 s3, 1
    s_cbranch_scc1 L_padB_1
    s_cmp_eq_u32 s3, 2
    s_cbranch_scc1 L_padB_2
    s_cmp_eq_u32 s3, 3
    s_cbranch_scc1 L_padB_3
    s_branch L_padB_0
L_backB:
    s_mov_b64 exec, -1
    s_add_u32 m0, s50, 0x2000
    s_add_u32 s48, s74, s75
    buffer_load_dwordx4 v204, s[8:11], s48 offen lds
    buffer_load_dwordx4 v205, s[8:11], s48 offen offset:1024 lds
    buffer_load_dwordx4 v206, s[8:11], s48 offen offset:2048 lds
    buffer_load_dwordx4 v207, s[8:11], s48 offen offset:3072 lds
    s_add_u32 s75, s75, 0x80
    s_and_b32 s75, s75, 0x3ff
    s_waitcnt vmcnt(11)
    ds_read_b128 v[0:3], v216 offset:0
    ds_read_b128 v[4:7], v217 offset:0
    ds_read_b128 v[8:11], v218 offset:0
    ds_read_b128 v[12:15], v219 offset:0
    s_add_u32 m0, s50, 0x3000
    s_add_u32 s48, s74, s75
    buffer_load_dwordx4 v204, s[8:11], s48 offen lds
    buffer_load_dwordx4 v205, s[8:11], s48 offen offset:1024 lds
    buffer_load_dwordx4 v206, s[8:11], s48 offen offset:2048 lds
    buffer_load_dwordx4 v207, s[8:11], s48 offen offset:3072 lds
    s_add_u32 s75, s75, 0x80
    s_and_b32 s75, s75, 0x3ff
    s_waitcnt vmcnt(11)
    ds_read_b128 v[16:19], v216 offset:4096
    ds_read_b128 v[20:23], v217 offset:4096
    ds_read_b128 v[24:27], v218 offset:4096
    ds_read_b128 v[28:31], v219 offset:4096
    s_add_u32 m0, s50, 0x4000
    s_add_u32 s48, s74, s75
    buffer_load_dwordx4 v204, s[8:11], s48 offen lds
    buffer_load_dwordx4 v205, s[8:11], s48 offen offset:1024 lds
    buffer_load_dwordx4 v206, s[8:11], s48 offen offset:2048 lds
    buffer_load_dwordx4 v207, s[8:11], s48 offen offset:3072 lds
    s_add_u32 s75, s75, 0x80
    s_and_b32 s75, s75, 0x3ff
    s_waitcnt lgkmcnt(1)
    v_dot2_f32_bf16 v220, v0, s63, v220
    v_dot2_f32_bf16 v222, v0, v0, v222
    v_dot2_f32_bf16 v221, v1, s63, v221
    v_dot2_f32_bf16 v223, v1, v1, v223
    v_dot2_f32_bf16 v220, v2, s63, v220
    v_dot2_f32_bf16 v222, v2, v2, v222
    v_dot2_f32_bf16 v221, v3, s63, v221
    v_dot2_f32_bf16 v223, v3, v3, v223
    v_dot2_f32_bf16 v220, v4, s63, v220
    v_dot2_f32_bf16 v222, v4, v4, v222
    v_dot2_f32_bf16 v221, v5, s63, v221
    v_dot2_f32_bf16 v223, v5, v5, v223
    v_dot2_f32_bf16 v220, v6, s63, v220
    v_dot2_f32_bf16 v222, v6, v6, v222
    v_dot2_f32_bf16 v221, v7, s63, v221
    v_dot2_f32_bf16 v223, v7, v7, v223
    v_dot2_f32_bf16 v220, v8, s63, v220
    v_dot2_f32_bf16 v222, v8, v8, v222
    v_dot2_f32_bf16 v221, v9, s63, v221
    v_dot2_f32_bf16 v223, v9, v9, v223
    v_dot2_f32_bf16 v220, v10, s63, v220
    v_dot2_f32_bf16 v222, v10, v10, v222
    v_dot2_f32_bf16 v221, v11, s63, v221
    v_dot2_f32_bf16 v223, v11, v11, v223
    v_dot2_f32_bf16 v220, v12, s63, v220
    v_dot2_f32_bf16 v222, v12, v12, v222
    v_dot2_f32_bf16 v221, v13, s63, v221
    v_dot2_f32_bf16 v223, v13, v13, v223
    v_dot2_f32_bf16 v220, v14, s63, v220
    v_dot2_f32_bf16 v222, v14, v14, v222
    v_dot2_f32_bf16 v221, v15, s63, v221
    v_dot2_f32_bf16 v223, v15, v15, v223
    s_waitcnt vmcnt(8)
    ds_read_b128 v[32:35], v216 offset:8192
    ds_read_b128 v[36:39], v217 offset:8192
    ds_read_b128 v[40:43], v218 offset:8192
    ds_read_b128 v[44:47], v219 offset:8192
    s_add_u32 m0, s50, 0x5000
    s_add_u32 s48, s74, s75
    buffer_load_dwordx4 v204, s[8:11], s48 offen lds
    buffer_load_dwordx4 v205, s[8:11], s48 offen offset:1024 lds
    buffer_load_dwordx4 v206, s[8:11], s48 offen offset:2048 lds
    buffer_load_dwordx4 v207, s[8:11], s48 offen offset:3072 lds
    s_add_u32 s75, s75, 0x80
    s_and_b32 s75, s75, 0x3ff
    v_dot2_f32_bf16 v220, v16, s63, v220
    v_dot2_f32_bf16 v222, v16, v16, v222
    v_dot2_f32_bf16 v221, v17, s63, v221
    v_dot2_f32_bf16 v223, v17, v17, v223
    v_dot2_f32_bf16 v220, v18, s63, v220
    v_dot2_f32_bf16 v222, v18, v18, v222
    v_dot2_f32_bf16 v221, v19, s63, v221
    v_dot2_f32_bf16 v223, v19, v19, v223
    v_dot2_f32_bf16 v220, v20, s63, v220
    v_dot2_f32_bf16 v222, v20, v20, v222
    v_dot2_f32_bf16 v221, v21, s63, v221
    v_dot2_f32_bf16 v223, v21, v21, v223
    v_dot2_f32_bf16 v220, v22, s63, v220
    v_dot2_f32_bf16 v222, v22, v22, v222
    v_dot2_f32_bf16 v221, v23, s63, v221
    v_dot2_f32_bf16 v223, v23, v23, v223
    v_dot2_f32_bf16 v220, v24, s63, v220
    v_dot2_f32_bf16 v222, v24, v24, v222
    v_dot2_f32_bf16 v221, v25, s63, v221
    v_dot2_f32_bf16 v223, v25, v25, v223
    v_dot2_f32_bf16 v220, v26, s63, v220
    v_dot2_f32_bf16 v222, v26, v26, v222
    v_dot2_f32_bf16 v221, v27, s63, v221
    v_dot2_f32_bf16 v223, v27, v27, v223
    s_waitcnt lgkmcnt(0)
    v_dot2_f32_bf16 v220, v28, s63, v220
    v_dot2_f32_bf16 v222, v28, v28, v222
    v_dot2_f32_bf16 v221, v29, s63, v221
    v_dot2_f32_bf16 v223, v29, v29, v223
    v_dot2_f32_bf16 v220, v30, s63, v220
    v_dot2_f32_bf16 v222, v30, v30, v222
    v_dot2_f32_bf16 v221, v31, s63, v221
    v_dot2_f32_bf16 v223, v31, v31, v223
    s_waitcnt vmcnt(8)
    ds_read_b128 v[48:51], v216 offset:12288
    ds_read_b128 v[52:55], v217 offset:12288
    ds_read_b128 v[56:59], v218 offset:12288
    ds_read_b128 v[60:63], v219 offset:12288
    s_add_u32 m0, s50, 0x6000
    s_add_u32 s48, s74, s75
    buffer_load_dwordx4 v204, s[8:11], s48 offen lds
    buffer_load_dwordx4 v205, s[8:11], s48 offen offset:1024 lds
    buffer_load_dwordx4 v206, s[8:11], s48 offen offset:2048 lds
    buffer_load_dwordx4 v207, s[8:11], s48 offen offset:3072 lds
    s_add_u32 s75, s75, 0x80
    s_and_b32 s75, s75, 0x3ff
    v_dot2_f32_bf16 v220, v32, s63, v220
    v_dot2_f32_bf16 v222, v32, v32, v222
    v_dot2_f32_bf16 v221, v33, s63, v221
    v_dot2_f32_bf16 v223, v33, v33, v223
    v_dot2_f32_bf16 v220, v34, s63, v220
    v_dot2_f32_bf16 v222, v34, v34, v222
    v_dot2_f32_bf16 v221, v35, s63, v221
    v_dot2_f32_bf16 v223, v35, v35, v223
    v_dot2_f32_bf16 v220, v36, s63, v220
    v_dot2_f32_bf16 v222, v36, v36, v222
    v_dot2_f32_bf16 v221, v37, s63, v221
    v_dot2_f32_bf16 v223, v37, v37, v223
    v_dot2_f32_bf16 v220, v38, s63, v220
    v_dot2_f32_bf16 v222, v38, v38, v222
    v_dot2_f32_bf16 v221, v39, s63, v221
    v_dot2_f32_bf16 v223, v39, v39, v223
    v_dot2_f32_bf16 v220, v40, s63, v220
    v_dot2_f32_bf16 v222, v40, v40, v222
    v_dot2_f32_bf16 v221, v41, s63, v221
    v_dot2_f32_bf16 v223, v41, v41, v223
    v_dot2_f32_bf16 v220, v42, s63, v220
    v_dot2_f32_bf16 v222, v42, v42, v222
    v_dot2_f32_bf16 v221, v43, s63, v221
    v_dot2_f32_bf16 v223, v43, v43, v223
    v_dot2_f32_bf16 v220, v44, s63, v220
    v_dot2_f32_bf16 v222, v44, v44, v222
    v_dot2_f32_bf16 v221, v45, s63, v221
    v_dot2_f32_bf16 v223, v45, v45, v223
L_padB_0:
    s_cbranch_execz L_padB_4
    v_dot2_f32_bf16 v220, v46, s63, v220
    v_dot2_f32_bf16 v222, v46, v46, v222
    v_dot2_f32_bf16 v221, v47, s63, v221
    v_dot2_f32_bf16 v223, v47, v47, v223
    s_waitcnt vmcnt(8)
    ds_read_b128 v[64:67], v216 offset:16384
    ds_read_b128 v[68:71], v217 offset:16384
    ds_read_b128 v[72:75], v218 offset:16384
    ds_read_b128 v[76:79], v219 offset:16384
    s_add_u32 m0, s50, 0x7000
    s_add_u32 s48, s74, s75
    buffer_load_dwordx4 v204, s[8:11], s48 offen lds
    buffer_load_dwordx4 v205, s[8:11], s48 offen offset:1024 lds
    buffer_load_dwordx4 v206, s[8:11], s48 offen offset:2048 lds
    buffer_load_dwordx4 v207, s[8:11], s48 offen offset:3072 lds
    s_waitcnt lgkmcnt(3)
    v_dot2_f32_bf16 v220, v48, s63, v220
    v_dot2_f32_bf16 v222, v48, v48, v222
    v_dot2_f32_bf16 v221, v49, s63, v221
    v_dot2_f32_bf16 v223, v49, v49, v223
    v_dot2_f32_bf16 v220, v50, s63, v220
    v_dot2_f32_bf16 v222, v50, v50, v222
    v_dot2_f32_bf16 v221, v51, s63, v221
    v_dot2_f32_bf16 v223, v51, v51, v223
    v_dot2_f32_bf16 v220, v52, s63, v220
    v_dot2_f32_bf16 v222, v52, v52, v222
    v_dot2_f32_bf16 v221, v53, s63, v221
    v_dot2_f32_bf16 v223, v53, v53, v223
    v_dot2_f32_bf16 v220, v54, s63, v220
    v_dot2_f32_bf16 v222, v54, v54, v222
    v_dot2_f32_bf16 v221, v55, s63, v221
    v_dot2_f32_bf16 v223, v55, v55, v223
    v_dot2_f32_bf16 v220, v56, s63, v220
    v_dot2_f32_bf16 v222, v56, v56, v222
    v_dot2_f32_bf16 v221, v57, s63, v221
    v_dot2_f32_bf16 v223, v57, v57, v223
    v_dot2_f32_bf16 v220, v58, s63, v220
    v_dot2_f32_bf16 v222, v58, v58, v222
    v_dot2_f32_bf16 v221, v59, s63, v221
    v_dot2_f32_bf16 v223, v59, v59, v223
    v_dot2_f32_bf16 v220, v60, s63, v220
    v_dot2_f32_bf16 v222, v60, v60, v222
    v_dot2_f32_bf16 v221, v61, s63, v221
    v_dot2_f32_bf16 v223, v61, v61, v223
    v_dot2_f32_bf16 v220, v62, s63, v220
    v_dot2_f32_bf16 v222, v62, v62, v222
    v_dot2_f32_bf16 v221, v63, s63, v221
    v_dot2_f32_bf16 v223, v63, v63, v223
    s_add_u32 m0, s50, 0
    s_nop 0
    buffer_load_dwordx4 v238, s[16:19], s53 offen lds
    buffer_load_dwordx4 v239, s[32:35], s53 offen offset:1024 lds
    buffer_load_dwordx4 v238, s[28:31], s53 offen offset:2048 lds
    buffer_load_dwordx4 v239, s[44:47], s53 offen offset:3072 lds
    s_add_u32 s53, s53, 0x1c000
    s_waitcnt vmcnt(12)
    ds_read_b128 v[80:83], v216 offset:20480
    ds_read_b128 v[84:87], v217 offset:20480
    ds_read_b128 v[88:91], v218 offset:20480
    ds_read_b128 v[92:95], v219 offset:20480
    v_dot2_f32_bf16 v220, v64, s63, v220
    v_dot2_f32_bf16 v222, v64, v64, v222
    v_dot2_f32_bf16 v221, v65, s63, v221
    v_dot2_f32_bf16 v223, v65, v65, v223
    v_dot2_f32_bf16 v220, v66, s63, v220
    v_dot2_f32_bf16 v222, v66, v66, v222
    v_dot2_f32_bf16 v221, v67, s63, v221
    v_dot2_f32_bf16 v223, v67, v67, v223
    s_waitcnt lgkmcnt(1)
    v_dot2_f32_bf16 v220, v68, s63, v220
    v_dot2_f32_bf16 v222, v68, v68, v222
    v_dot2_f32_bf16 v221, v69, s63, v221
    v_dot2_f32_bf16 v223, v69, v69, v223
    v_dot2_f32_bf16 v220, v70, s63, v220
    v_dot2_f32_bf16 v222, v70, v70, v222
    v_dot2_f32_bf16 v221, v71, s63, v221
    v_dot2_f32_bf16 v223, v71, v71, v223
    v_dot2_f32_bf16 v220, v72, s63, v220
    v_dot2_f32_bf16 v222, v72, v72, v222
    v_dot2_f32_bf16 v221, v73, s63, v221
    v_dot2_f32_bf16 v223, v73, v73, v223
    v_dot2_f32_bf16 v220, v74, s63, v220
    v_dot2_f32_bf16 v222, v74, v74, v222
    v_dot2_f32_bf16 v221, v75, s63, v221
    v_dot2_f32_bf16 v223, v75, v75, v223
    v_dot2_f32_bf16 v220, v76, s63, v220
    v_dot2_f32_bf16 v222, v76, v76, v222
    v_dot2_f32_bf16 v221, v77, s63, v221
    v_dot2_f32_bf16 v223, v77, v77, v223
    v_dot2_f32_bf16 v220, v78, s63, v220
    v_dot2_f32_bf16 v222, v78, v78, v222
    v_dot2_f32_bf16 v221, v79, s63, v221
    v_dot2_f32_bf16 v223, v79, v79, v223
    s_add_u32 m0, s50, 0x1000
    s_nop 0
    buffer_load_dwordx4 v238, s[16:19], s53 offen lds
    buffer_load_dwordx4 v239, s[32:35], s53 offen offset:1024 lds
    buffer_load_dwordx4 v238, s[28:31], s53 offen offset:2048 lds
    buffer_load_dwordx4 v239, s[44:47], s53 offen offset:3072 lds
    s_add_u32 s53, s53, 0x1c000
    v_dot2_f32_bf16 v220, v80, s63, v220
    v_dot2_f32_bf16 v222, v80, v80, v222
    v_dot2_f32_bf16 v221, v81, s63, v221
    v_dot2_f32_bf16 v223, v81, v81, v223
    v_dot2_f32_bf16 v220, v82, s63, v220
    v_dot2_f32_bf16 v222, v82, v82, v222
    v_dot2_f32_bf16 v221, v83, s63, v221
    v_dot2_f32_bf16 v223, v83, v83, v223
    v_dot2_f32_bf16 v220, v84, s63, v220
    v_dot2_f32_bf16 v222, v84, v84, v222
    v_dot2_f32_bf16 v221, v85, s63, v221
    v_dot2_f32_bf16 v223, v85, v85, v223
    v_dot2_f32_bf16 v220, v86, s63, v220
    v_dot2_f32_bf16 v222, v86, v86, v222
    v_dot2_f32_bf16 v221, v87, s63, v221
    v_dot2_f32_bf16 v223, v87, v87, v223
    v_dot2_f32_bf16 v220, v88, s63, v220
    v_dot2_f32_bf16 v222, v88, v88, v222
    v_dot2_f32_bf16 v221, v89, s63, v221
    v_dot2_f32_bf16 v223, v89, v89, v223
    v_dot2_f32_bf16 v220, v90, s63, v220
    v_dot2_f32_bf16 v222, v90, v90, v222
    v_dot2_f32_bf16 v221, v91, s63, v221
    v_dot2_f32_bf16 v223, v91, v91, v223
    s_waitcnt lgkmcnt(0)
    v_dot2_f32_bf16 v220, v92, s63, v220
    v_dot2_f32_bf16 v222, v92, v92, v222
    v_dot2_f32_bf16 v221, v93, s63, v221
    v_dot2_f32_bf16 v223, v93, v93, v223
    v_dot2_f32_bf16 v220, v94, s63, v220
    v_dot2_f32_bf16 v222, v94, v94, v222
    v_dot2_f32_bf16 v221, v95, s63, v221
    v_dot2_f32_bf16 v223, v95, v95, v223
    s_waitcnt vmcnt(12)
    ds_read_b128 v[96:99], v216 offset:24576
    ds_read_b128 v[100:103], v217 offset:24576
    ds_read_b128 v[104:107], v218 offset:24576
    ds_read_b128 v[108:111], v219 offset:24576
    s_add_u32 m0, s50, 0x2000
    s_nop 0
    buffer_load_dwordx4 v238, s[16:19], s53 offen lds
    buffer_load_dwordx4 v239, s[32:35], s53 offen offset:1024 lds
    buffer_load_dwordx4 v238, s[28:31], s53 offen offset:2048 lds
    buffer_load_dwordx4 v239, s[44:47], s53 offen offset:3072 lds
    s_add_u32 s53, s53, 0x1c000
    s_waitcnt lgkmcnt(2)
    v_dot2_f32_bf16 v220, v96, s63, v220
    v_dot2_f32_bf16 v222, v96, v96, v222
    v_dot2_f32_bf16 v221, v97, s63, v221
    v_dot2_f32_bf16 v223, v97, v97, v223
    v_dot2_f32_bf16 v220, v98, s63, v220
    v_dot2_f32_bf16 v222, v98, v98, v222
    v_dot2_f32_bf16 v221, v99, s63, v221
    v_dot2_f32_bf16 v223, v99, v99, v223
    v_dot2_f32_bf16 v220, v100, s63, v220
    v_dot2_f32_bf16 v222, v100, v100, v222
    v_dot2_f32_bf16 v221, v101, s63, v221
    v_dot2_f32_bf16 v223, v101, v101, v223
    v_dot2_f32_bf16 v220, v102, s63, v220
    v_dot2_f32_bf16 v222, v102, v102, v222
    v_dot2_f32_bf16 v221, v103, s63, v221
    v_dot2_f32_bf16 v223, v103, v103, v223
    s_waitcnt lgkmcnt(0)
    v_dot2_f32_bf16 v220, v104, s63, v220
    v_dot2_f32_bf16 v222, v104, v104, v222
    v_dot2_f32_bf16 v221, v105, s63, v221
    v_dot2_f32_bf16 v223, v105, v105, v223
    v_dot2_f32_bf16 v220, v106, s63, v220
    v_dot2_f32_bf16 v222, v106, v106, v222
    v_dot2_f32_bf16 v221, v107, s63, v221
    v_dot2_f32_bf16 v223, v107, v107, v223
    v_dot2_f32_bf16 v220, v108, s63, v220
    v_dot2_f32_bf16 v222, v108, v108, v222
    v_dot2_f32_bf16 v221, v109, s63, v221
    v_dot2_f32_bf16 v223, v109, v109, v223
    v_dot2_f32_bf16 v220, v110, s63, v220
    v_dot2_f32_bf16 v222, v110, v110, v222
    v_dot2_f32_bf16 v221, v111, s63, v221
    v_dot2_f32_bf16 v223, v111, v111, v223
    s_waitcnt vmcnt(12)
    ds_read_b128 v[112:115], v216 offset:28672
    ds_read_b128 v[116:119], v217 offset:28672
    ds_read_b128 v[120:123], v218 offset:28672
    ds_read_b128 v[124:127], v219 offset:28672
    s_add_u32 m0, s50, 0x3000
    s_nop 0
    buffer_load_dwordx4 v238, s[16:19], s53 offen lds
    buffer_load_dwordx4 v239, s[32:35], s53 offen offset:1024 lds
    buffer_load_dwordx4 v238, s[28:31], s53 offen offset:2048 lds
    buffer_load_dwordx4 v239, s[44:47], s53 offen offset:3072 lds
    s_add_u32 s53, s53, 0x1c000
    s_cmp_eq_u32 s76, 3
    s_cselect_b32 s55, 0x1c0000, 0
    s_sub_u32 s53, s53, s55
    s_waitcnt lgkmcnt(0)
    v_dot2_f32_bf16 v220, v112, s63, v220
    v_dot2_f32_bf16 v222, v112, v112, v222
    v_dot2_f32_bf16 v221, v113, s63, v221
    v_dot2_f32_bf16 v223, v113, v113, v223
    v_dot2_f32_bf16 v220, v114, s63, v220
    v_dot2_f32_bf16 v222, v114, v114, v222
    v_dot2_f32_bf16 v221, v115, s63, v221
    v_dot2_f32_bf16 v223, v115, v115, v223
    v_dot2_f32_bf16 v220, v116, s63, v220
    v_dot2_f32_bf16 v222, v116, v116, v222
    v_dot2_f32_bf16 v221, v117, s63, v221
    v_dot2_f32_bf16 v223, v117, v117, v223
    v_dot2_f32_bf16 v220, v118, s63, v220
    v_dot2_f32_bf16 v222, v118, v118, v222
    v_dot2_f32_bf16 v221, v119, s63, v221
    v_dot2_f32_bf16 v223, v119, v119, v223
    v_dot2_f32_bf16 v220, v120, s63, v220
    v_dot2_f32_bf16 v222, v120, v120, v222
    v_dot2_f32_bf16 v221, v121, s63, v221
    v_dot2_f32_bf16 v223, v121, v121, v223
    v_dot2_f32_bf16 v220, v122, s63, v220
    v_dot2_f32_bf16 v222, v122, v122, v222
    v_dot2_f32_bf16 v221, v123, s63, v221
    v_dot2_f32_bf16 v223, v123, v123, v223
    v_dot2_f32_bf16 v220, v124, s63, v220
    v_dot2_f32_bf16 v222, v124, v124, v222
    v_dot2_f32_bf16 v221, v125, s63, v221
    v_dot2_f32_bf16 v223, v125, v125, v223
    v_dot2_f32_bf16 v220, v126, s63, v220
    v_dot2_f32_bf16 v222, v126, v126, v222
    v_dot2_f32_bf16 v221, v127, s63, v221
    v_dot2_f32_bf16 v223, v127, v127, v223
    s_nop 1
    v_add_f32 v220, v220, v221
    v_add_f32 v222, v222, v223
    v_mov_b32 v221, v220
    v_mov_b32 v223, v222
    s_nop 0
    v_permlane32_swap_b32 v220, v221
    v_permlane32_swap_b32 v222, v223
    v_add_f32 v220, v220, v221
    v_add_f32 v222, v222, v223
    v_mul_f32 v220, s77, v220
    v_mul_f32 v221, v220, v220
    v_fma_f32 v222, v222, s77, -v221
    v_max_f32 v222, 0, v222
    v_cvt_pk_bf16_f32 v221, v220, v222
    v_and_b32 v223, s62, v221
    v_add_f32 v223, 0x3727c5ac, v223
    v_cvt_pk_bf16_f32 v223, v223, v223
    v_and_b32 v223, s62, v223
    v_sqrt_f32 v223, v223
    s_nop 0
    v_cvt_pk_bf16_f32 v223, v223, v223
    v_and_b32 v223, s62, v223
    v_rcp_f32 v244, v223
    v_lshlrev_b32 v221, 16, v221
    v_mul_f32 v245, -v221, v244
    s_waitcnt vmcnt(8)
    s_barrier
    ds_read_b64_tr_b16 a[0:1], v232 offset:0
    ds_read_b64_tr_b16 a[2:3], v232 offset:512
    ds_read_b64_tr_b16 a[4:5], v233 offset:0
    ds_read_b64_tr_b16 a[6:7], v233 offset:512
    ds_read_b64_tr_b16 a[8:9], v234 offset:0
    ds_read_b64_tr_b16 a[10:11], v234 offset:512
    ds_read_b64_tr_b16 a[12:13], v235 offset:0
    ds_read_b64_tr_b16 a[14:15], v235 offset:512
    ds_read_b64_tr_b16 a[16:17], v232 offset:2048
    ds_read_b64_tr_b16 a[18:19], v232 offset:2560
    ds_read_b64_tr_b16 a[20:21], v233 offset:2048
    ds_read_b64_tr_b16 a[22:23], v233 offset:2560
    v_lshlrev_b32 v224, 16, v0
    v_and_b32 v225, s62, v0
    v_fma_f32 v224, v224, v244, v245
    v_fma_f32 v225, v225, v244, v245
    v_cvt_pk_bf16_f32 v0, v224, v225
    v_lshlrev_b32 v226, 16, v1
    v_and_b32 v227, s62, v1
    v_fma_f32 v226, v226, v244, v245
    v_fma_f32 v227, v227, v244, v245
    v_cvt_pk_bf16_f32 v1, v226, v227
    v_lshlrev_b32 v228, 16, v2
    v_and_b32 v229, s62, v2
    v_fma_f32 v228, v228, v244, v245
    v_fma_f32 v229, v229, v244, v245
    v_cvt_pk_bf16_f32 v2, v228, v229
    v_lshlrev_b32 v230, 16, v3
    v_and_b32 v231, s62, v3
    v_fma_f32 v230, v230, v244, v245
    v_fma_f32 v231, v231, v244, v245
    v_cvt_pk_bf16_f32 v3, v230, v231
    s_waitcnt lgkmcnt(0)
    s_nop 0
    v_mfma_f32_32x32x16_bf16 v[128:143], a[0:3], v[0:3], 0
    ds_read_b64_tr_b16 a[24:25], v234 offset:2048
    ds_read_b64_tr_b16 a[26:27], v234 offset:2560
    v_lshlrev_b32 v224, 16, v4
    v_and_b32 v225, s62, v4
    v_fma_f32 v224, v224, v244, v245
    v_mfma_f32_32x32x16_bf16 v[144:159], a[4:7], v[0:3], 0
    ds_read_b64_tr_b16 a[28:29], v235 offset:2048
    ds_read_b64_tr_b16 a[30:31], v235 offset:2560
    v_fma_f32 v225, v225, v244, v245
    v_cvt_pk_bf16_f32 v4, v224, v225
    v_lshlrev_b32 v226, 16, v5
    v_and_b32 v227, s62, v5
    v_fma_f32 v226, v226, v244, v245
    v_mfma_f32_32x32x16_bf16 v[160:175], a[8:11], v[0:3], 0
    ds_read_b64_tr_b16 a[32:33], v232 offset:32768
    ds_read_b64_tr_b16 a[34:35], v232 offset:33280
    v_fma_f32 v227, v227, v244, v245
    v_cvt_pk_bf16_f32 v5, v226, v227
    v_lshlrev_b32 v228, 16, v6
    v_and_b32 v229, s62, v6
    v_mfma_f32_32x32x16_bf16 v[176:191], a[12:15], v[0:3], 0
    ds_read_b64_tr_b16 a[36:37], v233 offset:32768
    ds_read_b64_tr_b16 a[38:39], v233 offset:33280
    v_fma_f32 v228, v228, v244, v245
    v_fma_f32 v229, v229, v244, v245
    v_cvt_pk_bf16_f32 v6, v228, v229
    v_lshlrev_b32 v230, 16, v7
    v_and_b32 v231, s62, v7
    s_add_u32 m0, s50, 0x4000
    v_mfma_f32_32x32x16_bf16 v[192:207], a[16:19], v[0:3], 0
    ds_read_b64_tr_b16 a[40:41], v234 offset:32768
    ds_read_b64_tr_b16 a[42:43], v234 offset:33280
    buffer_load_dwordx4 v238, s[16:19], s53 offen lds
    v_fma_f32 v230, v230, v244, v245
    v_fma_f32 v231, v231, v244, v245
    v_mfma_f32_32x32x16_bf16 v[208:223], a[20:23], v[0:3], 0
    ds_read_b64_tr_b16 a[44:45], v235 offset:32768
    ds_read_b64_tr_b16 a[46:47], v235 offset:33280
    v_cvt_pk_bf16_f32 v7, v230, v231
    s_mov_b32 s40, s26
    s_mov_b32 s41, s27
    s_mov_b32 s26, 0x100
    s_waitcnt lgkmcnt(2)
    v_mfma_f32_32x32x16_bf16 a[112:127], a[24:27], v[0:3], 0
    ds_read_b64_tr_b16 a[0:1], v232 offset:34816
    ds_read_b64_tr_b16 a[2:3], v232 offset:35328
    buffer_load_dwordx4 v239, s[32:35], s53 offen offset:1024 lds
    s_mov_b32 s27, 0x20000
    s_mov_b32 s36, s22
    s_mov_b32 s37, s23
    v_mfma_f32_32x32x16_bf16 a[128:143], a[28:31], v[0:3], 0
    ds_read_b64_tr_b16 a[4:5], v233 offset:34816
    ds_read_b64_tr_b16 a[6:7], v233 offset:35328
    s_mov_b32 s22, 0x1c0000
    s_mov_b32 s23, 0x20000
    s_mov_b32 s14, 0x80000
    s_mov_b32 s15, 0x20000
    buffer_load_dwordx4 v238, s[28:31], s53 offen offset:2048 lds
    v_mfma_f32_32x32x16_bf16 v[128:143], a[32:35], v[4:7], v[128:143]
    ds_read_b64_tr_b16 a[8:9], v234 offset:34816
    ds_read_b64_tr_b16 a[10:11], v234 offset:35328
    s_and_b32 s68, s6, 3
    s_lshr_b32 s69, s6, 2
    s_lshl_b32 s69, s69, 7
    v_mfma_f32_32x32x16_bf16 v[144:159], a[36:39], v[4:7], v[144:159]
    ds_read_b64_tr_b16 a[12:13], v235 offset:34816
    ds_read_b64_tr_b16 a[14:15], v235 offset:35328
    buffer_load_dwordx4 v239, s[44:47], s53 offen offset:3072 lds
    s_lshl_b32 s51, s7, 3
    s_lshl_b32 s52, s68, 1
    s_add_u32 s51, s51, s52
    v_mfma_f32_32x32x16_bf16 v[160:175], a[40:43], v[4:7], v[160:175]
    ds_read_b64_tr_b16 a[16:17], v232 offset:4096
    ds_read_b64_tr_b16 a[18:19], v232 offset:4608
    s_and_b32 s52, s3, 1
    s_add_u32 s51, s51, s52
    s_lshl_b32 s58, s51, 1
    s_add_u32 s58, s58, s70
    s_waitcnt lgkmcnt(2)
    v_mfma_f32_32x32x16_bf16 v[176:191], a[44:47], v[4:7], v[176:191]
    ds_read_b64_tr_b16 a[20:21], v233 offset:4096
    ds_read_b64_tr_b16 a[22:23], v233 offset:4608
    s_add_u32 s53, s53, 0x1c000
    s_mul_i32 s58, s58, 0x400
    s_add_u32 s58, s58, 0x1c00000
    s_mul_i32 s56, s51, 0x24000
    s_lshl_b32 s66, s51, 15
    v_mfma_f32_32x32x16_bf16 v[192:207], a[0:3], v[4:7], v[192:207]
    ds_read_b64_tr_b16 a[24:25], v234 offset:4096
    ds_read_b64_tr_b16 a[26:27], v234 offset:4608
    s_and_b32 s66, s66, 0xffff7fff
    s_add_u32 s66, s66, s69
    v_lshlrev_b32 v224, 16, v8
    v_and_b32 v225, s62, v8
    v_fma_f32 v224, v224, v244, v245
    v_fma_f32 v225, v225, v244, v245
    v_cvt_pk_bf16_f32 v8, v224, v225
    v_mfma_f32_32x32x16_bf16 v[208:223], a[4:7], v[4:7], v[208:223]
    ds_read_b64_tr_b16 a[28:29], v235 offset:4096
    ds_read_b64_tr_b16 a[30:31], v235 offset:4608
    v_lshlrev_b32 v226, 16, v9
    v_and_b32 v227, s62, v9
    v_fma_f32 v226, v226, v244, v245
    v_fma_f32 v227, v227, v244, v245
    v_cvt_pk_bf16_f32 v9, v226, v227
    v_mfma_f32_32x32x16_bf16 a[112:127], a[8:11], v[4:7], a[112:127]
    ds_read_b64_tr_b16 a[32:33], v232 offset:6144
    ds_read_b64_tr_b16 a[34:35], v232 offset:6656
    v_lshlrev_b32 v228, 16, v10
    v_and_b32 v229, s62, v10
    v_fma_f32 v228, v228, v244, v245
    v_fma_f32 v229, v229, v244, v245
    v_cvt_pk_bf16_f32 v10, v228, v229
    v_mfma_f32_32x32x16_bf16 a[128:143], a[12:15], v[4:7], a[128:143]
    ds_read_b64_tr_b16 a[36:37], v233 offset:6144
    ds_read_b64_tr_b16 a[38:39], v233 offset:6656
    v_lshlrev_b32 v230, 16, v11
    v_and_b32 v231, s62, v11
    v_fma_f32 v230, v230, v244, v245
    v_fma_f32 v231, v231, v244, v245
    v_cvt_pk_bf16_f32 v11, v230, v231
    s_waitcnt lgkmcnt(2)
    s_nop 0
    v_mfma_f32_32x32x16_bf16 v[128:143], a[16:19], v[8:11], v[128:143]
    ds_read_b64_tr_b16 a[40:41], v234 offset:6144
    ds_read_b64_tr_b16 a[42:43], v234 offset:6656
    s_lshr_b32 s51, s50, 1
    s_add_u32 s66, s66, s51
    s_lshl_b32 s52, s52, 13
    v_mfma_f32_32x32x16_bf16 v[144:159], a[20:23], v[8:11], v[144:159]
    ds_read_b64_tr_b16 a[44:45], v235 offset:6144
    ds_read_b64_tr_b16 a[46:47], v235 offset:6656
    s_add_u32 s52, s52, s69
    s_mul_i32 s51, s70, 0xc000
    s_add_u32 s78, s56, s51
    s_mul_i32 s51, s70, 0xc0000
    s_add_u32 s81, s51, s52
    v_mfma_f32_32x32x16_bf16 v[160:175], a[24:27], v[8:11], v[160:175]
    ds_read_b64_tr_b16 a[0:1], v232 offset:36864
    ds_read_b64_tr_b16 a[2:3], v232 offset:37376
    s_mul_i32 s51, s70, 0x2000
    s_add_u32 s79, s56, s51
    s_mul_i32 s51, s70, 0x20000
    s_add_u32 s82, s51, s52
    v_mfma_f32_32x32x16_bf16 v[176:191], a[28:31], v[8:11], v[176:191]
    ds_read_b64_tr_b16 a[4:5], v233 offset:36864
    ds_read_b64_tr_b16 a[6:7], v233 offset:37376
    s_mul_i32 s51, s70, 0x4000
    s_add_u32 s80, s56, s51
    s_mul_i32 s51, s70, 0x40000
    s_add_u32 s83, s51, s52
    s_lshl_b32 s73, s3, 10
    v_mfma_f32_32x32x16_bf16 v[192:207], a[32:35], v[8:11], v[192:207]
    ds_read_b64_tr_b16 a[8:9], v234 offset:36864
    ds_read_b64_tr_b16 a[10:11], v234 offset:37376
    s_add_u32 s73, s73, 0x20000
    s_lshl_b32 s51, s4, 2
    s_add_u32 s51, s51, s3
    s_mul_i32 s52, s51, 0x90
    v_lshlrev_b32 v224, 16, v12
    v_and_b32 v225, s62, v12
    v_fma_f32 v224, v224, v244, v245
    v_fma_f32 v225, v225, v244, v245
    v_cvt_pk_bf16_f32 v12, v224, v225
    s_waitcnt lgkmcnt(0)
    v_mfma_f32_32x32x16_bf16 v[208:223], a[36:39], v[8:11], v[208:223]
    ds_read_b64_tr_b16 a[12:13], v235 offset:36864
    ds_read_b64_tr_b16 a[14:15], v235 offset:37376
    v_lshlrev_b32 v226, 16, v13
    v_and_b32 v227, s62, v13
    v_fma_f32 v226, v226, v244, v245
    v_fma_f32 v227, v227, v244, v245
    v_cvt_pk_bf16_f32 v13, v226, v227
    v_mfma_f32_32x32x16_bf16 a[112:127], a[40:43], v[8:11], a[112:127]
    ds_read_b64_tr_b16 a[16:17], v232 offset:38912
    ds_read_b64_tr_b16 a[18:19], v232 offset:39424
    v_lshlrev_b32 v228, 16, v14
    v_and_b32 v229, s62, v14
    v_fma_f32 v228, v228, v244, v245
    v_fma_f32 v229, v229, v244, v245
    v_cvt_pk_bf16_f32 v14, v228, v229
    v_mfma_f32_32x32x16_bf16 a[128:143], a[44:47], v[8:11], a[128:143]
    ds_read_b64_tr_b16 a[20:21], v233 offset:38912
    ds_read_b64_tr_b16 a[22:23], v233 offset:39424
    v_lshlrev_b32 v230, 16, v15
    v_and_b32 v231, s62, v15
    v_fma_f32 v230, v230, v244, v245
    v_fma_f32 v231, v231, v244, v245
    v_cvt_pk_bf16_f32 v15, v230, v231
    s_nop 1
    v_mfma_f32_32x32x16_bf16 v[128:143], a[0:3], v[12:15], v[128:143]
    ds_read_b64_tr_b16 a[24:25], v234 offset:38912
    ds_read_b64_tr_b16 a[26:27], v234 offset:39424
    s_add_u32 s61, s52, s65
    s_mul_i32 s61, s61, 0x400
    s_sub_u32 s59, s61, 0x2000
    v_mfma_f32_32x32x16_bf16 v[144:159], a[4:7], v[12:15], v[144:159]
    ds_read_b64_tr_b16 a[28:29], v235 offset:38912
    ds_read_b64_tr_b16 a[30:31], v235 offset:39424
    v_mov_b32 v242, v243
    s_lshl_b32 s51, s51, 1
    s_lshr_b32 s52, s5, 2
    s_waitcnt vmcnt(4)
    s_barrier
    v_mfma_f32_32x32x16_bf16 v[160:175], a[8:11], v[12:15], v[160:175]
    ds_read_b64_tr_b16 a[32:33], v232 offset:8192
    ds_read_b64_tr_b16 a[34:35], v232 offset:8704
    s_add_u32 m0, s50, 0x5000
    s_add_u32 s51, s51, s52
    buffer_load_dwordx4 v238, s[16:19], s53 offen lds
    s_waitcnt lgkmcnt(2)
    v_mfma_f32_32x32x16_bf16 v[176:191], a[12:15], v[12:15], v[176:191]
    ds_read_b64_tr_b16 a[36:37], v233 offset:8192
    ds_read_b64_tr_b16 a[38:39], v233 offset:8704
    buffer_load_dwordx4 v239, s[32:35], s53 offen offset:1024 lds
    s_mul_i32 s51, s51, 0x400
    s_and_b32 s52, s5, 3
    v_mfma_f32_32x32x16_bf16 v[192:207], a[16:19], v[12:15], v[192:207]
    ds_read_b64_tr_b16 a[40:41], v234 offset:8192
    ds_read_b64_tr_b16 a[42:43], v234 offset:8704
    buffer_load_dwordx4 v238, s[28:31], s53 offen offset:2048 lds
    s_lshl_b32 s52, s52, 2
    s_add_u32 s51, s51, s52
    s_add_u32 s57, s51, 0x1c00000
    v_lshlrev_b32 v224, 16, v16
    v_and_b32 v225, s62, v16
    v_fma_f32 v224, v224, v244, v245
    v_fma_f32 v225, v225, v244, v245
    v_cvt_pk_bf16_f32 v16, v224, v225
    v_mfma_f32_32x32x16_bf16 v[208:223], a[20:23], v[12:15], v[208:223]
    ds_read_b64_tr_b16 a[44:45], v235 offset:8192
    ds_read_b64_tr_b16 a[46:47], v235 offset:8704
    buffer_load_dwordx4 v239, s[44:47], s53 offen offset:3072 lds
    s_mov_b32 s38, 0x200000
    v_lshlrev_b32 v226, 16, v17
    v_and_b32 v227, s62, v17
    v_fma_f32 v226, v226, v244, v245
    v_fma_f32 v227, v227, v244, v245
    v_cvt_pk_bf16_f32 v17, v226, v227
    v_mfma_f32_32x32x16_bf16 a[112:127], a[24:27], v[12:15], a[112:127]
    ds_read_b64_tr_b16 a[0:1], v232 offset:10240
    ds_read_b64_tr_b16 a[2:3], v232 offset:10752
    s_add_u32 s53, s53, 0x1c000
    s_add_u32 m0, s50, 0
    s_mov_b32 s39, 0x20000
    buffer_load_dwordx4 v238, s[16:19], s53 offen lds
    v_lshlrev_b32 v228, 16, v18
    v_and_b32 v229, s62, v18
    v_fma_f32 v228, v228, v244, v245
    v_fma_f32 v229, v229, v244, v245
    v_cvt_pk_bf16_f32 v18, v228, v229
    v_mfma_f32_32x32x16_bf16 a[128:143], a[28:31], v[12:15], a[128:143]
    ds_read_b64_tr_b16 a[4:5], v233 offset:10240
    ds_read_b64_tr_b16 a[6:7], v233 offset:10752
    buffer_load_dwordx4 v239, s[32:35], s53 offen offset:1024 lds
    v_lshlrev_b32 v230, 16, v19
    v_and_b32 v231, s62, v19
    v_fma_f32 v230, v230, v244, v245
    v_fma_f32 v231, v231, v244, v245
    v_cvt_pk_bf16_f32 v19, v230, v231
    s_waitcnt lgkmcnt(2)
    s_nop 0
    v_mfma_f32_32x32x16_bf16 v[128:143], a[32:35], v[16:19], v[128:143]
    ds_read_b64_tr_b16 a[8:9], v234 offset:10240
    ds_read_b64_tr_b16 a[10:11], v234 offset:10752
    s_lshr_b32 s51, s81, 4
    s_sub_u32 s78, s78, s51
    s_lshr_b32 s51, s83, 4
    buffer_load_dwordx4 v238, s[28:31], s53 offen offset:2048 lds
    v_mfma_f32_32x32x16_bf16 v[144:159], a[36:39], v[16:19], v[144:159]
    ds_read_b64_tr_b16 a[12:13], v235 offset:10240
    ds_read_b64_tr_b16 a[14:15], v235 offset:10752
    s_sub_u32 s80, s80, s51
    s_add_u32 s51, s68, 3
    s_and_b32 s51, s51, 3
    v_mfma_f32_32x32x16_bf16 v[160:175], a[40:43], v[16:19], v[160:175]
    ds_read_b64_tr_b16 a[16:17], v232 offset:40960
    ds_read_b64_tr_b16 a[18:19], v232 offset:41472
    buffer_load_dwordx4 v239, s[44:47], s53 offen offset:3072 lds
    s_lshl_b32 s51, s51, 16
    s_add_u32 s69, s83, s51
    s_mul_i32 s51, s51, 3
    v_mfma_f32_32x32x16_bf16 v[176:191], a[44:47], v[16:19], v[176:191]
    ds_read_b64_tr_b16 a[20:21], v233 offset:40960
    ds_read_b64_tr_b16 a[22:23], v233 offset:41472
    s_add_u32 s5, s81, s51
    s_add_u32 s51, s68, 2
    s_and_b32 s51, s51, 3
    s_lshl_b32 s51, s51, 16
    v_mfma_f32_32x32x16_bf16 v[192:207], a[0:3], v[16:19], v[192:207]
    ds_read_b64_tr_b16 a[24:25], v234 offset:40960
    ds_read_b64_tr_b16 a[26:27], v234 offset:41472
    s_add_u32 s53, s53, 0x1c000
    s_add_u32 s7, s83, s51
L_padB_1:
    s_cbranch_execz L_padB_5
    s_mul_i32 s51, s51, 3
    s_add_u32 s1, s81, s51
    v_lshlrev_b32 v224, 16, v20
    v_and_b32 v225, s62, v20
    v_fma_f32 v224, v224, v244, v245
    v_fma_f32 v225, v225, v244, v245
    v_cvt_pk_bf16_f32 v20, v224, v225
    s_waitcnt lgkmcnt(0)
    v_mfma_f32_32x32x16_bf16 v[208:223], a[4:7], v[16:19], v[208:223]
    ds_read_b64_tr_b16 a[28:29], v235 offset:40960
    ds_read_b64_tr_b16 a[30:31], v235 offset:41472
    s_add_u32 s51, s68, 1
    s_and_b32 s51, s51, 3
    s_lshl_b32 s51, s51, 16
    v_lshlrev_b32 v226, 16, v21
    v_and_b32 v227, s62, v21
    v_fma_f32 v226, v226, v244, v245
    v_fma_f32 v227, v227, v244, v245
    v_cvt_pk_bf16_f32 v21, v226, v227
    v_mfma_f32_32x32x16_bf16 a[112:127], a[8:11], v[16:19], a[112:127]
    ds_read_b64_tr_b16 a[32:33], v232 offset:43008
    ds_read_b64_tr_b16 a[34:35], v232 offset:43520
    s_add_u32 s6, s83, s51
    s_mul_i32 s51, s51, 3
    s_add_u32 s0, s81, s51
    v_lshlrev_b32 v228, 16, v22
    v_and_b32 v229, s62, v22
    v_fma_f32 v228, v228, v244, v245
    v_fma_f32 v229, v229, v244, v245
    v_cvt_pk_bf16_f32 v22, v228, v229
    v_mfma_f32_32x32x16_bf16 a[128:143], a[12:15], v[16:19], a[128:143]
    ds_read_b64_tr_b16 a[36:37], v233 offset:43008
    ds_read_b64_tr_b16 a[38:39], v233 offset:43520
    s_add_u32 s51, s68, 0
    s_and_b32 s51, s51, 3
    s_lshl_b32 s51, s51, 16
    v_lshlrev_b32 v230, 16, v23
    v_and_b32 v231, s62, v23
    v_fma_f32 v230, v230, v244, v245
    v_fma_f32 v231, v231, v244, v245
    v_cvt_pk_bf16_f32 v23, v230, v231
    s_nop 1
    v_mfma_f32_32x32x16_bf16 v[128:143], a[16:19], v[20:23], v[128:143]
    ds_read_b64_tr_b16 a[40:41], v234 offset:43008
    ds_read_b64_tr_b16 a[42:43], v234 offset:43520
    s_add_u32 s83, s83, s51
    s_mul_i32 s51, s51, 3
    s_add_u32 s81, s81, s51
    s_lshl_b32 s75, s2, 2
    s_add_u32 s75, s75, s3
    v_mfma_f32_32x32x16_bf16 v[144:159], a[20:23], v[20:23], v[144:159]
    ds_read_b64_tr_b16 a[44:45], v235 offset:43008
    ds_read_b64_tr_b16 a[46:47], v235 offset:43520
    s_mul_i32 s67, s75, 0x700
    buffer_load_dword a199, v240, s[20:23], s67 offen
    v_mfma_f32_32x32x16_bf16 v[160:175], a[24:27], v[20:23], v[160:175]
    ds_read_b64_tr_b16 a[0:1], v232 offset:12288
    ds_read_b64_tr_b16 a[2:3], v232 offset:12800
    v_lshlrev_b32 v224, 16, v24
    v_and_b32 v225, s62, v24
    v_fma_f32 v224, v224, v244, v245
    v_fma_f32 v225, v225, v244, v245
    s_waitcnt lgkmcnt(2)
    v_mfma_f32_32x32x16_bf16 v[176:191], a[28:31], v[20:23], v[176:191]
    ds_read_b64_tr_b16 a[4:5], v233 offset:12288
    ds_read_b64_tr_b16 a[6:7], v233 offset:12800
    v_cvt_pk_bf16_f32 v24, v224, v225
    v_lshlrev_b32 v226, 16, v25
    v_and_b32 v227, s62, v25
    v_fma_f32 v226, v226, v244, v245
    v_mfma_f32_32x32x16_bf16 v[192:207], a[32:35], v[20:23], v[192:207]
    ds_read_b64_tr_b16 a[8:9], v234 offset:12288
    ds_read_b64_tr_b16 a[10:11], v234 offset:12800
    v_fma_f32 v227, v227, v244, v245
    v_cvt_pk_bf16_f32 v25, v226, v227
    v_lshlrev_b32 v228, 16, v26
    v_and_b32 v229, s62, v26
    v_fma_f32 v228, v228, v244, v245
    v_mfma_f32_32x32x16_bf16 v[208:223], a[36:39], v[20:23], v[208:223]
    ds_read_b64_tr_b16 a[12:13], v235 offset:12288
    ds_read_b64_tr_b16 a[14:15], v235 offset:12800
    v_fma_f32 v229, v229, v244, v245
    v_cvt_pk_bf16_f32 v26, v228, v229
    v_lshlrev_b32 v230, 16, v27
    v_and_b32 v231, s62, v27
    v_fma_f32 v230, v230, v244, v245
    v_mfma_f32_32x32x16_bf16 a[112:127], a[40:43], v[20:23], a[112:127]
    ds_read_b64_tr_b16 a[16:17], v232 offset:14336
    ds_read_b64_tr_b16 a[18:19], v232 offset:14848
    v_fma_f32 v231, v231, v244, v245
    v_cvt_pk_bf16_f32 v27, v230, v231
    v_lshlrev_b32 v224, 16, v28
    v_and_b32 v225, s62, v28
    v_fma_f32 v224, v224, v244, v245
    v_mfma_f32_32x32x16_bf16 a[128:143], a[44:47], v[20:23], a[128:143]
    ds_read_b64_tr_b16 a[20:21], v233 offset:14336
    ds_read_b64_tr_b16 a[22:23], v233 offset:14848
    v_fma_f32 v225, v225, v244, v245
    v_cvt_pk_bf16_f32 v28, v224, v225
    v_lshlrev_b32 v226, 16, v29
    v_and_b32 v227, s62, v29
    s_waitcnt lgkmcnt(2)
    v_mfma_f32_32x32x16_bf16 v[128:143], a[0:3], v[24:27], v[128:143]
    ds_read_b64_tr_b16 a[24:25], v234 offset:14336
    ds_read_b64_tr_b16 a[26:27], v234 offset:14848
    v_fma_f32 v226, v226, v244, v245
    v_fma_f32 v227, v227, v244, v245
    v_cvt_pk_bf16_f32 v29, v226, v227
    v_lshlrev_b32 v228, 16, v30
    v_mfma_f32_32x32x16_bf16 v[144:159], a[4:7], v[24:27], v[144:159]
    ds_read_b64_tr_b16 a[28:29], v235 offset:14336
    ds_read_b64_tr_b16 a[30:31], v235 offset:14848
    v_and_b32 v229, s62, v30
    v_fma_f32 v228, v228, v244, v245
    v_fma_f32 v229, v229, v244, v245
    v_cvt_pk_bf16_f32 v30, v228, v229
    v_lshlrev_b32 v230, 16, v31
    v_mfma_f32_32x32x16_bf16 v[160:175], a[8:11], v[24:27], v[160:175]
    ds_read_b64_tr_b16 a[32:33], v232 offset:45056
    ds_read_b64_tr_b16 a[34:35], v232 offset:45568
    v_and_b32 v231, s62, v31
    v_fma_f32 v230, v230, v244, v245
    v_fma_f32 v231, v231, v244, v245
    v_cvt_pk_bf16_f32 v31, v230, v231
    v_lshlrev_b32 v224, 16, v32
    v_mfma_f32_32x32x16_bf16 v[176:191], a[12:15], v[24:27], v[176:191]
    ds_read_b64_tr_b16 a[36:37], v233 offset:45056
    ds_read_b64_tr_b16 a[38:39], v233 offset:45568
    v_and_b32 v225, s62, v32
    v_fma_f32 v224, v224, v244, v245
    v_fma_f32 v225, v225, v244, v245
    v_cvt_pk_bf16_f32 v32, v224, v225
    v_lshlrev_b32 v226, 16, v33
    v_mfma_f32_32x32x16_bf16 v[192:207], a[16:19], v[24:27], v[192:207]
    ds_read_b64_tr_b16 a[40:41], v234 offset:45056
    ds_read_b64_tr_b16 a[42:43], v234 offset:45568
    v_and_b32 v227, s62, v33
    v_fma_f32 v226, v226, v244, v245
    v_fma_f32 v227, v227, v244, v245
    v_cvt_pk_bf16_f32 v33, v226, v227
    s_waitcnt lgkmcnt(2)
    v_mfma_f32_32x32x16_bf16 v[208:223], a[20:23], v[24:27], v[208:223]
    ds_read_b64_tr_b16 a[44:45], v235 offset:45056
    ds_read_b64_tr_b16 a[46:47], v235 offset:45568
    v_lshlrev_b32 v228, 16, v34
    v_and_b32 v229, s62, v34
    v_fma_f32 v228, v228, v244, v245
    v_fma_f32 v229, v229, v244, v245
    v_mfma_f32_32x32x16_bf16 a[112:127], a[24:27], v[24:27], a[112:127]
    ds_read_b64_tr_b16 a[0:1], v232 offset:47104
    ds_read_b64_tr_b16 a[2:3], v232 offset:47616
    v_cvt_pk_bf16_f32 v34, v228, v229
    v_lshlrev_b32 v230, 16, v35
    v_and_b32 v231, s62, v35
    v_fma_f32 v230, v230, v244, v245
    v_fma_f32 v231, v231, v244, v245
    v_mfma_f32_32x32x16_bf16 a[128:143], a[28:31], v[24:27], a[128:143]
    ds_read_b64_tr_b16 a[4:5], v233 offset:47104
    ds_read_b64_tr_b16 a[6:7], v233 offset:47616
    v_cvt_pk_bf16_f32 v35, v230, v231
    v_lshlrev_b32 v224, 16, v36
    v_and_b32 v225, s62, v36
    v_fma_f32 v224, v224, v244, v245
    v_fma_f32 v225, v225, v244, v245
    v_mfma_f32_32x32x16_bf16 v[128:143], a[32:35], v[28:31], v[128:143]
    ds_read_b64_tr_b16 a[8:9], v234 offset:47104
    ds_read_b64_tr_b16 a[10:11], v234 offset:47616
    v_cvt_pk_bf16_f32 v36, v224, v225
    v_lshlrev_b32 v226, 16, v37
    v_and_b32 v227, s62, v37
    v_fma_f32 v226, v226, v244, v245
    v_fma_f32 v227, v227, v244, v245
    v_mfma_f32_32x32x16_bf16 v[144:159], a[36:39], v[28:31], v[144:159]
    ds_read_b64_tr_b16 a[12:13], v235 offset:47104
    ds_read_b64_tr_b16 a[14:15], v235 offset:47616
    v_cvt_pk_bf16_f32 v37, v226, v227
    v_lshlrev_b32 v228, 16, v38
    s_waitcnt vmcnt(5)
    s_barrier
    s_waitcnt lgkmcnt(2)
    v_mfma_f32_32x32x16_bf16 v[160:175], a[40:43], v[28:31], v[160:175]
    ds_read_b64_tr_b16 a[16:17], v232 offset:16384
    ds_read_b64_tr_b16 a[18:19], v232 offset:16896
    s_add_u32 m0, s50, 0x1000
    v_and_b32 v229, s62, v38
    buffer_load_dwordx4 v238, s[16:19], s53 offen lds
    v_mfma_f32_32x32x16_bf16 v[176:191], a[44:47], v[28:31], v[176:191]
    ds_read_b64_tr_b16 a[20:21], v233 offset:16384
    ds_read_b64_tr_b16 a[22:23], v233 offset:16896
    buffer_load_dwordx4 v239, s[32:35], s53 offen offset:1024 lds
    v_fma_f32 v228, v228, v244, v245
    v_fma_f32 v229, v229, v244, v245
    v_cvt_pk_bf16_f32 v38, v228, v229
    v_mfma_f32_32x32x16_bf16 v[192:207], a[0:3], v[28:31], v[192:207]
    ds_read_b64_tr_b16 a[24:25], v234 offset:16384
    ds_read_b64_tr_b16 a[26:27], v234 offset:16896
    buffer_load_dwordx4 v238, s[28:31], s53 offen offset:2048 lds
    v_lshlrev_b32 v230, 16, v39
    v_and_b32 v231, s62, v39
    v_fma_f32 v230, v230, v244, v245
    v_mfma_f32_32x32x16_bf16 v[208:223], a[4:7], v[28:31], v[208:223]
    ds_read_b64_tr_b16 a[28:29], v235 offset:16384
    ds_read_b64_tr_b16 a[30:31], v235 offset:16896
    buffer_load_dwordx4 v239, s[44:47], s53 offen offset:3072 lds
    v_fma_f32 v231, v231, v244, v245
    v_cvt_pk_bf16_f32 v39, v230, v231
    v_lshlrev_b32 v224, 16, v40
    v_mfma_f32_32x32x16_bf16 a[112:127], a[8:11], v[28:31], a[112:127]
    ds_read_b64_tr_b16 a[32:33], v232 offset:18432
    ds_read_b64_tr_b16 a[34:35], v232 offset:18944
    s_add_u32 s53, s53, 0x1c000
    s_cmp_eq_u32 s76, 2
    s_cselect_b32 s55, 0x1c0000, 0
    s_sub_u32 s53, s53, s55
    s_add_u32 m0, s50, 0x2000
    s_waitcnt lgkmcnt(2)
    v_mfma_f32_32x32x16_bf16 a[128:143], a[12:15], v[28:31], a[128:143]
    ds_read_b64_tr_b16 a[36:37], v233 offset:18432
    ds_read_b64_tr_b16 a[38:39], v233 offset:18944
    buffer_load_dwordx4 v238, s[16:19], s53 offen lds
    v_and_b32 v225, s62, v40
    v_mfma_f32_32x32x16_bf16 v[128:143], a[16:19], v[32:35], v[128:143]
    ds_read_b64_tr_b16 a[40:41], v234 offset:18432
    ds_read_b64_tr_b16 a[42:43], v234 offset:18944
    buffer_load_dwordx4 v239, s[32:35], s53 offen offset:1024 lds
    v_fma_f32 v224, v224, v244, v245
    v_fma_f32 v225, v225, v244, v245
    v_cvt_pk_bf16_f32 v40, v224, v225
    v_mfma_f32_32x32x16_bf16 v[144:159], a[20:23], v[32:35], v[144:159]
    ds_read_b64_tr_b16 a[44:45], v235 offset:18432
    ds_read_b64_tr_b16 a[46:47], v235 offset:18944
    v_lshlrev_b32 v226, 16, v41
    v_and_b32 v227, s62, v41
    v_fma_f32 v226, v226, v244, v245
    v_fma_f32 v227, v227, v244, v245
    v_cvt_pk_bf16_f32 v41, v226, v227
    v_mfma_f32_32x32x16_bf16 v[160:175], a[24:27], v[32:35], v[160:175]
    ds_read_b64_tr_b16 a[0:1], v232 offset:49152
    ds_read_b64_tr_b16 a[2:3], v232 offset:49664
    buffer_load_dwordx4 v238, s[28:31], s53 offen offset:2048 lds
    v_lshlrev_b32 v228, 16, v42
    v_and_b32 v229, s62, v42
    v_fma_f32 v228, v228, v244, v245
    v_mfma_f32_32x32x16_bf16 v[176:191], a[28:31], v[32:35], v[176:191]
    ds_read_b64_tr_b16 a[4:5], v233 offset:49152
    ds_read_b64_tr_b16 a[6:7], v233 offset:49664
    v_fma_f32 v229, v229, v244, v245
    v_cvt_pk_bf16_f32 v42, v228, v229
    v_lshlrev_b32 v230, 16, v43
    v_and_b32 v231, s62, v43
    s_waitcnt lgkmcnt(2)
    v_mfma_f32_32x32x16_bf16 v[192:207], a[32:35], v[32:35], v[192:207]
    ds_read_b64_tr_b16 a[8:9], v234 offset:49152
    ds_read_b64_tr_b16 a[10:11], v234 offset:49664
    buffer_load_dwordx4 v239, s[44:47], s53 offen offset:3072 lds
    v_fma_f32 v230, v230, v244, v245
    v_fma_f32 v231, v231, v244, v245
    v_mfma_f32_32x32x16_bf16 v[208:223], a[36:39], v[32:35], v[208:223]
    ds_read_b64_tr_b16 a[12:13], v235 offset:49152
    ds_read_b64_tr_b16 a[14:15], v235 offset:49664
    v_cvt_pk_bf16_f32 v43, v230, v231
    v_lshlrev_b32 v224, 16, v44
    v_and_b32 v225, s62, v44
    v_fma_f32 v224, v224, v244, v245
    v_fma_f32 v225, v225, v244, v245
    v_mfma_f32_32x32x16_bf16 a[112:127], a[40:43], v[32:35], a[112:127]
    ds_read_b64_tr_b16 a[16:17], v232 offset:51200
    ds_read_b64_tr_b16 a[18:19], v232 offset:51712
    s_add_u32 s53, s53, 0x1c000
    s_lshl_b32 s67, s75, 9
    buffer_load_dword a199, v246, s[12:15], s67 offen
    v_cvt_pk_bf16_f32 v44, v224, v225
    v_mfma_f32_32x32x16_bf16 a[128:143], a[44:47], v[32:35], a[128:143]
    ds_read_b64_tr_b16 a[20:21], v233 offset:51200
    ds_read_b64_tr_b16 a[22:23], v233 offset:51712
    v_lshlrev_b32 v226, 16, v45
    v_and_b32 v227, s62, v45
    v_fma_f32 v226, v226, v244, v245
    v_fma_f32 v227, v227, v244, v245
    v_cvt_pk_bf16_f32 v45, v226, v227
    v_mfma_f32_32x32x16_bf16 v[128:143], a[0:3], v[36:39], v[128:143]
    ds_read_b64_tr_b16 a[24:25], v234 offset:51200
    ds_read_b64_tr_b16 a[26:27], v234 offset:51712
    buffer_load_dword a199, v240, s[40:43], s58 offen sc1
    v_lshlrev_b32 v228, 16, v46
    v_and_b32 v229, s62, v46
    s_waitcnt lgkmcnt(2)
    v_mfma_f32_32x32x16_bf16 v[144:159], a[4:7], v[36:39], v[144:159]
    ds_read_b64_tr_b16 a[28:29], v235 offset:51200
    ds_read_b64_tr_b16 a[30:31], v235 offset:51712
    v_fma_f32 v228, v228, v244, v245
    v_fma_f32 v229, v229, v244, v245
    v_cvt_pk_bf16_f32 v46, v228, v229
    v_lshlrev_b32 v230, 16, v47
    v_mfma_f32_32x32x16_bf16 v[160:175], a[8:11], v[36:39], v[160:175]
    ds_read_b64_tr_b16 a[32:33], v232 offset:20480
    ds_read_b64_tr_b16 a[34:35], v232 offset:20992
    v_and_b32 v231, s62, v47
    v_fma_f32 v230, v230, v244, v245
    v_fma_f32 v231, v231, v244, v245
    v_cvt_pk_bf16_f32 v47, v230, v231
    v_lshlrev_b32 v224, 16, v48
    v_mfma_f32_32x32x16_bf16 v[176:191], a[12:15], v[36:39], v[176:191]
    ds_read_b64_tr_b16 a[36:37], v233 offset:20480
    ds_read_b64_tr_b16 a[38:39], v233 offset:20992
    v_and_b32 v225, s62, v48
    v_fma_f32 v224, v224, v244, v245
    v_fma_f32 v225, v225, v244, v245
    v_cvt_pk_bf16_f32 v48, v224, v225
    v_lshlrev_b32 v226, 16, v49
    v_mfma_f32_32x32x16_bf16 v[192:207], a[16:19], v[36:39], v[192:207]
    ds_read_b64_tr_b16 a[40:41], v234 offset:20480
    ds_read_b64_tr_b16 a[42:43], v234 offset:20992
    v_and_b32 v227, s62, v49
    v_fma_f32 v226, v226, v244, v245
    v_fma_f32 v227, v227, v244, v245
    v_cvt_pk_bf16_f32 v49, v226, v227
    v_lshlrev_b32 v228, 16, v50
    v_mfma_f32_32x32x16_bf16 v[208:223], a[20:23], v[36:39], v[208:223]
    ds_read_b64_tr_b16 a[44:45], v235 offset:20480
    ds_read_b64_tr_b16 a[46:47], v235 offset:20992
    v_and_b32 v229, s62, v50
    v_fma_f32 v228, v228, v244, v245
    v_fma_f32 v229, v229, v244, v245
    v_cvt_pk_bf16_f32 v50, v228, v229
    s_waitcnt lgkmcnt(2)
    v_mfma_f32_32x32x16_bf16 a[112:127], a[24:27], v[36:39], a[112:127]
    ds_read_b64_tr_b16 a[0:1], v232 offset:22528
    ds_read_b64_tr_b16 a[2:3], v232 offset:23040
    v_lshlrev_b32 v230, 16, v51
    v_and_b32 v231, s62, v51
    v_fma_f32 v230, v230, v244, v245
    v_fma_f32 v231, v231, v244, v245
    v_mfma_f32_32x32x16_bf16 a[128:143], a[28:31], v[36:39], a[128:143]
    ds_read_b64_tr_b16 a[4:5], v233 offset:22528
    ds_read_b64_tr_b16 a[6:7], v233 offset:23040
    v_cvt_pk_bf16_f32 v51, v230, v231
    v_lshlrev_b32 v224, 16, v52
    v_and_b32 v225, s62, v52
    v_fma_f32 v224, v224, v244, v245
    v_fma_f32 v225, v225, v244, v245
    v_mfma_f32_32x32x16_bf16 v[128:143], a[32:35], v[40:43], v[128:143]
    ds_read_b64_tr_b16 a[8:9], v234 offset:22528
    ds_read_b64_tr_b16 a[10:11], v234 offset:23040
    v_cvt_pk_bf16_f32 v52, v224, v225
    v_lshlrev_b32 v226, 16, v53
    v_and_b32 v227, s62, v53
    v_fma_f32 v226, v226, v244, v245
    v_fma_f32 v227, v227, v244, v245
    v_mfma_f32_32x32x16_bf16 v[144:159], a[36:39], v[40:43], v[144:159]
    ds_read_b64_tr_b16 a[12:13], v235 offset:22528
    ds_read_b64_tr_b16 a[14:15], v235 offset:23040
    v_cvt_pk_bf16_f32 v53, v226, v227
    v_lshlrev_b32 v228, 16, v54
    v_and_b32 v229, s62, v54
    v_fma_f32 v228, v228, v244, v245
    v_fma_f32 v229, v229, v244, v245
    v_mfma_f32_32x32x16_bf16 v[160:175], a[40:43], v[40:43], v[160:175]
    ds_read_b64_tr_b16 a[16:17], v232 offset:53248
    ds_read_b64_tr_b16 a[18:19], v232 offset:53760
    v_cvt_pk_bf16_f32 v54, v228, v229
    v_lshlrev_b32 v230, 16, v55
    v_and_b32 v231, s62, v55
    v_fma_f32 v230, v230, v244, v245
    s_waitcnt lgkmcnt(2)
    v_mfma_f32_32x32x16_bf16 v[176:191], a[44:47], v[40:43], v[176:191]
    ds_read_b64_tr_b16 a[20:21], v233 offset:53248
    ds_read_b64_tr_b16 a[22:23], v233 offset:53760
    v_fma_f32 v231, v231, v244, v245
    v_cvt_pk_bf16_f32 v55, v230, v231
    v_lshlrev_b32 v224, 16, v56
    v_and_b32 v225, s62, v56
    v_mfma_f32_32x32x16_bf16 v[192:207], a[0:3], v[40:43], v[192:207]
    ds_read_b64_tr_b16 a[24:25], v234 offset:53248
    ds_read_b64_tr_b16 a[26:27], v234 offset:53760
    v_fma_f32 v224, v224, v244, v245
    v_fma_f32 v225, v225, v244, v245
    v_cvt_pk_bf16_f32 v56, v224, v225
    v_lshlrev_b32 v226, 16, v57
    v_and_b32 v227, s62, v57
    v_mfma_f32_32x32x16_bf16 v[208:223], a[4:7], v[40:43], v[208:223]
    ds_read_b64_tr_b16 a[28:29], v235 offset:53248
    ds_read_b64_tr_b16 a[30:31], v235 offset:53760
    v_fma_f32 v226, v226, v244, v245
    v_fma_f32 v227, v227, v244, v245
    v_cvt_pk_bf16_f32 v57, v226, v227
    v_lshlrev_b32 v228, 16, v58
    v_and_b32 v229, s62, v58
    v_mfma_f32_32x32x16_bf16 a[112:127], a[8:11], v[40:43], a[112:127]
    ds_read_b64_tr_b16 a[32:33], v232 offset:55296
    ds_read_b64_tr_b16 a[34:35], v232 offset:55808
    v_fma_f32 v228, v228, v244, v245
    v_fma_f32 v229, v229, v244, v245
    v_cvt_pk_bf16_f32 v58, v228, v229
    v_lshlrev_b32 v230, 16, v59
    v_and_b32 v231, s62, v59
    v_mfma_f32_32x32x16_bf16 a[128:143], a[12:15], v[40:43], a[128:143]
    ds_read_b64_tr_b16 a[36:37], v233 offset:55296
    ds_read_b64_tr_b16 a[38:39], v233 offset:55808
    v_fma_f32 v230, v230, v244, v245
    v_fma_f32 v231, v231, v244, v245
    v_cvt_pk_bf16_f32 v59, v230, v231
    v_lshlrev_b32 v224, 16, v60
    s_waitcnt lgkmcnt(2)
    v_mfma_f32_32x32x16_bf16 v[128:143], a[16:19], v[44:47], v[128:143]
    ds_read_b64_tr_b16 a[40:41], v234 offset:55296
    ds_read_b64_tr_b16 a[42:43], v234 offset:55808
    v_and_b32 v225, s62, v60
    v_fma_f32 v224, v224, v244, v245
    v_fma_f32 v225, v225, v244, v245
    v_cvt_pk_bf16_f32 v60, v224, v225
    v_mfma_f32_32x32x16_bf16 v[144:159], a[20:23], v[44:47], v[144:159]
    ds_read_b64_tr_b16 a[44:45], v235 offset:55296
    ds_read_b64_tr_b16 a[46:47], v235 offset:55808
    v_lshlrev_b32 v226, 16, v61
    v_and_b32 v227, s62, v61
    v_fma_f32 v226, v226, v244, v245
    s_waitcnt vmcnt(6)
    s_barrier
    v_mfma_f32_32x32x16_bf16 v[160:175], a[24:27], v[44:47], v[160:175]
    ds_read_b64_tr_b16 a[0:1], v232 offset:0
    ds_read_b64_tr_b16 a[2:3], v232 offset:512
    s_add_u32 m0, s50, 0x3000
    v_fma_f32 v227, v227, v244, v245
    buffer_load_dwordx4 v238, s[16:19], s53 offen lds
    v_cvt_pk_bf16_f32 v61, v226, v227
    v_mfma_f32_32x32x16_bf16 v[176:191], a[28:31], v[44:47], v[176:191]
    ds_read_b64_tr_b16 a[4:5], v233 offset:0
    ds_read_b64_tr_b16 a[6:7], v233 offset:512
    buffer_load_dwordx4 v239, s[32:35], s53 offen offset:1024 lds
    v_lshlrev_b32 v228, 16, v62
    v_and_b32 v229, s62, v62
    v_fma_f32 v228, v228, v244, v245
    v_mfma_f32_32x32x16_bf16 v[192:207], a[32:35], v[44:47], v[192:207]
    ds_read_b64_tr_b16 a[8:9], v234 offset:0
    ds_read_b64_tr_b16 a[10:11], v234 offset:512
    buffer_load_dwordx4 v238, s[28:31], s53 offen offset:2048 lds
    v_fma_f32 v229, v229, v244, v245
    v_cvt_pk_bf16_f32 v62, v228, v229
    s_waitcnt lgkmcnt(2)
    v_mfma_f32_32x32x16_bf16 v[208:223], a[36:39], v[44:47], v[208:223]
    ds_read_b64_tr_b16 a[12:13], v235 offset:0
    ds_read_b64_tr_b16 a[14:15], v235 offset:512
    buffer_load_dwordx4 v239, s[44:47], s53 offen offset:3072 lds
    v_lshlrev_b32 v230, 16, v63
    v_and_b32 v231, s62, v63
    v_mfma_f32_32x32x16_bf16 a[112:127], a[40:43], v[44:47], a[112:127]
    ds_read_b64_tr_b16 a[16:17], v232 offset:2048
    ds_read_b64_tr_b16 a[18:19], v232 offset:2560
    s_add_u32 s53, s53, 0x1c000
    s_add_u32 m0, s50, 0x4000
    v_fma_f32 v230, v230, v244, v245
    buffer_load_dwordx4 v238, s[16:19], s53 offen lds
    v_mfma_f32_32x32x16_bf16 a[128:143], a[44:47], v[44:47], a[128:143]
    ds_read_b64_tr_b16 a[20:21], v233 offset:2048
    ds_read_b64_tr_b16 a[22:23], v233 offset:2560
    v_fma_f32 v231, v231, v244, v245
    v_cvt_pk_bf16_f32 v63, v230, v231
    v_lshlrev_b32 v224, 16, v64
    v_and_b32 v225, s62, v64
    v_fma_f32 v224, v224, v244, v245
    v_mfma_f32_32x32x16_bf16 v[128:143], a[0:3], v[48:51], v[128:143]
    ds_read_b64_tr_b16 a[24:25], v234 offset:2048
    ds_read_b64_tr_b16 a[26:27], v234 offset:2560
    buffer_load_dwordx4 v239, s[32:35], s53 offen offset:1024 lds
    v_fma_f32 v225, v225, v244, v245
    v_cvt_pk_bf16_f32 v64, v224, v225
    v_lshlrev_b32 v226, 16, v65
    v_mfma_f32_32x32x16_bf16 v[144:159], a[4:7], v[48:51], v[144:159]
    ds_read_b64_tr_b16 a[28:29], v235 offset:2048
    ds_read_b64_tr_b16 a[30:31], v235 offset:2560
    v_and_b32 v227, s62, v65
    v_fma_f32 v226, v226, v244, v245
    v_fma_f32 v227, v227, v244, v245
    v_cvt_pk_bf16_f32 v65, v226, v227
    s_waitcnt lgkmcnt(2)
    v_mfma_f32_32x32x16_bf16 v[160:175], a[8:11], v[48:51], v[160:175]
    ds_read_b64_tr_b16 a[32:33], v232 offset:32768
    ds_read_b64_tr_b16 a[34:35], v232 offset:33280
    buffer_load_dwordx4 v238, s[28:31], s53 offen offset:2048 lds
    v_lshlrev_b32 v228, 16, v66
    v_and_b32 v229, s62, v66
    v_mfma_f32_32x32x16_bf16 v[176:191], a[12:15], v[48:51], v[176:191]
    ds_read_b64_tr_b16 a[36:37], v233 offset:32768
    ds_read_b64_tr_b16 a[38:39], v233 offset:33280
    v_fma_f32 v228, v228, v244, v245
    v_fma_f32 v229, v229, v244, v245
    v_cvt_pk_bf16_f32 v66, v228, v229
    v_lshlrev_b32 v230, 16, v67
    v_and_b32 v231, s62, v67
    v_mfma_f32_32x32x16_bf16 v[192:207], a[16:19], v[48:51], v[192:207]
    ds_read_b64_tr_b16 a[40:41], v234 offset:32768
    ds_read_b64_tr_b16 a[42:43], v234 offset:33280
    buffer_load_dwordx4 v239, s[44:47], s53 offen offset:3072 lds
    v_fma_f32 v230, v230, v244, v245
    v_fma_f32 v231, v231, v244, v245
    v_cvt_pk_bf16_f32 v67, v230, v231
    v_mfma_f32_32x32x16_bf16 v[208:223], a[20:23], v[48:51], v[208:223]
    ds_read_b64_tr_b16 a[44:45], v235 offset:32768
    ds_read_b64_tr_b16 a[46:47], v235 offset:33280
    v_lshlrev_b32 v224, 16, v68
    v_and_b32 v225, s62, v68
    v_fma_f32 v224, v224, v244, v245
    v_fma_f32 v225, v225, v244, v245
    v_cvt_pk_bf16_f32 v68, v224, v225
    v_mfma_f32_32x32x16_bf16 a[112:127], a[24:27], v[48:51], a[112:127]
    ds_read_b64_tr_b16 a[0:1], v232 offset:34816
    ds_read_b64_tr_b16 a[2:3], v232 offset:35328
    s_add_u32 s53, s53, 0x1c000
    s_add_u32 m0, s50, 0x6000
    s_add_u32 s49, s81, 0x40000
    buffer_load_dwordx4 v241, s[20:23], s49 offen lds
    s_waitcnt lgkmcnt(2)
    v_mfma_f32_32x32x16_bf16 a[128:143], a[28:31], v[48:51], a[128:143]
    ds_read_b64_tr_b16 a[4:5], v233 offset:34816
    ds_read_b64_tr_b16 a[6:7], v233 offset:35328
    s_and_b32 s67, s3, 3
    s_mul_i32 s67, s67, 8
    v_lshlrev_b32 v226, 16, v69
    v_mfma_f32_32x32x16_bf16 v[128:143], a[32:35], v[52:55], v[128:143]
    ds_read_b64_tr_b16 a[8:9], v234 offset:34816
    ds_read_b64_tr_b16 a[10:11], v234 offset:35328
    s_lshl_b32 s75, s4, 5
    s_add_u32 s67, s67, s75
    s_mul_i32 s67, s67, 0xe00
    s_lshl_b32 s75, s65, 5
    s_add_u32 s67, s67, s75
    buffer_load_dword a199, v247, s[16:19], s67 offen
    v_mfma_f32_32x32x16_bf16 v[144:159], a[36:39], v[52:55], v[144:159]
    ds_read_b64_tr_b16 a[12:13], v235 offset:34816
    ds_read_b64_tr_b16 a[14:15], v235 offset:35328
    v_and_b32 v227, s62, v69
    v_fma_f32 v226, v226, v244, v245
    v_fma_f32 v227, v227, v244, v245
    v_mfma_f32_32x32x16_bf16 v[160:175], a[40:43], v[52:55], v[160:175]
    ds_read_b64_tr_b16 a[16:17], v232 offset:4096
    ds_read_b64_tr_b16 a[18:19], v232 offset:4608
    buffer_load_dword a199, v247, s[32:35], s67 offen offset:1024
    v_cvt_pk_bf16_f32 v69, v226, v227
    v_lshlrev_b32 v228, 16, v70
    v_and_b32 v229, s62, v70
    v_mfma_f32_32x32x16_bf16 v[176:191], a[44:47], v[52:55], v[176:191]
    ds_read_b64_tr_b16 a[20:21], v233 offset:4096
    ds_read_b64_tr_b16 a[22:23], v233 offset:4608
    v_fma_f32 v228, v228, v244, v245
    v_fma_f32 v229, v229, v244, v245
    v_cvt_pk_bf16_f32 v70, v228, v229
    v_lshlrev_b32 v230, 16, v71
    s_waitcnt lgkmcnt(2)
    v_mfma_f32_32x32x16_bf16 v[192:207], a[0:3], v[52:55], v[192:207]
    ds_read_b64_tr_b16 a[24:25], v234 offset:4096
    ds_read_b64_tr_b16 a[26:27], v234 offset:4608
    s_add_u32 m0, s50, 0x6400
    s_add_u32 s49, s81, 0x44000
    buffer_load_dwordx4 v241, s[20:23], s49 offen lds
    v_mfma_f32_32x32x16_bf16 v[208:223], a[4:7], v[52:55], v[208:223]
    ds_read_b64_tr_b16 a[28:29], v235 offset:4096
    ds_read_b64_tr_b16 a[30:31], v235 offset:4608
    v_and_b32 v231, s62, v71
    v_fma_f32 v230, v230, v244, v245
    v_fma_f32 v231, v231, v244, v245
    v_cvt_pk_bf16_f32 v71, v230, v231
    v_lshlrev_b32 v224, 16, v72
    v_mfma_f32_32x32x16_bf16 a[112:127], a[8:11], v[52:55], a[112:127]
    ds_read_b64_tr_b16 a[32:33], v232 offset:6144
    ds_read_b64_tr_b16 a[34:35], v232 offset:6656
    s_add_u32 m0, s50, 0x6800
    s_add_u32 s49, s81, 0x48000
    buffer_load_dwordx4 v241, s[20:23], s49 offen lds
    v_and_b32 v225, s62, v72
    v_mfma_f32_32x32x16_bf16 a[128:143], a[12:15], v[52:55], a[128:143]
    ds_read_b64_tr_b16 a[36:37], v233 offset:6144
    ds_read_b64_tr_b16 a[38:39], v233 offset:6656
    v_fma_f32 v224, v224, v244, v245
    v_fma_f32 v225, v225, v244, v245
    v_cvt_pk_bf16_f32 v72, v224, v225
    v_lshlrev_b32 v226, 16, v73
    v_and_b32 v227, s62, v73
    s_add_u32 m0, s50, 0x6c00
    s_add_u32 s49, s81, 0x4c000
    v_mfma_f32_32x32x16_bf16 v[128:143], a[16:19], v[56:59], v[128:143]
    ds_read_b64_tr_b16 a[40:41], v234 offset:6144
    ds_read_b64_tr_b16 a[42:43], v234 offset:6656
    buffer_load_dwordx4 v241, s[20:23], s49 offen lds
    s_waitcnt lgkmcnt(2)
    v_mfma_f32_32x32x16_bf16 v[144:159], a[20:23], v[56:59], v[144:159]
    ds_read_b64_tr_b16 a[44:45], v235 offset:6144
    ds_read_b64_tr_b16 a[46:47], v235 offset:6656
    v_fma_f32 v226, v226, v244, v245
L_padB_2:
    s_cbranch_execz L_padB_6
    v_fma_f32 v227, v227, v244, v245
    v_cvt_pk_bf16_f32 v73, v226, v227
    v_lshlrev_b32 v228, 16, v74
    v_and_b32 v229, s62, v74
    s_add_u32 m0, s50, 0x7000
    s_add_u32 s49, s81, 0x50000
    v_mfma_f32_32x32x16_bf16 v[160:175], a[24:27], v[56:59], v[160:175]
    ds_read_b64_tr_b16 a[0:1], v232 offset:36864
    ds_read_b64_tr_b16 a[2:3], v232 offset:37376
    buffer_load_dwordx4 v241, s[20:23], s49 offen lds
    v_fma_f32 v228, v228, v244, v245
    v_mfma_f32_32x32x16_bf16 v[176:191], a[28:31], v[56:59], v[176:191]
    ds_read_b64_tr_b16 a[4:5], v233 offset:36864
    ds_read_b64_tr_b16 a[6:7], v233 offset:37376
    v_fma_f32 v229, v229, v244, v245
    v_cvt_pk_bf16_f32 v74, v228, v229
    v_lshlrev_b32 v230, 16, v75
    v_and_b32 v231, s62, v75
    v_fma_f32 v230, v230, v244, v245
    s_add_u32 m0, s50, 0x7400
    s_add_u32 s49, s81, 0x54000
    v_mfma_f32_32x32x16_bf16 v[192:207], a[32:35], v[56:59], v[192:207]
    ds_read_b64_tr_b16 a[8:9], v234 offset:36864
    ds_read_b64_tr_b16 a[10:11], v234 offset:37376
    buffer_load_dwordx4 v241, s[20:23], s49 offen lds
    v_fma_f32 v231, v231, v244, v245
    v_mfma_f32_32x32x16_bf16 v[208:223], a[36:39], v[56:59], v[208:223]
    ds_read_b64_tr_b16 a[12:13], v235 offset:36864
    ds_read_b64_tr_b16 a[14:15], v235 offset:37376
    v_cvt_pk_bf16_f32 v75, v230, v231
    v_lshlrev_b32 v224, 16, v76
    v_and_b32 v225, s62, v76
    v_fma_f32 v224, v224, v244, v245
    s_waitcnt lgkmcnt(2)
    v_mfma_f32_32x32x16_bf16 a[112:127], a[40:43], v[56:59], a[112:127]
    ds_read_b64_tr_b16 a[16:17], v232 offset:38912
    ds_read_b64_tr_b16 a[18:19], v232 offset:39424
    s_add_u32 m0, s50, 0x7800
    s_add_u32 s49, s81, 0x58000
    buffer_load_dwordx4 v241, s[20:23], s49 offen lds
    v_mfma_f32_32x32x16_bf16 a[128:143], a[44:47], v[56:59], a[128:143]
    ds_read_b64_tr_b16 a[20:21], v233 offset:38912
    ds_read_b64_tr_b16 a[22:23], v233 offset:39424
    v_fma_f32 v225, v225, v244, v245
    v_cvt_pk_bf16_f32 v76, v224, v225
    v_lshlrev_b32 v226, 16, v77
    v_and_b32 v227, s62, v77
    v_fma_f32 v226, v226, v244, v245
    v_mfma_f32_32x32x16_bf16 v[128:143], a[0:3], v[60:63], v[128:143]
    ds_read_b64_tr_b16 a[24:25], v234 offset:38912
    ds_read_b64_tr_b16 a[26:27], v234 offset:39424
    s_add_u32 m0, s50, 0x7c00
    s_add_u32 s49, s81, 0x5c000
    buffer_load_dwordx4 v241, s[20:23], s49 offen lds
    v_fma_f32 v227, v227, v244, v245
    v_mfma_f32_32x32x16_bf16 v[144:159], a[4:7], v[60:63], v[144:159]
    ds_read_b64_tr_b16 a[28:29], v235 offset:38912
    ds_read_b64_tr_b16 a[30:31], v235 offset:39424
    v_cvt_pk_bf16_f32 v77, v226, v227
    v_lshlrev_b32 v228, 16, v78
    v_and_b32 v229, s62, v78
    s_waitcnt vmcnt(14)
    s_barrier
    v_mfma_f32_32x32x16_bf16 v[160:175], a[8:11], v[60:63], v[160:175]
    ds_read_b64_tr_b16 a[32:33], v232 offset:8192
    ds_read_b64_tr_b16 a[34:35], v232 offset:8704
    s_add_u32 m0, s50, 0x5000
    v_fma_f32 v228, v228, v244, v245
    buffer_load_dwordx4 v238, s[16:19], s53 offen lds
    s_waitcnt lgkmcnt(2)
    v_mfma_f32_32x32x16_bf16 v[176:191], a[12:15], v[60:63], v[176:191]
    ds_read_b64_tr_b16 a[36:37], v233 offset:8192
    ds_read_b64_tr_b16 a[38:39], v233 offset:8704
    v_fma_f32 v229, v229, v244, v245
    v_cvt_pk_bf16_f32 v78, v228, v229
    v_lshlrev_b32 v230, 16, v79
    v_and_b32 v231, s62, v79
    v_mfma_f32_32x32x16_bf16 v[192:207], a[16:19], v[60:63], v[192:207]
    ds_read_b64_tr_b16 a[40:41], v234 offset:8192
    ds_read_b64_tr_b16 a[42:43], v234 offset:8704
    buffer_load_dwordx4 v239, s[32:35], s53 offen offset:1024 lds
    v_fma_f32 v230, v230, v244, v245
    v_fma_f32 v231, v231, v244, v245
    v_cvt_pk_bf16_f32 v79, v230, v231
    v_mfma_f32_32x32x16_bf16 v[208:223], a[20:23], v[60:63], v[208:223]
    ds_read_b64_tr_b16 a[44:45], v235 offset:8192
    ds_read_b64_tr_b16 a[46:47], v235 offset:8704
    v_lshlrev_b32 v224, 16, v80
    v_and_b32 v225, s62, v80
    v_fma_f32 v224, v224, v244, v245
    buffer_load_dwordx4 v238, s[28:31], s53 offen offset:2048 lds
    v_mfma_f32_32x32x16_bf16 a[112:127], a[24:27], v[60:63], a[112:127]
    ds_read_b64_tr_b16 a[0:1], v232 offset:10240
    ds_read_b64_tr_b16 a[2:3], v232 offset:10752
    v_fma_f32 v225, v225, v244, v245
    v_cvt_pk_bf16_f32 v80, v224, v225
    v_lshlrev_b32 v226, 16, v81
    v_and_b32 v227, s62, v81
    v_fma_f32 v226, v226, v244, v245
    v_mfma_f32_32x32x16_bf16 a[128:143], a[28:31], v[60:63], a[128:143]
    ds_read_b64_tr_b16 a[4:5], v233 offset:10240
    ds_read_b64_tr_b16 a[6:7], v233 offset:10752
    buffer_load_dwordx4 v239, s[44:47], s53 offen offset:3072 lds
    v_fma_f32 v227, v227, v244, v245
    v_cvt_pk_bf16_f32 v81, v226, v227
    s_waitcnt lgkmcnt(2)
    v_mfma_f32_32x32x16_bf16 v[128:143], a[32:35], v[64:67], v[128:143]
    ds_read_b64_tr_b16 a[8:9], v234 offset:10240
    ds_read_b64_tr_b16 a[10:11], v234 offset:10752
    v_lshlrev_b32 v228, 16, v82
    v_and_b32 v229, s62, v82
    v_fma_f32 v228, v228, v244, v245
    v_fma_f32 v229, v229, v244, v245
    v_mfma_f32_32x32x16_bf16 v[144:159], a[36:39], v[64:67], v[144:159]
    ds_read_b64_tr_b16 a[12:13], v235 offset:10240
    ds_read_b64_tr_b16 a[14:15], v235 offset:10752
    s_add_u32 s53, s53, 0x1c000
    s_cmp_eq_u32 s76, 1
    s_cselect_b32 s55, 0x1c0000, 0
    s_sub_u32 s53, s53, s55
    s_add_u32 m0, s50, 0
    v_mfma_f32_32x32x16_bf16 v[160:175], a[40:43], v[64:67], v[160:175]
    ds_read_b64_tr_b16 a[16:17], v232 offset:40960
    ds_read_b64_tr_b16 a[18:19], v232 offset:41472
    buffer_load_dwordx4 v238, s[16:19], s53 offen lds
    v_cvt_pk_bf16_f32 v82, v228, v229
    v_lshlrev_b32 v230, 16, v83
    v_and_b32 v231, s62, v83
    v_mfma_f32_32x32x16_bf16 v[176:191], a[44:47], v[64:67], v[176:191]
    ds_read_b64_tr_b16 a[20:21], v233 offset:40960
    ds_read_b64_tr_b16 a[22:23], v233 offset:41472
    buffer_load_dwordx4 v239, s[32:35], s53 offen offset:1024 lds
    v_fma_f32 v230, v230, v244, v245
    v_fma_f32 v231, v231, v244, v245
    v_cvt_pk_bf16_f32 v83, v230, v231
    v_mfma_f32_32x32x16_bf16 v[192:207], a[0:3], v[64:67], v[192:207]
    ds_read_b64_tr_b16 a[24:25], v234 offset:40960
    ds_read_b64_tr_b16 a[26:27], v234 offset:41472
    v_lshlrev_b32 v224, 16, v84
    v_and_b32 v225, s62, v84
    v_fma_f32 v224, v224, v244, v245
    v_fma_f32 v225, v225, v244, v245
    s_waitcnt lgkmcnt(2)
    v_mfma_f32_32x32x16_bf16 v[208:223], a[4:7], v[64:67], v[208:223]
    ds_read_b64_tr_b16 a[28:29], v235 offset:40960
    ds_read_b64_tr_b16 a[30:31], v235 offset:41472
    buffer_load_dwordx4 v238, s[28:31], s53 offen offset:2048 lds
    v_cvt_pk_bf16_f32 v84, v224, v225
    v_lshlrev_b32 v226, 16, v85
    v_mfma_f32_32x32x16_bf16 a[112:127], a[8:11], v[64:67], a[112:127]
    ds_read_b64_tr_b16 a[32:33], v232 offset:43008
    ds_read_b64_tr_b16 a[34:35], v232 offset:43520
    v_and_b32 v227, s62, v85
    v_fma_f32 v226, v226, v244, v245
    v_fma_f32 v227, v227, v244, v245
    v_cvt_pk_bf16_f32 v85, v226, v227
    v_lshlrev_b32 v228, 16, v86
    v_mfma_f32_32x32x16_bf16 a[128:143], a[12:15], v[64:67], a[128:143]
    ds_read_b64_tr_b16 a[36:37], v233 offset:43008
    ds_read_b64_tr_b16 a[38:39], v233 offset:43520
    buffer_load_dwordx4 v239, s[44:47], s53 offen offset:3072 lds
    v_and_b32 v229, s62, v86
    v_fma_f32 v228, v228, v244, v245
    v_fma_f32 v229, v229, v244, v245
    v_mfma_f32_32x32x16_bf16 v[128:143], a[16:19], v[68:71], v[128:143]
    ds_read_b64_tr_b16 a[40:41], v234 offset:43008
    ds_read_b64_tr_b16 a[42:43], v234 offset:43520
    v_cvt_pk_bf16_f32 v86, v228, v229
    v_lshlrev_b32 v230, 16, v87
    v_and_b32 v231, s62, v87
    v_fma_f32 v230, v230, v244, v245
    v_fma_f32 v231, v231, v244, v245
    v_mfma_f32_32x32x16_bf16 v[144:159], a[20:23], v[68:71], v[144:159]
    ds_read_b64_tr_b16 a[44:45], v235 offset:43008
    ds_read_b64_tr_b16 a[46:47], v235 offset:43520
    s_add_u32 s53, s53, 0x1c000
    s_add_u32 m0, s73, 0
    s_add_u32 s49, s0, 0x40000
    buffer_load_dwordx4 v241, s[20:23], s49 offen lds
    s_waitcnt lgkmcnt(2)
    v_mfma_f32_32x32x16_bf16 v[160:175], a[24:27], v[68:71], v[160:175]
    ds_read_b64_tr_b16 a[0:1], v232 offset:12288
    ds_read_b64_tr_b16 a[2:3], v232 offset:12800
    v_cvt_pk_bf16_f32 v87, v230, v231
    v_lshlrev_b32 v224, 16, v88
    v_and_b32 v225, s62, v88
    v_mfma_f32_32x32x16_bf16 v[176:191], a[28:31], v[68:71], v[176:191]
    ds_read_b64_tr_b16 a[4:5], v233 offset:12288
    ds_read_b64_tr_b16 a[6:7], v233 offset:12800
    s_add_u32 m0, s73, 0x1000
    s_add_u32 s49, s0, 0x44000
    buffer_load_dwordx4 v241, s[20:23], s49 offen lds
    v_fma_f32 v224, v224, v244, v245
    v_mfma_f32_32x32x16_bf16 v[192:207], a[32:35], v[68:71], v[192:207]
    ds_read_b64_tr_b16 a[8:9], v234 offset:12288
    ds_read_b64_tr_b16 a[10:11], v234 offset:12800
    v_fma_f32 v225, v225, v244, v245
    v_cvt_pk_bf16_f32 v88, v224, v225
    v_lshlrev_b32 v226, 16, v89
    v_and_b32 v227, s62, v89
    v_fma_f32 v226, v226, v244, v245
    v_mfma_f32_32x32x16_bf16 v[208:223], a[36:39], v[68:71], v[208:223]
    ds_read_b64_tr_b16 a[12:13], v235 offset:12288
    ds_read_b64_tr_b16 a[14:15], v235 offset:12800
    s_add_u32 m0, s73, 0x2000
    s_add_u32 s49, s0, 0x48000
    buffer_load_dwordx4 v241, s[20:23], s49 offen lds
    v_fma_f32 v227, v227, v244, v245
    v_mfma_f32_32x32x16_bf16 a[112:127], a[40:43], v[68:71], a[112:127]
    ds_read_b64_tr_b16 a[16:17], v232 offset:14336
    ds_read_b64_tr_b16 a[18:19], v232 offset:14848
    v_cvt_pk_bf16_f32 v89, v226, v227
    v_lshlrev_b32 v228, 16, v90
    v_and_b32 v229, s62, v90
    v_fma_f32 v228, v228, v244, v245
    s_waitcnt lgkmcnt(2)
    v_mfma_f32_32x32x16_bf16 a[128:143], a[44:47], v[68:71], a[128:143]
    ds_read_b64_tr_b16 a[20:21], v233 offset:14336
    ds_read_b64_tr_b16 a[22:23], v233 offset:14848
    s_add_u32 m0, s73, 0x3000
    s_add_u32 s49, s0, 0x4c000
    buffer_load_dwordx4 v241, s[20:23], s49 offen lds
    v_mfma_f32_32x32x16_bf16 v[128:143], a[0:3], v[72:75], v[128:143]
    ds_read_b64_tr_b16 a[24:25], v234 offset:14336
    ds_read_b64_tr_b16 a[26:27], v234 offset:14848
    v_fma_f32 v229, v229, v244, v245
    v_cvt_pk_bf16_f32 v90, v228, v229
    v_lshlrev_b32 v230, 16, v91
    v_and_b32 v231, s62, v91
    v_fma_f32 v230, v230, v244, v245
    v_mfma_f32_32x32x16_bf16 v[144:159], a[4:7], v[72:75], v[144:159]
    ds_read_b64_tr_b16 a[28:29], v235 offset:14336
    ds_read_b64_tr_b16 a[30:31], v235 offset:14848
    s_add_u32 m0, s73, 0x4000
    s_add_u32 s49, s0, 0x50000
    buffer_load_dwordx4 v241, s[20:23], s49 offen lds
    v_fma_f32 v231, v231, v244, v245
    v_mfma_f32_32x32x16_bf16 v[160:175], a[8:11], v[72:75], v[160:175]
    ds_read_b64_tr_b16 a[32:33], v232 offset:45056
    ds_read_b64_tr_b16 a[34:35], v232 offset:45568
    v_cvt_pk_bf16_f32 v91, v230, v231
    v_lshlrev_b32 v224, 16, v92
    v_and_b32 v225, s62, v92
    v_fma_f32 v224, v224, v244, v245
    v_fma_f32 v225, v225, v244, v245
    v_mfma_f32_32x32x16_bf16 v[176:191], a[12:15], v[72:75], v[176:191]
    ds_read_b64_tr_b16 a[36:37], v233 offset:45056
    ds_read_b64_tr_b16 a[38:39], v233 offset:45568
    s_add_u32 m0, s73, 0x5000
    s_add_u32 s49, s0, 0x54000
    buffer_load_dwordx4 v241, s[20:23], s49 offen lds
    s_waitcnt lgkmcnt(2)
    v_mfma_f32_32x32x16_bf16 v[192:207], a[16:19], v[72:75], v[192:207]
    ds_read_b64_tr_b16 a[40:41], v234 offset:45056
    ds_read_b64_tr_b16 a[42:43], v234 offset:45568
    v_cvt_pk_bf16_f32 v92, v224, v225
    v_lshlrev_b32 v226, 16, v93
    v_and_b32 v227, s62, v93
    v_fma_f32 v226, v226, v244, v245
    v_mfma_f32_32x32x16_bf16 v[208:223], a[20:23], v[72:75], v[208:223]
    ds_read_b64_tr_b16 a[44:45], v235 offset:45056
    ds_read_b64_tr_b16 a[46:47], v235 offset:45568
    s_add_u32 m0, s73, 0x6000
    s_add_u32 s49, s0, 0x58000
    buffer_load_dwordx4 v241, s[20:23], s49 offen lds
    v_fma_f32 v227, v227, v244, v245
    v_mfma_f32_32x32x16_bf16 a[112:127], a[24:27], v[72:75], a[112:127]
    ds_read_b64_tr_b16 a[0:1], v232 offset:47104
    ds_read_b64_tr_b16 a[2:3], v232 offset:47616
    v_cvt_pk_bf16_f32 v93, v226, v227
    v_lshlrev_b32 v228, 16, v94
    v_and_b32 v229, s62, v94
    v_fma_f32 v228, v228, v244, v245
    v_fma_f32 v229, v229, v244, v245
    v_mfma_f32_32x32x16_bf16 a[128:143], a[28:31], v[72:75], a[128:143]
    ds_read_b64_tr_b16 a[4:5], v233 offset:47104
    ds_read_b64_tr_b16 a[6:7], v233 offset:47616
    s_add_u32 m0, s73, 0x7000
    s_add_u32 s49, s0, 0x5c000
    buffer_load_dwordx4 v241, s[20:23], s49 offen lds
    v_cvt_pk_bf16_f32 v94, v228, v229
    v_mfma_f32_32x32x16_bf16 v[128:143], a[32:35], v[76:79], v[128:143]
    ds_read_b64_tr_b16 a[8:9], v234 offset:47104
    ds_read_b64_tr_b16 a[10:11], v234 offset:47616
    v_lshlrev_b32 v230, 16, v95
    v_and_b32 v231, s62, v95
    v_fma_f32 v230, v230, v244, v245
    v_fma_f32 v231, v231, v244, v245
    s_waitcnt lgkmcnt(2)
    v_mfma_f32_32x32x16_bf16 v[144:159], a[36:39], v[76:79], v[144:159]
    ds_read_b64_tr_b16 a[12:13], v235 offset:47104
    ds_read_b64_tr_b16 a[14:15], v235 offset:47616
    v_cvt_pk_bf16_f32 v95, v230, v231
    v_lshlrev_b32 v224, 16, v96
    s_waitcnt vmcnt(12)
    s_barrier
    v_mfma_f32_32x32x16_bf16 v[160:175], a[40:43], v[76:79], v[160:175]
    ds_read_b64_tr_b16 a[16:17], v232 offset:16384
    ds_read_b64_tr_b16 a[18:19], v232 offset:16896
    s_add_u32 m0, s50, 0x1000
    ds_read_b64_tr_b16 a[200:201], v251 offset:24576
    ds_read_b64_tr_b16 a[202:203], v251 offset:57344
    buffer_load_dwordx4 v238, s[16:19], s53 offen lds
    v_mfma_f32_32x32x16_bf16 v[176:191], a[44:47], v[76:79], v[176:191]
    ds_read_b64_tr_b16 a[20:21], v233 offset:16384
    ds_read_b64_tr_b16 a[22:23], v233 offset:16896
    buffer_load_dwordx4 v239, s[32:35], s53 offen offset:1024 lds
    ds_read_b64_tr_b16 a[204:205], v252 offset:24576
    ds_read_b64_tr_b16 a[206:207], v252 offset:57344
    ds_read_b64_tr_b16 a[208:209], v251 offset:25600
    ds_read_b64_tr_b16 a[210:211], v251 offset:58368
    v_mfma_f32_32x32x16_bf16 v[192:207], a[0:3], v[76:79], v[192:207]
    ds_read_b64_tr_b16 a[24:25], v234 offset:16384
    ds_read_b64_tr_b16 a[26:27], v234 offset:16896
    ds_read_b64_tr_b16 a[212:213], v252 offset:25600
    ds_read_b64_tr_b16 a[214:215], v252 offset:58368
    ds_read_b64_tr_b16 a[216:217], v251 offset:26624
    ds_read_b64_tr_b16 a[218:219], v251 offset:59392
    buffer_load_dwordx4 v238, s[28:31], s53 offen offset:2048 lds
    v_mfma_f32_32x32x16_bf16 v[208:223], a[4:7], v[76:79], v[208:223]
    ds_read_b64_tr_b16 a[28:29], v235 offset:16384
    ds_read_b64_tr_b16 a[30:31], v235 offset:16896
    ds_read_b64_tr_b16 a[220:221], v252 offset:26624
    ds_read_b64_tr_b16 a[222:223], v252 offset:59392
    s_waitcnt lgkmcnt(7)
    v_mfma_f32_32x32x16_bf16 a[112:127], a[8:11], v[76:79], a[112:127]
    ds_read_b64_tr_b16 a[32:33], v232 offset:18432
    ds_read_b64_tr_b16 a[34:35], v232 offset:18944
    buffer_load_dwordx4 v239, s[44:47], s53 offen offset:3072 lds
    ds_read_b64_tr_b16 a[224:225], v251 offset:27648
    ds_read_b64_tr_b16 a[226:227], v251 offset:60416
    ds_read_b64_tr_b16 a[228:229], v252 offset:27648
    ds_read_b64_tr_b16 a[230:231], v252 offset:60416
    v_mfma_f32_32x32x16_bf16 a[128:143], a[12:15], v[76:79], a[128:143]
    ds_read_b64_tr_b16 a[36:37], v233 offset:18432
    ds_read_b64_tr_b16 a[38:39], v233 offset:18944
    ds_read_b64_tr_b16 a[232:233], v251 offset:28672
    ds_read_b64_tr_b16 a[234:235], v251 offset:61440
    ds_read_b64_tr_b16 a[236:237], v252 offset:28672
    ds_read_b64_tr_b16 a[238:239], v252 offset:61440
    v_mfma_f32_32x32x16_bf16 v[128:143], a[16:19], v[80:83], v[128:143]
    ds_read_b64_tr_b16 a[40:41], v234 offset:18432
    ds_read_b64_tr_b16 a[42:43], v234 offset:18944
    s_add_u32 s53, s53, 0x1c000
    s_add_u32 m0, s50, 0x2000
    ds_read_b64_tr_b16 a[240:241], v251 offset:29696
    ds_read_b64_tr_b16 a[242:243], v251 offset:62464
    buffer_load_dwordx4 v238, s[16:19], s53 offen lds
    v_mfma_f32_32x32x16_bf16 v[144:159], a[20:23], v[80:83], v[144:159]
    ds_read_b64_tr_b16 a[44:45], v235 offset:18432
    ds_read_b64_tr_b16 a[46:47], v235 offset:18944
    ds_read_b64_tr_b16 a[244:245], v252 offset:29696
    ds_read_b64_tr_b16 a[246:247], v252 offset:62464
    ds_read_b64_tr_b16 a[248:249], v251 offset:30720
    ds_read_b64_tr_b16 a[250:251], v251 offset:63488
    v_mfma_f32_32x32x16_bf16 v[160:175], a[24:27], v[80:83], v[160:175]
    ds_read_b64_tr_b16 a[0:1], v232 offset:49152
    ds_read_b64_tr_b16 a[2:3], v232 offset:49664
    buffer_load_dwordx4 v239, s[32:35], s53 offen offset:1024 lds
    ds_read_b64_tr_b16 a[252:253], v252 offset:30720
    ds_read_b64_tr_b16 a[254:255], v252 offset:63488
    s_waitcnt lgkmcnt(7)
    v_mfma_f32_32x32x16_bf16 v[176:191], a[28:31], v[80:83], v[176:191]
    ds_read_b64_tr_b16 a[4:5], v233 offset:49152
    ds_read_b64_tr_b16 a[6:7], v233 offset:49664
    ds_read_b64_tr_b16 a[144:145], v251 offset:31744
    ds_read_b64_tr_b16 a[146:147], v251 offset:64512
    ds_read_b64_tr_b16 a[148:149], v252 offset:31744
    ds_read_b64_tr_b16 a[150:151], v252 offset:64512
    v_mfma_f32_32x32x16_bf16 v[192:207], a[32:35], v[80:83], v[192:207]
    ds_read_b64_tr_b16 a[8:9], v234 offset:49152
    ds_read_b64_tr_b16 a[10:11], v234 offset:49664
    buffer_load_dwordx4 v238, s[28:31], s53 offen offset:2048 lds
    v_and_b32 v225, s62, v96
    v_fma_f32 v224, v224, v244, v245
    v_mfma_f32_32x32x16_bf16 v[208:223], a[36:39], v[80:83], v[208:223]
    ds_read_b64_tr_b16 a[12:13], v235 offset:49152
    ds_read_b64_tr_b16 a[14:15], v235 offset:49664
    v_fma_f32 v225, v225, v244, v245
    v_cvt_pk_bf16_f32 v96, v224, v225
    v_lshlrev_b32 v226, 16, v97
    v_and_b32 v227, s62, v97
    v_fma_f32 v226, v226, v244, v245
    v_mfma_f32_32x32x16_bf16 a[112:127], a[40:43], v[80:83], a[112:127]
    ds_read_b64_tr_b16 a[16:17], v232 offset:51200
    ds_read_b64_tr_b16 a[18:19], v232 offset:51712
    buffer_load_dwordx4 v239, s[44:47], s53 offen offset:3072 lds
    v_fma_f32 v227, v227, v244, v245
    v_cvt_pk_bf16_f32 v97, v226, v227
    v_lshlrev_b32 v228, 16, v98
    v_mfma_f32_32x32x16_bf16 a[128:143], a[44:47], v[80:83], a[128:143]
    ds_read_b64_tr_b16 a[20:21], v233 offset:51200
    ds_read_b64_tr_b16 a[22:23], v233 offset:51712
    v_and_b32 v229, s62, v98
    v_fma_f32 v228, v228, v244, v245
    v_fma_f32 v229, v229, v244, v245
    v_cvt_pk_bf16_f32 v98, v228, v229
    s_waitcnt lgkmcnt(2)
    v_mfma_f32_32x32x16_bf16 v[128:143], a[0:3], v[84:87], v[128:143]
    ds_read_b64_tr_b16 a[24:25], v234 offset:51200
    ds_read_b64_tr_b16 a[26:27], v234 offset:51712
    s_add_u32 s53, s53, 0x1c000
    v_lshlrev_b32 v230, 16, v99
    v_and_b32 v231, s62, v99
    v_fma_f32 v230, v230, v244, v245
    v_fma_f32 v231, v231, v244, v245
    v_mfma_f32_32x32x16_bf16 v[144:159], a[4:7], v[84:87], v[144:159]
    ds_read_b64_tr_b16 a[28:29], v235 offset:51200
    ds_read_b64_tr_b16 a[30:31], v235 offset:51712
    v_cvt_pk_bf16_f32 v99, v230, v231
    v_lshlrev_b32 v224, 16, v100
    v_and_b32 v225, s62, v100
    v_fma_f32 v224, v224, v244, v245
    v_mfma_f32_32x32x16_bf16 v[160:175], a[8:11], v[84:87], v[160:175]
    ds_read_b64_tr_b16 a[32:33], v232 offset:20480
    ds_read_b64_tr_b16 a[34:35], v232 offset:20992
    v_fma_f32 v225, v225, v244, v245
    v_cvt_pk_bf16_f32 v100, v224, v225
    v_lshlrev_b32 v226, 16, v101
    v_and_b32 v227, s62, v101
    v_fma_f32 v226, v226, v244, v245
    v_mfma_f32_32x32x16_bf16 v[176:191], a[12:15], v[84:87], v[176:191]
    ds_read_b64_tr_b16 a[36:37], v233 offset:20480
    ds_read_b64_tr_b16 a[38:39], v233 offset:20992
    v_fma_f32 v227, v227, v244, v245
    v_cvt_pk_bf16_f32 v101, v226, v227
    v_lshlrev_b32 v228, 16, v102
    v_and_b32 v229, s62, v102
    v_fma_f32 v228, v228, v244, v245
    v_mfma_f32_32x32x16_bf16 v[192:207], a[16:19], v[84:87], v[192:207]
    ds_read_b64_tr_b16 a[40:41], v234 offset:20480
    ds_read_b64_tr_b16 a[42:43], v234 offset:20992
    v_fma_f32 v229, v229, v244, v245
    v_cvt_pk_bf16_f32 v102, v228, v229
    v_lshlrev_b32 v230, 16, v103
    v_and_b32 v231, s62, v103
    s_waitcnt lgkmcnt(2)
    v_mfma_f32_32x32x16_bf16 v[208:223], a[20:23], v[84:87], v[208:223]
    ds_read_b64_tr_b16 a[44:45], v235 offset:20480
    ds_read_b64_tr_b16 a[46:47], v235 offset:20992
    v_fma_f32 v230, v230, v244, v245
    v_fma_f32 v231, v231, v244, v245
    v_cvt_pk_bf16_f32 v103, v230, v231
    v_lshlrev_b32 v224, 16, v104
    v_and_b32 v225, s62, v104
    v_mfma_f32_32x32x16_bf16 a[112:127], a[24:27], v[84:87], a[112:127]
    ds_read_b64_tr_b16 a[0:1], v232 offset:22528
    ds_read_b64_tr_b16 a[2:3], v232 offset:23040
    v_fma_f32 v224, v224, v244, v245
    v_fma_f32 v225, v225, v244, v245
    v_cvt_pk_bf16_f32 v104, v224, v225
    v_lshlrev_b32 v226, 16, v105
    v_mfma_f32_32x32x16_bf16 a[128:143], a[28:31], v[84:87], a[128:143]
    ds_read_b64_tr_b16 a[4:5], v233 offset:22528
    ds_read_b64_tr_b16 a[6:7], v233 offset:23040
    v_and_b32 v227, s62, v105
    v_fma_f32 v226, v226, v244, v245
    v_fma_f32 v227, v227, v244, v245
    v_cvt_pk_bf16_f32 v105, v226, v227
    v_lshlrev_b32 v228, 16, v106
    v_mfma_f32_32x32x16_bf16 v[128:143], a[32:35], v[88:91], v[128:143]
    ds_read_b64_tr_b16 a[8:9], v234 offset:22528
    ds_read_b64_tr_b16 a[10:11], v234 offset:23040
    v_and_b32 v229, s62, v106
    v_fma_f32 v228, v228, v244, v245
    v_fma_f32 v229, v229, v244, v245
    v_cvt_pk_bf16_f32 v106, v228, v229
    v_lshlrev_b32 v230, 16, v107
    v_mfma_f32_32x32x16_bf16 v[144:159], a[36:39], v[88:91], v[144:159]
    ds_read_b64_tr_b16 a[12:13], v235 offset:22528
    ds_read_b64_tr_b16 a[14:15], v235 offset:23040
    v_and_b32 v231, s62, v107
    v_fma_f32 v230, v230, v244, v245
    v_fma_f32 v231, v231, v244, v245
    v_cvt_pk_bf16_f32 v107, v230, v231
    s_waitcnt lgkmcnt(2)
    v_mfma_f32_32x32x16_bf16 v[160:175], a[40:43], v[88:91], v[160:175]
    ds_read_b64_tr_b16 a[16:17], v232 offset:53248
    ds_read_b64_tr_b16 a[18:19], v232 offset:53760
    v_lshlrev_b32 v224, 16, v108
    v_and_b32 v225, s62, v108
    v_fma_f32 v224, v224, v244, v245
    v_fma_f32 v225, v225, v244, v245
    v_cvt_pk_bf16_f32 v108, v224, v225
    v_mfma_f32_32x32x16_bf16 v[176:191], a[44:47], v[88:91], v[176:191]
    ds_read_b64_tr_b16 a[20:21], v233 offset:53248
    ds_read_b64_tr_b16 a[22:23], v233 offset:53760
    v_lshlrev_b32 v226, 16, v109
    v_and_b32 v227, s62, v109
    v_fma_f32 v226, v226, v244, v245
    v_fma_f32 v227, v227, v244, v245
    v_mfma_f32_32x32x16_bf16 v[192:207], a[0:3], v[88:91], v[192:207]
    ds_read_b64_tr_b16 a[24:25], v234 offset:53248
    ds_read_b64_tr_b16 a[26:27], v234 offset:53760
    v_cvt_pk_bf16_f32 v109, v226, v227
    v_lshlrev_b32 v228, 16, v110
    v_and_b32 v229, s62, v110
    v_fma_f32 v228, v228, v244, v245
    v_fma_f32 v229, v229, v244, v245
    v_mfma_f32_32x32x16_bf16 v[208:223], a[4:7], v[88:91], v[208:223]
    ds_read_b64_tr_b16 a[28:29], v235 offset:53248
    ds_read_b64_tr_b16 a[30:31], v235 offset:53760
    v_cvt_pk_bf16_f32 v110, v228, v229
    v_lshlrev_b32 v230, 16, v111
    v_and_b32 v231, s62, v111
    v_fma_f32 v230, v230, v244, v245
    v_fma_f32 v231, v231, v244, v245
    v_mfma_f32_32x32x16_bf16 a[112:127], a[8:11], v[88:91], a[112:127]
    ds_read_b64_tr_b16 a[32:33], v232 offset:55296
    ds_read_b64_tr_b16 a[34:35], v232 offset:55808
    v_cvt_pk_bf16_f32 v111, v230, v231
    v_lshlrev_b32 v224, 16, v112
    v_and_b32 v225, s62, v112
    v_fma_f32 v224, v224, v244, v245
    s_waitcnt lgkmcnt(2)
    v_mfma_f32_32x32x16_bf16 a[128:143], a[12:15], v[88:91], a[128:143]
    ds_read_b64_tr_b16 a[36:37], v233 offset:55296
    ds_read_b64_tr_b16 a[38:39], v233 offset:55808
    v_fma_f32 v225, v225, v244, v245
    v_cvt_pk_bf16_f32 v112, v224, v225
    v_lshlrev_b32 v226, 16, v113
    v_and_b32 v227, s62, v113
    v_fma_f32 v226, v226, v244, v245
    v_mfma_f32_32x32x16_bf16 v[128:143], a[16:19], v[92:95], v[128:143]
    ds_read_b64_tr_b16 a[40:41], v234 offset:55296
    ds_read_b64_tr_b16 a[42:43], v234 offset:55808
    v_fma_f32 v227, v227, v244, v245
    v_cvt_pk_bf16_f32 v113, v226, v227
    v_lshlrev_b32 v228, 16, v114
    v_and_b32 v229, s62, v114
    v_mfma_f32_32x32x16_bf16 v[144:159], a[20:23], v[92:95], v[144:159]
    ds_read_b64_tr_b16 a[44:45], v235 offset:55296
    ds_read_b64_tr_b16 a[46:47], v235 offset:55808
    v_fma_f32 v228, v228, v244, v245
    v_fma_f32 v229, v229, v244, v245
    v_cvt_pk_bf16_f32 v114, v228, v229
    s_waitcnt vmcnt(4)
    s_barrier
    v_mfma_f32_32x32x16_bf16 v[160:175], a[24:27], v[92:95], v[160:175]
    ds_read_b64_tr_b16 a[0:1], v232 offset:0
    ds_read_b64_tr_b16 a[2:3], v232 offset:512
    s_add_u32 m0, s50, 0x3000
    ds_read_b64_tr_b16 a[152:153], v253 offset:0
    ds_read_b64_tr_b16 a[154:155], v253 offset:1024
    buffer_load_dwordx4 v238, s[16:19], s53 offen lds
    v_mfma_f32_32x32x16_bf16 v[176:191], a[28:31], v[92:95], v[176:191]
    ds_read_b64_tr_b16 a[4:5], v233 offset:0
    ds_read_b64_tr_b16 a[6:7], v233 offset:512
    buffer_load_dwordx4 v239, s[32:35], s53 offen offset:1024 lds
    ds_read_b64_tr_b16 a[156:157], v254 offset:0
    ds_read_b64_tr_b16 a[158:159], v254 offset:1024
    s_waitcnt lgkmcnt(6)
    v_mfma_f32_32x32x16_bf16 v[192:207], a[32:35], v[92:95], v[192:207]
    ds_read_b64_tr_b16 a[8:9], v234 offset:0
    ds_read_b64_tr_b16 a[10:11], v234 offset:512
    buffer_load_dwordx4 v238, s[28:31], s53 offen offset:2048 lds
    ds_read_b64_tr_b16 a[48:49], v253 offset:4096
    ds_read_b64_tr_b16 a[50:51], v253 offset:5120
    ds_read_b64_tr_b16 a[52:53], v254 offset:4096
    ds_read_b64_tr_b16 a[54:55], v254 offset:5120
    v_mfma_f32_32x32x16_bf16 v[208:223], a[36:39], v[92:95], v[208:223]
    ds_read_b64_tr_b16 a[12:13], v235 offset:0
    ds_read_b64_tr_b16 a[14:15], v235 offset:512
    buffer_load_dwordx4 v239, s[44:47], s53 offen offset:3072 lds
    ds_read_b64_tr_b16 a[56:57], v253 offset:8192
L_padB_3:
    s_cbranch_execz L_backB
    ds_read_b64_tr_b16 a[58:59], v253 offset:9216
    v_mfma_f32_32x32x16_bf16 a[112:127], a[40:43], v[92:95], a[112:127]
    ds_read_b64_tr_b16 a[16:17], v232 offset:2048
    ds_read_b64_tr_b16 a[18:19], v232 offset:2560
    s_add_u32 m0, s50, 0x4000
    s_add_u32 s55, s54, 0xd800
    buffer_load_dwordx4 v238, s[16:19], s54 offen lds
    v_mfma_f32_32x32x16_bf16 a[128:143], a[44:47], v[92:95], a[128:143]
    ds_read_b64_tr_b16 a[20:21], v233 offset:2048
    ds_read_b64_tr_b16 a[22:23], v233 offset:2560
    ds_read_b64_tr_b16 a[60:61], v254 offset:8192
    ds_read_b64_tr_b16 a[62:63], v254 offset:9216
    ds_read_b64_tr_b16 a[64:65], v253 offset:12288
    ds_read_b64_tr_b16 a[66:67], v253 offset:13312
    ds_read_b64_tr_b16 a[68:69], v254 offset:12288
    ds_read_b64_tr_b16 a[70:71], v254 offset:13312
    v_mfma_f32_32x32x16_bf16 v[128:143], a[0:3], v[96:99], v[128:143]
    ds_read_b64_tr_b16 a[24:25], v234 offset:2048
    ds_read_b64_tr_b16 a[26:27], v234 offset:2560
    buffer_load_dwordx4 v239, s[32:35], s54 offen offset:1024 lds
    ds_read_b64_tr_b16 a[72:73], v253 offset:16384
    ds_read_b64_tr_b16 a[74:75], v253 offset:17408
    s_waitcnt lgkmcnt(7)
    v_mfma_f32_32x32x16_bf16 v[144:159], a[4:7], v[96:99], v[144:159]
    ds_read_b64_tr_b16 a[28:29], v235 offset:2048
    ds_read_b64_tr_b16 a[30:31], v235 offset:2560
    ds_read_b64_tr_b16 a[76:77], v254 offset:16384
    ds_read_b64_tr_b16 a[78:79], v254 offset:17408
    ds_read_b64_tr_b16 a[80:81], v253 offset:20480
    ds_read_b64_tr_b16 a[82:83], v253 offset:21504
    v_mfma_f32_32x32x16_bf16 v[160:175], a[8:11], v[96:99], v[160:175]
    ds_read_b64_tr_b16 a[32:33], v232 offset:32768
    ds_read_b64_tr_b16 a[34:35], v232 offset:33280
    buffer_load_dwordx4 v238, s[16:19], s55 offen offset:2048 lds
    ds_read_b64_tr_b16 a[84:85], v254 offset:20480
    ds_read_b64_tr_b16 a[86:87], v254 offset:21504
    v_mfma_f32_32x32x16_bf16 v[176:191], a[12:15], v[96:99], v[176:191]
    ds_read_b64_tr_b16 a[36:37], v233 offset:32768
    ds_read_b64_tr_b16 a[38:39], v233 offset:33280
    ds_read_b64_tr_b16 a[88:89], v253 offset:24576
    ds_read_b64_tr_b16 a[90:91], v253 offset:25600
    ds_read_b64_tr_b16 a[92:93], v254 offset:24576
    ds_read_b64_tr_b16 a[94:95], v254 offset:25600
    ds_read_b64_tr_b16 a[96:97], v253 offset:28672
    ds_read_b64_tr_b16 a[98:99], v253 offset:29696
    v_mfma_f32_32x32x16_bf16 v[192:207], a[16:19], v[96:99], v[192:207]
    ds_read_b64_tr_b16 a[40:41], v234 offset:32768
    ds_read_b64_tr_b16 a[42:43], v234 offset:33280
    buffer_load_dwordx4 v239, s[32:35], s55 offen offset:3072 lds
    ds_read_b64_tr_b16 a[100:101], v254 offset:28672
    ds_read_b64_tr_b16 a[102:103], v254 offset:29696
    v_mfma_f32_32x32x16_bf16 v[208:223], a[20:23], v[96:99], v[208:223]
    ds_read_b64_tr_b16 a[44:45], v235 offset:32768
    ds_read_b64_tr_b16 a[46:47], v235 offset:33280
    v_lshlrev_b32 v230, 16, v115
    v_and_b32 v231, s62, v115
    v_fma_f32 v230, v230, v244, v245
    v_fma_f32 v231, v231, v244, v245
    s_waitcnt lgkmcnt(4)
    v_mfma_f32_32x32x16_bf16 a[112:127], a[24:27], v[96:99], a[112:127]
    ds_read_b64_tr_b16 a[0:1], v232 offset:34816
    ds_read_b64_tr_b16 a[2:3], v232 offset:35328
    s_add_u32 s54, s54, 0x38000
    buffer_load_dword v248, off, s[24:27], 0 sc1
    v_cvt_pk_bf16_f32 v115, v230, v231
    v_lshlrev_b32 v224, 16, v116
    v_mfma_f32_32x32x16_bf16 a[128:143], a[28:31], v[96:99], a[128:143]
    ds_read_b64_tr_b16 a[4:5], v233 offset:34816
    ds_read_b64_tr_b16 a[6:7], v233 offset:35328
    v_and_b32 v225, s62, v116
    v_fma_f32 v224, v224, v244, v245
    v_fma_f32 v225, v225, v244, v245
    v_cvt_pk_bf16_f32 v116, v224, v225
    v_mfma_f32_32x32x16_bf16 v[128:143], a[32:35], v[100:103], v[128:143]
    ds_read_b64_tr_b16 a[8:9], v234 offset:34816
    ds_read_b64_tr_b16 a[10:11], v234 offset:35328
    s_add_u32 m0, s50, 0x6000
    s_add_u32 s49, s1, 0x40000
    buffer_load_dwordx4 v241, s[20:23], s49 offen lds
    v_lshlrev_b32 v226, 16, v117
    v_mfma_f32_32x32x16_bf16 v[144:159], a[36:39], v[100:103], v[144:159]
    ds_read_b64_tr_b16 a[12:13], v235 offset:34816
    ds_read_b64_tr_b16 a[14:15], v235 offset:35328
    v_and_b32 v227, s62, v117
    v_fma_f32 v226, v226, v244, v245
    v_fma_f32 v227, v227, v244, v245
    v_cvt_pk_bf16_f32 v117, v226, v227
    v_lshlrev_b32 v228, 16, v118
    v_mfma_f32_32x32x16_bf16 v[160:175], a[40:43], v[100:103], v[160:175]
    ds_read_b64_tr_b16 a[16:17], v232 offset:4096
    ds_read_b64_tr_b16 a[18:19], v232 offset:4608
    s_add_u32 m0, s50, 0x6400
    s_add_u32 s49, s1, 0x44000
    buffer_load_dwordx4 v241, s[20:23], s49 offen lds
    s_waitcnt lgkmcnt(2)
    v_mfma_f32_32x32x16_bf16 v[176:191], a[44:47], v[100:103], v[176:191]
    ds_read_b64_tr_b16 a[20:21], v233 offset:4096
    ds_read_b64_tr_b16 a[22:23], v233 offset:4608
    v_and_b32 v229, s62, v118
    v_fma_f32 v228, v228, v244, v245
    v_fma_f32 v229, v229, v244, v245
    v_cvt_pk_bf16_f32 v118, v228, v229
    v_lshlrev_b32 v230, 16, v119
    v_mfma_f32_32x32x16_bf16 v[192:207], a[0:3], v[100:103], v[192:207]
    ds_read_b64_tr_b16 a[24:25], v234 offset:4096
    ds_read_b64_tr_b16 a[26:27], v234 offset:4608
    s_add_u32 m0, s50, 0x6800
    s_add_u32 s49, s1, 0x48000
    buffer_load_dwordx4 v241, s[20:23], s49 offen lds
    v_mfma_f32_32x32x16_bf16 v[208:223], a[4:7], v[100:103], v[208:223]
    ds_read_b64_tr_b16 a[28:29], v235 offset:4096
    ds_read_b64_tr_b16 a[30:31], v235 offset:4608
    v_and_b32 v231, s62, v119
    v_fma_f32 v230, v230, v244, v245
    v_fma_f32 v231, v231, v244, v245
    v_cvt_pk_bf16_f32 v119, v230, v231
    v_lshlrev_b32 v224, 16, v120
    v_mfma_f32_32x32x16_bf16 a[112:127], a[8:11], v[100:103], a[112:127]
    ds_read_b64_tr_b16 a[32:33], v232 offset:6144
    ds_read_b64_tr_b16 a[34:35], v232 offset:6656
    s_add_u32 m0, s50, 0x6c00
    s_add_u32 s49, s1, 0x4c000
    buffer_load_dwordx4 v241, s[20:23], s49 offen lds
    v_and_b32 v225, s62, v120
    v_mfma_f32_32x32x16_bf16 a[128:143], a[12:15], v[100:103], a[128:143]
    ds_read_b64_tr_b16 a[36:37], v233 offset:6144
    ds_read_b64_tr_b16 a[38:39], v233 offset:6656
    v_fma_f32 v224, v224, v244, v245
    v_fma_f32 v225, v225, v244, v245
    v_cvt_pk_bf16_f32 v120, v224, v225
    v_lshlrev_b32 v226, 16, v121
    s_waitcnt lgkmcnt(2)
    v_mfma_f32_32x32x16_bf16 v[128:143], a[16:19], v[104:107], v[128:143]
    ds_read_b64_tr_b16 a[40:41], v234 offset:6144
    ds_read_b64_tr_b16 a[42:43], v234 offset:6656
    s_add_u32 m0, s50, 0x7000
    s_add_u32 s49, s1, 0x50000
    buffer_load_dwordx4 v241, s[20:23], s49 offen lds
    v_and_b32 v227, s62, v121
    v_mfma_f32_32x32x16_bf16 v[144:159], a[20:23], v[104:107], v[144:159]
    ds_read_b64_tr_b16 a[44:45], v235 offset:6144
    ds_read_b64_tr_b16 a[46:47], v235 offset:6656
    v_fma_f32 v226, v226, v244, v245
    v_fma_f32 v227, v227, v244, v245
    v_cvt_pk_bf16_f32 v121, v226, v227
    v_lshlrev_b32 v228, 16, v122
    v_mfma_f32_32x32x16_bf16 v[160:175], a[24:27], v[104:107], v[160:175]
    ds_read_b64_tr_b16 a[0:1], v232 offset:36864
    ds_read_b64_tr_b16 a[2:3], v232 offset:37376
    s_add_u32 m0, s50, 0x7400
    s_add_u32 s49, s1, 0x54000
    buffer_load_dwordx4 v241, s[20:23], s49 offen lds
    v_and_b32 v229, s62, v122
    v_mfma_f32_32x32x16_bf16 v[176:191], a[28:31], v[104:107], v[176:191]
    ds_read_b64_tr_b16 a[4:5], v233 offset:36864
    ds_read_b64_tr_b16 a[6:7], v233 offset:37376
    v_fma_f32 v228, v228, v244, v245
    v_fma_f32 v229, v229, v244, v245
    v_cvt_pk_bf16_f32 v122, v228, v229
    v_lshlrev_b32 v230, 16, v123
    v_and_b32 v231, s62, v123
    v_mfma_f32_32x32x16_bf16 v[192:207], a[32:35], v[104:107], v[192:207]
    ds_read_b64_tr_b16 a[8:9], v234 offset:36864
    ds_read_b64_tr_b16 a[10:11], v234 offset:37376
    s_add_u32 m0, s50, 0x7800
    s_add_u32 s49, s1, 0x58000
    buffer_load_dwordx4 v241, s[20:23], s49 offen lds
    s_waitcnt lgkmcnt(2)
    v_mfma_f32_32x32x16_bf16 v[208:223], a[36:39], v[104:107], v[208:223]
    ds_read_b64_tr_b16 a[12:13], v235 offset:36864
    ds_read_b64_tr_b16 a[14:15], v235 offset:37376
    v_fma_f32 v230, v230, v244, v245
    v_fma_f32 v231, v231, v244, v245
    v_cvt_pk_bf16_f32 v123, v230, v231
    v_lshlrev_b32 v224, 16, v124
    v_and_b32 v225, s62, v124
    v_mfma_f32_32x32x16_bf16 a[112:127], a[40:43], v[104:107], a[112:127]
    ds_read_b64_tr_b16 a[16:17], v232 offset:38912
    ds_read_b64_tr_b16 a[18:19], v232 offset:39424
    s_add_u32 m0, s50, 0x7c00
    s_add_u32 s49, s1, 0x5c000
    buffer_load_dwordx4 v241, s[20:23], s49 offen lds
    v_mfma_f32_32x32x16_bf16 a[128:143], a[44:47], v[104:107], a[128:143]
    ds_read_b64_tr_b16 a[20:21], v233 offset:38912
    ds_read_b64_tr_b16 a[22:23], v233 offset:39424
    v_fma_f32 v224, v224, v244, v245
    v_fma_f32 v225, v225, v244, v245
    v_cvt_pk_bf16_f32 v124, v224, v225
    v_lshlrev_b32 v226, 16, v125
    v_and_b32 v227, s62, v125
    v_mfma_f32_32x32x16_bf16 v[128:143], a[0:3], v[108:111], v[128:143]
    ds_read_b64_tr_b16 a[24:25], v234 offset:38912
    ds_read_b64_tr_b16 a[26:27], v234 offset:39424
    v_fma_f32 v226, v226, v244, v245
    v_fma_f32 v227, v227, v244, v245
    v_cvt_pk_bf16_f32 v125, v226, v227
    v_lshlrev_b32 v228, 16, v126
    v_and_b32 v229, s62, v126
    v_mfma_f32_32x32x16_bf16 v[144:159], a[4:7], v[108:111], v[144:159]
    ds_read_b64_tr_b16 a[28:29], v235 offset:38912
    ds_read_b64_tr_b16 a[30:31], v235 offset:39424
    v_fma_f32 v228, v228, v244, v245
    v_fma_f32 v229, v229, v244, v245
    s_waitcnt vmcnt(13)
    s_barrier
    s_waitcnt lgkmcnt(2)
    v_mfma_f32_32x32x16_bf16 v[160:175], a[8:11], v[108:111], v[160:175]
    ds_read_b64_tr_b16 a[32:33], v232 offset:8192
    ds_read_b64_tr_b16 a[34:35], v232 offset:8704
    s_add_u32 m0, s50, 0x5000
    s_add_u32 s55, s54, 0xd800
    buffer_load_dwordx4 v238, s[16:19], s54 offen lds
    v_cvt_pk_bf16_f32 v126, v228, v229
    v_mfma_f32_32x32x16_bf16 v[176:191], a[12:15], v[108:111], v[176:191]
    ds_read_b64_tr_b16 a[36:37], v233 offset:8192
    ds_read_b64_tr_b16 a[38:39], v233 offset:8704
    buffer_load_dwordx4 v239, s[32:35], s54 offen offset:1024 lds
    v_lshlrev_b32 v230, 16, v127
    v_and_b32 v231, s62, v127
    v_mfma_f32_32x32x16_bf16 v[192:207], a[16:19], v[108:111], v[192:207]
    ds_read_b64_tr_b16 a[40:41], v234 offset:8192
    ds_read_b64_tr_b16 a[42:43], v234 offset:8704
    buffer_load_dwordx4 v238, s[16:19], s55 offen offset:2048 lds
    v_fma_f32 v230, v230, v244, v245
    v_fma_f32 v231, v231, v244, v245
    v_cvt_pk_bf16_f32 v127, v230, v231
    v_mfma_f32_32x32x16_bf16 v[208:223], a[20:23], v[108:111], v[208:223]
    ds_read_b64_tr_b16 a[44:45], v235 offset:8192
    ds_read_b64_tr_b16 a[46:47], v235 offset:8704
    v_mfma_f32_32x32x16_bf16 a[112:127], a[24:27], v[108:111], a[112:127]
    ds_read_b64_tr_b16 a[0:1], v232 offset:10240
    ds_read_b64_tr_b16 a[2:3], v232 offset:10752
    buffer_load_dwordx4 v239, s[32:35], s55 offen offset:3072 lds
    s_waitcnt lgkmcnt(4)
    v_mfma_f32_32x32x16_bf16 a[128:143], a[28:31], v[108:111], a[128:143]
    ds_read_b64_tr_b16 a[4:5], v233 offset:10240
    ds_read_b64_tr_b16 a[6:7], v233 offset:10752
    v_mfma_f32_32x32x16_bf16 v[128:143], a[32:35], v[112:115], v[128:143]
    ds_read_b64_tr_b16 a[8:9], v234 offset:10240
    ds_read_b64_tr_b16 a[10:11], v234 offset:10752
    s_add_u32 s54, s54, 0x38000
    s_cmp_eq_u32 s76, 3
    s_cselect_b32 s55, 0x1c0000, 0
    s_sub_u32 s54, s54, s55
    s_add_u32 m0, s50, 0
    s_add_u32 s55, s54, 0xd800
    buffer_load_dwordx4 v238, s[16:19], s54 offen lds
    v_mfma_f32_32x32x16_bf16 v[144:159], a[36:39], v[112:115], v[144:159]
    ds_read_b64_tr_b16 a[12:13], v235 offset:10240
    ds_read_b64_tr_b16 a[14:15], v235 offset:10752
    v_mfma_f32_32x32x16_bf16 v[160:175], a[40:43], v[112:115], v[160:175]
    ds_read_b64_tr_b16 a[16:17], v232 offset:40960
    ds_read_b64_tr_b16 a[18:19], v232 offset:41472
    buffer_load_dwordx4 v239, s[32:35], s54 offen offset:1024 lds
    s_waitcnt lgkmcnt(4)
    v_mfma_f32_32x32x16_bf16 v[176:191], a[44:47], v[112:115], v[176:191]
    ds_read_b64_tr_b16 a[20:21], v233 offset:40960
    ds_read_b64_tr_b16 a[22:23], v233 offset:41472
    v_mfma_f32_32x32x16_bf16 v[192:207], a[0:3], v[112:115], v[192:207]
    ds_read_b64_tr_b16 a[24:25], v234 offset:40960
    ds_read_b64_tr_b16 a[26:27], v234 offset:41472
    buffer_load_dwordx4 v238, s[16:19], s55 offen offset:2048 lds
    v_mfma_f32_32x32x16_bf16 v[208:223], a[4:7], v[112:115], v[208:223]
    ds_read_b64_tr_b16 a[28:29], v235 offset:40960
    ds_read_b64_tr_b16 a[30:31], v235 offset:41472
    v_mfma_f32_32x32x16_bf16 a[112:127], a[8:11], v[112:115], a[112:127]
    ds_read_b64_tr_b16 a[32:33], v232 offset:43008
    ds_read_b64_tr_b16 a[34:35], v232 offset:43520
    buffer_load_dwordx4 v239, s[32:35], s55 offen offset:3072 lds
    s_waitcnt lgkmcnt(5)
    v_mfma_f32_32x32x16_bf16 a[128:143], a[12:15], v[112:115], a[128:143]
    ds_read_b64_tr_b16 a[36:37], v233 offset:43008
    ds_read_b64_tr_b16 a[38:39], v233 offset:43520
    v_mfma_f32_32x32x16_bf16 v[128:143], a[16:19], v[116:119], v[128:143]
    ds_read_b64_tr_b16 a[40:41], v234 offset:43008
    ds_read_b64_tr_b16 a[42:43], v234 offset:43520
    s_add_u32 s54, s54, 0x38000
    s_add_u32 m0, s73, 0
    s_add_u32 s49, s5, 0x40000
    buffer_load_dwordx4 v241, s[20:23], s49 offen lds
    v_mfma_f32_32x32x16_bf16 v[144:159], a[20:23], v[116:119], v[144:159]
    ds_read_b64_tr_b16 a[44:45], v235 offset:43008
    ds_read_b64_tr_b16 a[46:47], v235 offset:43520
    s_waitcnt lgkmcnt(4)
    v_mfma_f32_32x32x16_bf16 v[160:175], a[24:27], v[116:119], v[160:175]
    ds_read_b64_tr_b16 a[0:1], v232 offset:12288
    ds_read_b64_tr_b16 a[2:3], v232 offset:12800
    s_add_u32 m0, s73, 0x1000
    s_add_u32 s49, s5, 0x44000
    buffer_load_dwordx4 v241, s[20:23], s49 offen lds
    v_mfma_f32_32x32x16_bf16 v[176:191], a[28:31], v[116:119], v[176:191]
    ds_read_b64_tr_b16 a[4:5], v232 offset:45056
    ds_read_b64_tr_b16 a[6:7], v232 offset:45568
    v_mfma_f32_32x32x16_bf16 v[192:207], a[32:35], v[116:119], v[192:207]
    ds_read_b64_tr_b16 a[8:9], v233 offset:12288
    ds_read_b64_tr_b16 a[10:11], v233 offset:12800
    s_add_u32 m0, s73, 0x2000
    s_add_u32 s49, s5, 0x48000
    buffer_load_dwordx4 v241, s[20:23], s49 offen lds
    v_mfma_f32_32x32x16_bf16 v[208:223], a[36:39], v[116:119], v[208:223]
    ds_read_b64_tr_b16 a[12:13], v233 offset:45056
    ds_read_b64_tr_b16 a[14:15], v233 offset:45568
    s_waitcnt lgkmcnt(4)
    v_mfma_f32_32x32x16_bf16 a[112:127], a[40:43], v[116:119], a[112:127]
    ds_read_b64_tr_b16 a[16:17], v234 offset:12288
    ds_read_b64_tr_b16 a[18:19], v234 offset:12800
    s_add_u32 m0, s73, 0x3000
    s_add_u32 s49, s5, 0x4c000
    buffer_load_dwordx4 v241, s[20:23], s49 offen lds
    v_mfma_f32_32x32x16_bf16 a[128:143], a[44:47], v[116:119], a[128:143]
    ds_read_b64_tr_b16 a[20:21], v234 offset:45056
    ds_read_b64_tr_b16 a[22:23], v234 offset:45568
    v_mfma_f32_32x32x16_bf16 v[128:143], a[0:3], v[120:123], v[128:143]
    ds_read_b64_tr_b16 a[24:25], v235 offset:12288
    ds_read_b64_tr_b16 a[26:27], v235 offset:12800
    s_add_u32 m0, s73, 0x4000
    s_add_u32 s49, s5, 0x50000
    buffer_load_dwordx4 v241, s[20:23], s49 offen lds
    v_mfma_f32_32x32x16_bf16 v[128:143], a[4:7], v[124:127], v[128:143]
    ds_read_b64_tr_b16 a[28:29], v235 offset:45056
    ds_read_b64_tr_b16 a[30:31], v235 offset:45568
    s_waitcnt lgkmcnt(4)
    v_mfma_f32_32x32x16_bf16 v[144:159], a[8:11], v[120:123], v[144:159]
    ds_read_b64_tr_b16 a[32:33], v232 offset:14336
    ds_read_b64_tr_b16 a[34:35], v232 offset:14848
    s_add_u32 m0, s73, 0x5000
    s_add_u32 s49, s5, 0x54000
    buffer_load_dwordx4 v241, s[20:23], s49 offen lds
    v_mfma_f32_32x32x16_bf16 v[144:159], a[12:15], v[124:127], v[144:159]
    ds_read_b64_tr_b16 a[36:37], v232 offset:47104
    ds_read_b64_tr_b16 a[38:39], v232 offset:47616
    v_mul_f32 v128, v128, v136
    v_mul_f32 v129, v129, v137
    v_mul_f32 v130, v130, v138
    v_mul_f32 v131, v131, v139
    v_mul_f32 v132, v132, v140
    v_mul_f32 v133, v133, v141
    v_mul_f32 v134, v134, v142
    v_mul_f32 v135, v135, v143
    v_cvt_pk_bf16_f32 v128, v128, v129
    v_cvt_pk_bf16_f32 v129, v130, v131
    v_mfma_f32_32x32x16_bf16 v[160:175], a[16:19], v[120:123], v[160:175]
    ds_read_b64_tr_b16 a[40:41], v233 offset:14336
    ds_read_b64_tr_b16 a[42:43], v233 offset:14848
    s_add_u32 m0, s73, 0x6000
    s_add_u32 s49, s5, 0x58000
    buffer_load_dwordx4 v241, s[20:23], s49 offen lds
    v_cvt_pk_bf16_f32 v130, v132, v133
    v_cvt_pk_bf16_f32 v131, v134, v135
    buffer_store_dwordx4 v[128:131], v242, s[40:43], s59 offen sc1
    v_mul_f32 v144, v144, v152
    v_mul_f32 v145, v145, v153
    v_mfma_f32_32x32x16_bf16 v[160:175], a[20:23], v[124:127], v[160:175]
    ds_read_b64_tr_b16 a[44:45], v233 offset:47104
    ds_read_b64_tr_b16 a[46:47], v233 offset:47616
    v_mul_f32 v146, v146, v154
    v_mul_f32 v147, v147, v155
    v_mul_f32 v148, v148, v156
    v_mul_f32 v149, v149, v157
    v_mul_f32 v150, v150, v158
    v_mul_f32 v151, v151, v159
    v_cvt_pk_bf16_f32 v144, v144, v145
    v_cvt_pk_bf16_f32 v145, v146, v147
    v_cvt_pk_bf16_f32 v146, v148, v149
    s_waitcnt lgkmcnt(0)
    v_mfma_f32_32x32x16_bf16 v[176:191], a[24:27], v[120:123], v[176:191]
    ds_read_b64_tr_b16 a[0:1], v234 offset:14336
    ds_read_b64_tr_b16 a[2:3], v234 offset:14848
    v_cvt_pk_bf16_f32 v147, v150, v151
    buffer_store_dwordx4 v[144:147], v242, s[40:43], s59 offen offset:1024 sc1
    v_mul_f32 v160, v160, v168
    v_mul_f32 v161, v161, v169
    v_mul_f32 v162, v162, v170
    v_mul_f32 v163, v163, v171
    v_mul_f32 v164, v164, v172
    v_mul_f32 v165, v165, v173
    v_mul_f32 v166, v166, v174
    v_mfma_f32_32x32x16_bf16 v[176:191], a[28:31], v[124:127], v[176:191]
    ds_read_b64_tr_b16 a[4:5], v234 offset:47104
    ds_read_b64_tr_b16 a[6:7], v234 offset:47616
    v_mul_f32 v167, v167, v175
    v_cvt_pk_bf16_f32 v160, v160, v161
    v_cvt_pk_bf16_f32 v161, v162, v163
    v_cvt_pk_bf16_f32 v162, v164, v165
    v_cvt_pk_bf16_f32 v163, v166, v167
    buffer_store_dwordx4 v[160:163], v242, s[40:43], s59 offen offset:2048 sc1
    v_mfma_f32_32x32x16_bf16 v[192:207], a[32:35], v[120:123], v[192:207]
    ds_read_b64_tr_b16 a[8:9], v235 offset:14336
    ds_read_b64_tr_b16 a[10:11], v235 offset:14848
    s_waitcnt vmcnt(26)
    v_readfirstlane_b32 s56, v248
    s_nop 2
    s_cmp_eq_u32 s56, 0
    s_cbranch_scc1 L_tagspin_17
L_tagok_16:
    v_mul_f32 v176, v176, v184
    v_mul_f32 v177, v177, v185
    v_mul_f32 v178, v178, v186
    v_mfma_f32_32x32x16_bf16 v[192:207], a[36:39], v[124:127], v[192:207]
    ds_read_b64_tr_b16 a[12:13], v235 offset:47104
    ds_read_b64_tr_b16 a[14:15], v235 offset:47616
    v_mul_f32 v179, v179, v187
    v_mul_f32 v180, v180, v188
    v_mul_f32 v181, v181, v189
    s_add_u32 m0, s73, 0x7000
    s_add_u32 s49, s5, 0x5c000
    buffer_load_dwordx4 v241, s[20:23], s49 offen lds
    v_mul_f32 v182, v182, v190
    s_waitcnt vmcnt(15)
    s_barrier
    v_mfma_f32_32x32x16_bf16 v[208:223], a[40:43], v[120:123], v[208:223]
    ds_read_b64_tr_b16 a[16:17], v232 offset:16384
    ds_read_b64_tr_b16 a[18:19], v232 offset:16896
    v_mul_f32 v183, v183, v191
    v_cvt_pk_bf16_f32 v176, v176, v177
    v_cvt_pk_bf16_f32 v177, v178, v179
    v_cvt_pk_bf16_f32 v178, v180, v181
    v_cvt_pk_bf16_f32 v179, v182, v183
    buffer_store_dwordx4 v[176:179], v242, s[40:43], s59 offen offset:3072 sc1
    v_mul_f32 v192, v192, v200
    v_mul_f32 v193, v193, v201
    v_mul_f32 v194, v194, v202
    v_mfma_f32_32x32x16_bf16 v[208:223], a[44:47], v[124:127], v[208:223]
    ds_read_b64_tr_b16 a[20:21], v233 offset:16384
    ds_read_b64_tr_b16 a[22:23], v233 offset:16896
    v_mul_f32 v195, v195, v203
    v_mul_f32 v196, v196, v204
    v_mul_f32 v197, v197, v205
    v_mul_f32 v198, v198, v206
    v_mul_f32 v199, v199, v207
    v_cvt_pk_bf16_f32 v192, v192, v193
    v_cvt_pk_bf16_f32 v193, v194, v195
    v_cvt_pk_bf16_f32 v194, v196, v197
    v_cvt_pk_bf16_f32 v195, v198, v199
    s_waitcnt lgkmcnt(0)
    v_mfma_f32_32x32x16_bf16 a[112:127], a[0:3], v[120:123], a[112:127]
    ds_read_b64_tr_b16 a[24:25], v234 offset:16384
    ds_read_b64_tr_b16 a[26:27], v234 offset:16896
    s_add_u32 s60, s59, 0x1000
    buffer_store_dwordx4 v[192:195], v242, s[40:43], s60 offen sc1
    v_mul_f32 v208, v208, v216
    v_mul_f32 v209, v209, v217
    v_mul_f32 v210, v210, v218
    v_mul_f32 v211, v211, v219
    v_mul_f32 v212, v212, v220
    v_mul_f32 v213, v213, v221
    v_mul_f32 v214, v214, v222
    v_mfma_f32_32x32x16_bf16 a[112:127], a[4:7], v[124:127], a[112:127]
    ds_read_b64_tr_b16 a[28:29], v235 offset:16384
    ds_read_b64_tr_b16 a[30:31], v235 offset:16896
    v_mul_f32 v215, v215, v223
    s_add_u32 m0, s50, 0x1000
    s_add_u32 s55, s54, 0xd800
    buffer_load_dwordx4 v238, s[16:19], s54 offen lds
    v_cvt_pk_bf16_f32 v208, v208, v209
    v_cvt_pk_bf16_f32 v209, v210, v211
    v_cvt_pk_bf16_f32 v210, v212, v213
    v_cvt_pk_bf16_f32 v211, v214, v215
    s_add_u32 s60, s59, 0x1400
    buffer_store_dwordx4 v[208:211], v242, s[40:43], s60 offen sc1
    v_mfma_f32_32x32x16_bf16 a[128:143], a[8:11], v[120:123], a[128:143]
    ds_read_b64_tr_b16 a[32:33], v232 offset:18432
    ds_read_b64_tr_b16 a[34:35], v232 offset:18944
    v_accvgpr_read_b32 v192, a112
    v_accvgpr_read_b32 v193, a113
    v_accvgpr_read_b32 v194, a114
    v_accvgpr_read_b32 v195, a115
    v_accvgpr_read_b32 v196, a116
    v_accvgpr_read_b32 v197, a117
    v_accvgpr_read_b32 v198, a118
    v_accvgpr_read_b32 v199, a119
    v_mfma_f32_32x32x16_bf16 a[128:143], a[12:15], v[124:127], a[128:143]
    ds_read_b64_tr_b16 a[36:37], v233 offset:18432
    ds_read_b64_tr_b16 a[38:39], v233 offset:18944
    v_accvgpr_read_b32 v200, a120
    v_accvgpr_read_b32 v201, a121
    v_accvgpr_read_b32 v202, a122
    v_accvgpr_read_b32 v203, a123
    v_accvgpr_read_b32 v204, a124
    v_accvgpr_read_b32 v205, a125
    v_accvgpr_read_b32 v206, a126
    v_accvgpr_read_b32 v207, a127
    v_mul_f32 v192, v192, v200
    buffer_load_dwordx4 v239, s[32:35], s54 offen offset:1024 lds
    v_mfma_f32_32x32x16_bf16 v[128:143], a[16:19], v[0:3], 0
    ds_read_b64_tr_b16 a[40:41], v234 offset:18432
    ds_read_b64_tr_b16 a[42:43], v234 offset:18944
    v_mul_f32 v193, v193, v201
    v_mul_f32 v194, v194, v202
    v_mul_f32 v195, v195, v203
    v_mul_f32 v196, v196, v204
    v_mul_f32 v197, v197, v205
    v_mul_f32 v198, v198, v206
    v_mul_f32 v199, v199, v207
    v_mfma_f32_32x32x16_bf16 v[144:159], a[20:23], v[0:3], 0
    ds_read_b64_tr_b16 a[44:45], v235 offset:18432
    ds_read_b64_tr_b16 a[46:47], v235 offset:18944
    buffer_load_dwordx4 v238, s[16:19], s55 offen offset:2048 lds
    v_cvt_pk_bf16_f32 v192, v192, v193
    v_cvt_pk_bf16_f32 v193, v194, v195
    v_cvt_pk_bf16_f32 v194, v196, v197
    v_cvt_pk_bf16_f32 v195, v198, v199
    s_waitcnt lgkmcnt(2)
    v_mfma_f32_32x32x16_bf16 v[160:175], a[24:27], v[0:3], 0
    ds_read_b64_tr_b16 a[0:1], v232 offset:49152
    ds_read_b64_tr_b16 a[2:3], v232 offset:49664
    s_add_u32 s60, s59, 0x1800
    buffer_store_dwordx4 v[192:195], v242, s[40:43], s60 offen sc1
    v_accvgpr_read_b32 v208, a128
    v_accvgpr_read_b32 v209, a129
    v_accvgpr_read_b32 v210, a130
    v_accvgpr_read_b32 v211, a131
    v_mfma_f32_32x32x16_bf16 v[176:191], a[28:31], v[0:3], 0
    ds_read_b64_tr_b16 a[4:5], v233 offset:49152
    ds_read_b64_tr_b16 a[6:7], v233 offset:49664
    v_accvgpr_read_b32 v212, a132
    v_accvgpr_read_b32 v213, a133
    v_accvgpr_read_b32 v214, a134
    v_accvgpr_read_b32 v215, a135
    v_accvgpr_read_b32 v216, a136
    v_accvgpr_read_b32 v217, a137
    v_accvgpr_read_b32 v218, a138
    v_mfma_f32_32x32x16_bf16 v[128:143], a[32:35], v[4:7], v[128:143]
    ds_read_b64_tr_b16 a[8:9], v234 offset:49152
    ds_read_b64_tr_b16 a[10:11], v234 offset:49664
    v_accvgpr_read_b32 v219, a139
    v_accvgpr_read_b32 v220, a140
    v_accvgpr_read_b32 v221, a141
    buffer_load_dwordx4 v239, s[32:35], s55 offen offset:3072 lds
    v_accvgpr_read_b32 v222, a142
    v_accvgpr_read_b32 v223, a143
    v_mfma_f32_32x32x16_bf16 v[144:159], a[36:39], v[4:7], v[144:159]
    ds_read_b64_tr_b16 a[12:13], v235 offset:49152
    ds_read_b64_tr_b16 a[14:15], v235 offset:49664
    v_mul_f32 v208, v208, v216
    v_mul_f32 v209, v209, v217
    v_mul_f32 v210, v210, v218
    v_mul_f32 v211, v211, v219
    v_mul_f32 v212, v212, v220
    v_mul_f32 v213, v213, v221
    v_mul_f32 v214, v214, v222
    v_mfma_f32_32x32x16_bf16 v[160:175], a[40:43], v[4:7], v[160:175]
    ds_read_b64_tr_b16 a[16:17], v232 offset:51200
    ds_read_b64_tr_b16 a[18:19], v232 offset:51712
    s_add_u32 s54, s54, 0x38000
    s_cmp_eq_u32 s76, 2
    s_cselect_b32 s55, 0x1c0000, 0
    s_sub_u32 s54, s54, s55
    s_add_u32 m0, s50, 0x2000
    s_add_u32 s55, s54, 0xd800
    buffer_load_dwordx4 v238, s[16:19], s54 offen lds
    s_waitcnt lgkmcnt(2)
    v_mfma_f32_32x32x16_bf16 v[176:191], a[44:47], v[4:7], v[176:191]
    ds_read_b64_tr_b16 a[20:21], v233 offset:51200
    ds_read_b64_tr_b16 a[22:23], v233 offset:51712
    v_mul_f32 v215, v215, v223
    v_cvt_pk_bf16_f32 v208, v208, v209
    v_cvt_pk_bf16_f32 v209, v210, v211
    v_cvt_pk_bf16_f32 v210, v212, v213
    buffer_load_dwordx4 v239, s[32:35], s54 offen offset:1024 lds
    v_mfma_f32_32x32x16_bf16 v[128:143], a[0:3], v[8:11], v[128:143]
    ds_read_b64_tr_b16 a[24:25], v234 offset:51200
    ds_read_b64_tr_b16 a[26:27], v234 offset:51712
    v_cvt_pk_bf16_f32 v211, v214, v215
    s_add_u32 s60, s59, 0x1c00
    buffer_store_dwordx4 v[208:211], v242, s[40:43], s60 offen sc1
    v_mfma_f32_32x32x16_bf16 v[144:159], a[4:7], v[8:11], v[144:159]
    ds_read_b64_tr_b16 a[28:29], v235 offset:51200
    ds_read_b64_tr_b16 a[30:31], v235 offset:51712
    v_mfma_f32_32x32x16_bf16 v[160:175], a[8:11], v[8:11], v[160:175]
    ds_read_b64_tr_b16 a[32:33], v232 offset:20480
    ds_read_b64_tr_b16 a[34:35], v232 offset:20992
    v_mfma_f32_32x32x16_bf16 v[176:191], a[12:15], v[8:11], v[176:191]
L_padB_4:
    s_cbranch_execz L_backB
    ds_read_b64_tr_b16 a[36:37], v233 offset:20480
    ds_read_b64_tr_b16 a[38:39], v233 offset:20992
    buffer_load_dwordx4 v238, s[16:19], s55 offen offset:2048 lds
    buffer_load_dwordx4 v239, s[32:35], s55 offen offset:3072 lds
    s_add_u32 s54, s54, 0x38000
    s_waitcnt lgkmcnt(4)
    v_mfma_f32_32x32x16_bf16 v[128:143], a[16:19], v[12:15], v[128:143]
    ds_read_b64_tr_b16 a[40:41], v234 offset:20480
    ds_read_b64_tr_b16 a[42:43], v234 offset:20992
    v_mfma_f32_32x32x16_bf16 v[144:159], a[20:23], v[12:15], v[144:159]
    ds_read_b64_tr_b16 a[44:45], v235 offset:20480
    ds_read_b64_tr_b16 a[46:47], v235 offset:20992
    v_mfma_f32_32x32x16_bf16 v[160:175], a[24:27], v[12:15], v[160:175]
    ds_read_b64_tr_b16 a[0:1], v232 offset:22528
    ds_read_b64_tr_b16 a[2:3], v232 offset:23040
    v_mfma_f32_32x32x16_bf16 v[176:191], a[28:31], v[12:15], v[176:191]
    ds_read_b64_tr_b16 a[4:5], v233 offset:22528
    ds_read_b64_tr_b16 a[6:7], v233 offset:23040
    s_add_u32 s74, s6, 0
    buffer_load_dwordx4 a[104:107], v241, s[12:15], s74 offen
    s_waitcnt lgkmcnt(5)
    v_mfma_f32_32x32x16_bf16 v[128:143], a[32:35], v[16:19], v[128:143]
    ds_read_b64_tr_b16 a[8:9], v234 offset:22528
    ds_read_b64_tr_b16 a[10:11], v234 offset:23040
    v_mfma_f32_32x32x16_bf16 v[144:159], a[36:39], v[16:19], v[144:159]
    ds_read_b64_tr_b16 a[12:13], v235 offset:22528
    ds_read_b64_tr_b16 a[14:15], v235 offset:23040
    s_add_u32 s74, s6, 0x4000
    buffer_load_dwordx4 a[108:111], v241, s[12:15], s74 offen
    v_mfma_f32_32x32x16_bf16 v[160:175], a[40:43], v[16:19], v[160:175]
    ds_read_b64_tr_b16 a[16:17], v232 offset:53248
    ds_read_b64_tr_b16 a[18:19], v232 offset:53760
    s_waitcnt lgkmcnt(5)
    v_mfma_f32_32x32x16_bf16 v[176:191], a[44:47], v[16:19], v[176:191]
    ds_read_b64_tr_b16 a[20:21], v233 offset:53248
    ds_read_b64_tr_b16 a[22:23], v233 offset:53760
    s_add_u32 s74, s6, 0x8000
    buffer_load_dwordx4 a[112:115], v241, s[12:15], s74 offen
    v_mfma_f32_32x32x16_bf16 v[128:143], a[0:3], v[20:23], v[128:143]
    ds_read_b64_tr_b16 a[24:25], v234 offset:53248
    ds_read_b64_tr_b16 a[26:27], v234 offset:53760
    v_mfma_f32_32x32x16_bf16 v[144:159], a[4:7], v[20:23], v[144:159]
    ds_read_b64_tr_b16 a[28:29], v235 offset:53248
    ds_read_b64_tr_b16 a[30:31], v235 offset:53760
    s_add_u32 s74, s6, 0xc000
    buffer_load_dwordx4 a[116:119], v241, s[12:15], s74 offen
    s_waitcnt lgkmcnt(4)
    v_mfma_f32_32x32x16_bf16 v[160:175], a[8:11], v[20:23], v[160:175]
    ds_read_b64_tr_b16 a[32:33], v232 offset:55296
    ds_read_b64_tr_b16 a[34:35], v232 offset:55808
    v_mfma_f32_32x32x16_bf16 v[176:191], a[12:15], v[20:23], v[176:191]
    ds_read_b64_tr_b16 a[36:37], v233 offset:55296
    ds_read_b64_tr_b16 a[38:39], v233 offset:55808
    s_add_u32 s74, s7, 0
    buffer_load_dwordx4 a[120:123], v241, s[12:15], s74 offen
    v_mfma_f32_32x32x16_bf16 v[128:143], a[16:19], v[24:27], v[128:143]
    ds_read_b64_tr_b16 a[40:41], v234 offset:55296
    ds_read_b64_tr_b16 a[42:43], v234 offset:55808
    s_waitcnt vmcnt(7)
    buffer_store_dword v248, off, s[40:43], s57 sc1
    v_mfma_f32_32x32x16_bf16 v[144:159], a[20:23], v[24:27], v[144:159]
    ds_read_b64_tr_b16 a[44:45], v235 offset:55296
    ds_read_b64_tr_b16 a[46:47], v235 offset:55808
    s_barrier
    s_waitcnt lgkmcnt(4)
    v_mfma_f32_32x32x16_bf16 v[160:175], a[24:27], v[24:27], v[160:175]
    ds_read_b64_tr_b16 a[0:1], v232 offset:0
    ds_read_b64_tr_b16 a[2:3], v232 offset:512
    s_add_u32 m0, s50, 0x3000
    s_add_u32 s55, s54, 0xd800
    buffer_load_dwordx4 v238, s[16:19], s54 offen lds
    v_mfma_f32_32x32x16_bf16 v[176:191], a[28:31], v[24:27], v[176:191]
    ds_read_b64_tr_b16 a[4:5], v233 offset:0
    ds_read_b64_tr_b16 a[6:7], v233 offset:512
    buffer_load_dwordx4 v239, s[32:35], s54 offen offset:1024 lds
    v_mfma_f32_32x32x16_bf16 v[128:143], a[32:35], v[28:31], v[128:143]
    ds_read_b64_tr_b16 a[8:9], v234 offset:0
    ds_read_b64_tr_b16 a[10:11], v234 offset:512
    buffer_load_dwordx4 v238, s[16:19], s55 offen offset:2048 lds
    v_mfma_f32_32x32x16_bf16 v[144:159], a[36:39], v[28:31], v[144:159]
    ds_read_b64_tr_b16 a[12:13], v235 offset:0
    ds_read_b64_tr_b16 a[14:15], v235 offset:512
    buffer_load_dwordx4 v239, s[32:35], s55 offen offset:3072 lds
    s_add_u32 s54, s54, 0x38000
    s_waitcnt lgkmcnt(4)
    v_mfma_f32_32x32x16_bf16 v[160:175], a[40:43], v[28:31], v[160:175]
    ds_read_b64_tr_b16 a[16:17], v232 offset:2048
    ds_read_b64_tr_b16 a[18:19], v232 offset:2560
    s_cmp_eq_u32 s76, 1
    s_cselect_b32 s55, 0x1c0000, 0
    s_sub_u32 s54, s54, s55
    s_add_u32 m0, s50, 0x4000
    s_add_u32 s55, s54, 0xd800
    buffer_load_dwordx4 v238, s[16:19], s54 offen lds
    v_mfma_f32_32x32x16_bf16 v[176:191], a[44:47], v[28:31], v[176:191]
    ds_read_b64_tr_b16 a[20:21], v233 offset:2048
    ds_read_b64_tr_b16 a[22:23], v233 offset:2560
    buffer_load_dwordx4 v239, s[32:35], s54 offen offset:1024 lds
    v_mfma_f32_32x32x16_bf16 v[128:143], a[0:3], v[32:35], v[128:143]
    ds_read_b64_tr_b16 a[24:25], v234 offset:2048
    ds_read_b64_tr_b16 a[26:27], v234 offset:2560
    buffer_load_dwordx4 v238, s[16:19], s55 offen offset:2048 lds
    v_mfma_f32_32x32x16_bf16 v[144:159], a[4:7], v[32:35], v[144:159]
    ds_read_b64_tr_b16 a[28:29], v235 offset:2048
    ds_read_b64_tr_b16 a[30:31], v235 offset:2560
    buffer_load_dwordx4 v239, s[32:35], s55 offen offset:3072 lds
    s_waitcnt lgkmcnt(4)
    v_mfma_f32_32x32x16_bf16 v[160:175], a[8:11], v[32:35], v[160:175]
    ds_read_b64_tr_b16 a[32:33], v232 offset:32768
    ds_read_b64_tr_b16 a[34:35], v232 offset:33280
    s_add_u32 s54, s54, 0x38000
    v_mfma_f32_32x32x16_bf16 v[176:191], a[12:15], v[32:35], v[176:191]
    ds_read_b64_tr_b16 a[36:37], v233 offset:32768
    ds_read_b64_tr_b16 a[38:39], v233 offset:33280
    v_mfma_f32_32x32x16_bf16 v[128:143], a[16:19], v[36:39], v[128:143]
    ds_read_b64_tr_b16 a[40:41], v234 offset:32768
    ds_read_b64_tr_b16 a[42:43], v234 offset:33280
    v_mfma_f32_32x32x16_bf16 v[144:159], a[20:23], v[36:39], v[144:159]
    ds_read_b64_tr_b16 a[44:45], v235 offset:32768
    ds_read_b64_tr_b16 a[46:47], v235 offset:33280
    s_waitcnt lgkmcnt(6)
    v_mfma_f32_32x32x16_bf16 v[160:175], a[24:27], v[36:39], v[160:175]
    ds_read_b64_tr_b16 a[0:1], v232 offset:34816
    ds_read_b64_tr_b16 a[2:3], v232 offset:35328
    v_mfma_f32_32x32x16_bf16 v[176:191], a[28:31], v[36:39], v[176:191]
    ds_read_b64_tr_b16 a[4:5], v233 offset:34816
    ds_read_b64_tr_b16 a[6:7], v233 offset:35328
    v_mfma_f32_32x32x16_bf16 v[128:143], a[32:35], v[40:43], v[128:143]
    ds_read_b64_tr_b16 a[8:9], v234 offset:34816
    ds_read_b64_tr_b16 a[10:11], v234 offset:35328
    s_waitcnt lgkmcnt(6)
    v_mfma_f32_32x32x16_bf16 v[144:159], a[36:39], v[40:43], v[144:159]
    ds_read_b64_tr_b16 a[12:13], v235 offset:34816
    ds_read_b64_tr_b16 a[14:15], v235 offset:35328
    v_mfma_f32_32x32x16_bf16 v[160:175], a[40:43], v[40:43], v[160:175]
    ds_read_b64_tr_b16 a[16:17], v232 offset:4096
    ds_read_b64_tr_b16 a[18:19], v232 offset:4608
    v_mfma_f32_32x32x16_bf16 v[176:191], a[44:47], v[40:43], v[176:191]
    ds_read_b64_tr_b16 a[20:21], v233 offset:4096
    ds_read_b64_tr_b16 a[22:23], v233 offset:4608
    s_add_u32 s74, s7, 0x4000
    buffer_load_dwordx4 a[124:127], v241, s[12:15], s74 offen
    s_waitcnt lgkmcnt(5)
    v_mfma_f32_32x32x16_bf16 v[128:143], a[0:3], v[44:47], v[128:143]
    ds_read_b64_tr_b16 a[24:25], v234 offset:4096
    ds_read_b64_tr_b16 a[26:27], v234 offset:4608
    v_mfma_f32_32x32x16_bf16 v[144:159], a[4:7], v[44:47], v[144:159]
    ds_read_b64_tr_b16 a[28:29], v235 offset:4096
    ds_read_b64_tr_b16 a[30:31], v235 offset:4608
    s_add_u32 s74, s7, 0x8000
    buffer_load_dwordx4 a[128:131], v241, s[12:15], s74 offen
    v_mfma_f32_32x32x16_bf16 v[160:175], a[8:11], v[44:47], v[160:175]
    ds_read_b64_tr_b16 a[32:33], v232 offset:6144
    ds_read_b64_tr_b16 a[34:35], v232 offset:6656
    s_waitcnt lgkmcnt(5)
    v_mfma_f32_32x32x16_bf16 v[176:191], a[12:15], v[44:47], v[176:191]
    ds_read_b64_tr_b16 a[36:37], v233 offset:6144
    ds_read_b64_tr_b16 a[38:39], v233 offset:6656
    s_add_u32 s74, s7, 0xc000
    buffer_load_dwordx4 a[132:135], v241, s[12:15], s74 offen
    v_add_u32 v46, s50, v243
    v_mfma_f32_32x32x16_bf16 v[128:143], a[16:19], v[48:51], v[128:143]
    ds_read_b64_tr_b16 a[40:41], v234 offset:6144
    ds_read_b64_tr_b16 a[42:43], v234 offset:6656
    v_mfma_f32_32x32x16_bf16 v[144:159], a[20:23], v[48:51], v[144:159]
    ds_read_b64_tr_b16 a[44:45], v235 offset:6144
    ds_read_b64_tr_b16 a[46:47], v235 offset:6656
    s_add_u32 s74, s69, 0
    buffer_load_dwordx4 a[136:139], v241, s[12:15], s74 offen
    s_waitcnt lgkmcnt(4)
    v_mfma_f32_32x32x16_bf16 v[160:175], a[24:27], v[48:51], v[160:175]
    ds_read_b64_tr_b16 a[0:1], v232 offset:36864
    ds_read_b64_tr_b16 a[2:3], v232 offset:37376
    v_mfma_f32_32x32x16_bf16 v[176:191], a[28:31], v[48:51], v[176:191]
    ds_read_b64_tr_b16 a[4:5], v233 offset:36864
    ds_read_b64_tr_b16 a[6:7], v233 offset:37376
    s_add_u32 s74, s69, 0x4000
    buffer_load_dwordx4 a[140:143], v241, s[12:15], s74 offen
    v_mfma_f32_32x32x16_bf16 v[128:143], a[32:35], v[52:55], v[128:143]
    ds_read_b64_tr_b16 a[8:9], v234 offset:36864
    ds_read_b64_tr_b16 a[10:11], v234 offset:37376
    v_mfma_f32_32x32x16_bf16 v[144:159], a[36:39], v[52:55], v[144:159]
    ds_read_b64_tr_b16 a[12:13], v235 offset:36864
    ds_read_b64_tr_b16 a[14:15], v235 offset:37376
    s_add_u32 s74, s69, 0x8000
    buffer_load_dwordx4 v[192:195], v241, s[12:15], s74 offen
    s_waitcnt lgkmcnt(4)
    v_mfma_f32_32x32x16_bf16 v[160:175], a[40:43], v[52:55], v[160:175]
    ds_read_b64_tr_b16 a[16:17], v232 offset:38912
    ds_read_b64_tr_b16 a[18:19], v232 offset:39424
    v_mfma_f32_32x32x16_bf16 v[176:191], a[44:47], v[52:55], v[176:191]
    ds_read_b64_tr_b16 a[20:21], v233 offset:38912
    ds_read_b64_tr_b16 a[22:23], v233 offset:39424
    s_add_u32 s74, s69, 0xc000
    buffer_load_dwordx4 v[196:199], v241, s[12:15], s74 offen
    v_mfma_f32_32x32x16_bf16 v[128:143], a[0:3], v[56:59], v[128:143]
    ds_read_b64_tr_b16 a[24:25], v234 offset:38912
    ds_read_b64_tr_b16 a[26:27], v234 offset:39424
    v_mfma_f32_32x32x16_bf16 v[144:159], a[4:7], v[56:59], v[144:159]
    ds_read_b64_tr_b16 a[28:29], v235 offset:38912
    ds_read_b64_tr_b16 a[30:31], v235 offset:39424
    s_add_u32 s74, s81, 0x60000
    buffer_load_dwordx4 v[200:203], v241, s[20:23], s74 offen
    s_waitcnt vmcnt(8)
    s_barrier
    s_waitcnt lgkmcnt(4)
    v_mfma_f32_32x32x16_bf16 v[160:175], a[8:11], v[56:59], v[160:175]
    ds_read_b64_tr_b16 a[32:33], v232 offset:8192
    ds_read_b64_tr_b16 a[34:35], v232 offset:8704
    v_mfma_f32_32x32x16_bf16 v[176:191], a[12:15], v[56:59], v[176:191]
    ds_read_b64_tr_b16 a[36:37], v233 offset:8192
    ds_read_b64_tr_b16 a[38:39], v233 offset:8704
    buffer_load_dword v249, v250, s[40:43], s58 offen sc1
    v_mfma_f32_32x32x16_bf16 v[128:143], a[16:19], v[60:63], v[128:143]
    ds_read_b64_tr_b16 a[40:41], v234 offset:8192
    ds_read_b64_tr_b16 a[42:43], v234 offset:8704
    v_mfma_f32_32x32x16_bf16 v[144:159], a[20:23], v[60:63], v[144:159]
    ds_read_b64_tr_b16 a[44:45], v235 offset:8192
    ds_read_b64_tr_b16 a[46:47], v235 offset:8704
    s_add_u32 m0, s50, 0x5000
    s_add_u32 s55, s54, 0xd800
    buffer_load_dwordx4 v238, s[16:19], s54 offen lds
    s_waitcnt lgkmcnt(4)
    v_mfma_f32_32x32x16_bf16 v[160:175], a[24:27], v[60:63], v[160:175]
    ds_read_b64_tr_b16 a[0:1], v232 offset:10240
    ds_read_b64_tr_b16 a[2:3], v232 offset:10752
    v_mfma_f32_32x32x16_bf16 v[176:191], a[28:31], v[60:63], v[176:191]
    ds_read_b64_tr_b16 a[4:5], v233 offset:10240
    ds_read_b64_tr_b16 a[6:7], v233 offset:10752
    buffer_load_dwordx4 v239, s[32:35], s54 offen offset:1024 lds
    v_mfma_f32_32x32x16_bf16 v[128:143], a[32:35], v[64:67], v[128:143]
    ds_read_b64_tr_b16 a[8:9], v234 offset:10240
    ds_read_b64_tr_b16 a[10:11], v234 offset:10752
    buffer_load_dwordx4 v238, s[16:19], s55 offen offset:2048 lds
    buffer_load_dwordx4 v239, s[32:35], s55 offen offset:3072 lds
    v_mfma_f32_32x32x16_bf16 v[144:159], a[36:39], v[64:67], v[144:159]
    ds_read_b64_tr_b16 a[12:13], v235 offset:10240
    ds_read_b64_tr_b16 a[14:15], v235 offset:10752
    s_waitcnt lgkmcnt(4)
    v_mfma_f32_32x32x16_bf16 v[160:175], a[40:43], v[64:67], v[160:175]
    ds_read_b64_tr_b16 a[16:17], v232 offset:40960
    ds_read_b64_tr_b16 a[18:19], v232 offset:41472
    v_mfma_f32_32x32x16_bf16 v[176:191], a[44:47], v[64:67], v[176:191]
    ds_read_b64_tr_b16 a[20:21], v233 offset:40960
    ds_read_b64_tr_b16 a[22:23], v233 offset:41472
    v_mfma_f32_32x32x16_bf16 v[128:143], a[0:3], v[68:71], v[128:143]
    ds_read_b64_tr_b16 a[24:25], v234 offset:40960
    ds_read_b64_tr_b16 a[26:27], v234 offset:41472
    v_mfma_f32_32x32x16_bf16 v[144:159], a[4:7], v[68:71], v[144:159]
    ds_read_b64_tr_b16 a[28:29], v235 offset:40960
    ds_read_b64_tr_b16 a[30:31], v235 offset:41472
    s_add_u32 m0, s50, 0
    s_add_u32 s49, s82, 0
    buffer_load_dwordx4 v241, s[20:23], s49 offen lds
    s_waitcnt lgkmcnt(4)
    v_mfma_f32_32x32x16_bf16 v[160:175], a[8:11], v[68:71], v[160:175]
    ds_read_b64_tr_b16 a[32:33], v232 offset:43008
    ds_read_b64_tr_b16 a[34:35], v232 offset:43520
    v_mfma_f32_32x32x16_bf16 v[176:191], a[12:15], v[68:71], v[176:191]
    ds_read_b64_tr_b16 a[36:37], v233 offset:43008
    ds_read_b64_tr_b16 a[38:39], v233 offset:43520
    s_add_u32 m0, s50, 0x400
    s_add_u32 s49, s82, 0x4000
    buffer_load_dwordx4 v241, s[20:23], s49 offen lds
    v_mfma_f32_32x32x16_bf16 v[128:143], a[16:19], v[72:75], v[128:143]
    ds_read_b64_tr_b16 a[40:41], v234 offset:43008
    ds_read_b64_tr_b16 a[42:43], v234 offset:43520
    v_mfma_f32_32x32x16_bf16 v[144:159], a[20:23], v[72:75], v[144:159]
    ds_read_b64_tr_b16 a[44:45], v235 offset:43008
    ds_read_b64_tr_b16 a[46:47], v235 offset:43520
    s_add_u32 m0, s50, 0x800
    s_add_u32 s49, s82, 0x8000
    buffer_load_dwordx4 v241, s[20:23], s49 offen lds
    s_waitcnt lgkmcnt(4)
    v_mfma_f32_32x32x16_bf16 v[160:175], a[24:27], v[72:75], v[160:175]
    ds_read_b64_tr_b16 a[0:1], v232 offset:12288
    ds_read_b64_tr_b16 a[2:3], v232 offset:12800
    v_mfma_f32_32x32x16_bf16 v[176:191], a[28:31], v[72:75], v[176:191]
    ds_read_b64_tr_b16 a[4:5], v232 offset:14336
    ds_read_b64_tr_b16 a[6:7], v232 offset:14848
    s_add_u32 m0, s50, 0xc00
    s_add_u32 s49, s82, 0xc000
    buffer_load_dwordx4 v241, s[20:23], s49 offen lds
    v_mfma_f32_32x32x16_bf16 v[128:143], a[32:35], v[76:79], v[128:143]
    ds_read_b64_tr_b16 a[8:9], v232 offset:45056
    ds_read_b64_tr_b16 a[10:11], v232 offset:45568
    v_mfma_f32_32x32x16_bf16 v[144:159], a[36:39], v[76:79], v[144:159]
    ds_read_b64_tr_b16 a[12:13], v232 offset:47104
    ds_read_b64_tr_b16 a[14:15], v232 offset:47616
    s_add_u32 s74, s81, 0x64000
    buffer_load_dwordx4 v[204:207], v241, s[20:23], s74 offen
    s_waitcnt lgkmcnt(4)
    v_mfma_f32_32x32x16_bf16 v[160:175], a[40:43], v[76:79], v[160:175]
    ds_read_b64_tr_b16 a[16:17], v232 offset:16384
    ds_read_b64_tr_b16 a[18:19], v232 offset:16896
    v_mfma_f32_32x32x16_bf16 v[176:191], a[44:47], v[76:79], v[176:191]
    ds_read_b64_tr_b16 a[20:21], v232 offset:18432
    ds_read_b64_tr_b16 a[22:23], v232 offset:18944
    v_mfma_f32_32x32x16_bf16 v[128:143], a[0:3], v[80:83], v[128:143]
    ds_read_b64_tr_b16 a[24:25], v232 offset:49152
    ds_read_b64_tr_b16 a[26:27], v232 offset:49664
    v_mfma_f32_32x32x16_bf16 v[128:143], a[4:7], v[84:87], v[128:143]
    ds_read_b64_tr_b16 a[28:29], v232 offset:51200
    ds_read_b64_tr_b16 a[30:31], v232 offset:51712
    s_waitcnt vmcnt(5)
    s_barrier
    s_waitcnt lgkmcnt(5)
    v_mfma_f32_32x32x16_bf16 v[128:143], a[8:11], v[88:91], v[128:143]
    ds_read_b64_tr_b16 a[32:33], v232 offset:20480
    ds_read_b64_tr_b16 a[34:35], v232 offset:20992
    s_add_u32 m0, s50, 0x1000
    s_add_u32 s49, s82, 0x10000
    buffer_load_dwordx4 v241, s[20:23], s49 offen lds
    v_mfma_f32_32x32x16_bf16 v[128:143], a[12:15], v[92:95], v[128:143]
    ds_read_b64_tr_b16 a[36:37], v232 offset:22528
    ds_read_b64_tr_b16 a[38:39], v232 offset:23040
    s_add_u32 m0, s50, 0x1400
    s_add_u32 s49, s82, 0x14000
    buffer_load_dwordx4 v241, s[20:23], s49 offen lds
    v_mfma_f32_32x32x16_bf16 v[128:143], a[16:19], v[96:99], v[128:143]
    ds_read_b64_tr_b16 a[40:41], v232 offset:53248
    ds_read_b64_tr_b16 a[42:43], v232 offset:53760
    v_cmp_ne_u32 vcc, s56, v249
    s_cbranch_vccnz L_gatespin_19
L_gateok_18:
    s_lshr_b32 s48, s81, 4
    s_add_u32 s48, s48, s78
    s_add_u32 s48, s48, 0x4000
    buffer_load_dwordx4 v[0:3], v242, s[40:43], s48 offen sc1
    s_waitcnt lgkmcnt(2)
    v_mfma_f32_32x32x16_bf16 v[128:143], a[20:23], v[100:103], v[128:143]
    ds_read_b64_tr_b16 a[44:45], v232 offset:55296
    ds_read_b64_tr_b16 a[46:47], v232 offset:55808
    buffer_load_dwordx4 v[4:7], v242, s[40:43], s48 offen offset:1024 sc1
    v_mfma_f32_32x32x16_bf16 v[128:143], a[24:27], v[104:107], v[128:143]
    ds_read_b64_tr_b16 a[0:1], v233 offset:12288
    ds_read_b64_tr_b16 a[2:3], v233 offset:12800
    v_mfma_f32_32x32x16_bf16 v[128:143], a[28:31], v[108:111], v[128:143]
    ds_read_b64_tr_b16 a[4:5], v233 offset:14336
    ds_read_b64_tr_b16 a[6:7], v233 offset:14848
    buffer_load_dwordx4 v[8:11], v242, s[40:43], s48 offen offset:2048 sc1
    v_mfma_f32_32x32x16_bf16 v[128:143], a[32:35], v[112:115], v[128:143]
    ds_read_b64_tr_b16 a[8:9], v233 offset:45056
    ds_read_b64_tr_b16 a[10:11], v233 offset:45568
    v_mfma_f32_32x32x16_bf16 v[128:143], a[36:39], v[116:119], v[128:143]
    ds_read_b64_tr_b16 a[12:13], v233 offset:47104
    ds_read_b64_tr_b16 a[14:15], v233 offset:47616
    buffer_load_dwordx4 v[12:15], v242, s[40:43], s48 offen offset:3072 sc1
    s_waitcnt lgkmcnt(5)
    v_mfma_f32_32x32x16_bf16 v[128:143], a[40:43], v[120:123], v[128:143]
    ds_read_b64_tr_b16 a[16:17], v233 offset:16384
    ds_read_b64_tr_b16 a[18:19], v233 offset:16896
    v_mfma_f32_32x32x16_bf16 v[128:143], a[44:47], v[124:127], v[128:143]
    ds_read_b64_tr_b16 a[20:21], v233 offset:18432
    ds_read_b64_tr_b16 a[22:23], v233 offset:18944
    s_lshr_b32 s48, s81, 4
    s_add_u32 s48, s48, s78
    s_add_u32 s48, s48, 0x5000
    buffer_load_dwordx4 v[16:19], v242, s[40:43], s48 offen sc1
    v_mfma_f32_32x32x16_bf16 v[144:159], a[0:3], v[80:83], v[144:159]
    ds_read_b64_tr_b16 a[24:25], v233 offset:49152
    ds_read_b64_tr_b16 a[26:27], v233 offset:49664
    s_waitcnt lgkmcnt(4)
    v_mfma_f32_32x32x16_bf16 v[144:159], a[4:7], v[84:87], v[144:159]
    ds_read_b64_tr_b16 a[28:29], v233 offset:51200
    ds_read_b64_tr_b16 a[30:31], v233 offset:51712
    v_mul_f32 v128, v128, v136
    v_mul_f32 v129, v129, v137
    v_mul_f32 v130, v130, v138
    v_mul_f32 v131, v131, v139
    v_mul_f32 v132, v132, v140
    v_mul_f32 v133, v133, v141
    buffer_load_dwordx4 v[20:23], v242, s[40:43], s48 offen offset:1024 sc1
    v_mfma_f32_32x32x16_bf16 v[144:159], a[8:11], v[88:91], v[144:159]
    ds_read_b64_tr_b16 a[32:33], v233 offset:20480
    ds_read_b64_tr_b16 a[34:35], v233 offset:20992
    v_mul_f32 v134, v134, v142
    v_mul_f32 v135, v135, v143
    v_cvt_pk_bf16_f32 v128, v128, v129
    v_cvt_pk_bf16_f32 v129, v130, v131
    v_mfma_f32_32x32x16_bf16 v[144:159], a[12:15], v[92:95], v[144:159]
    ds_read_b64_tr_b16 a[36:37], v233 offset:22528
    ds_read_b64_tr_b16 a[38:39], v233 offset:23040
    v_cvt_pk_bf16_f32 v130, v132, v133
    v_cvt_pk_bf16_f32 v131, v134, v135
    buffer_store_dwordx4 v[128:131], v242, s[40:43], s61 offen sc1
    v_mfma_f32_32x32x16_bf16 v[144:159], a[16:19], v[96:99], v[144:159]
    ds_read_b64_tr_b16 a[40:41], v233 offset:53248
    ds_read_b64_tr_b16 a[42:43], v233 offset:53760
    s_waitcnt lgkmcnt(4)
    v_mfma_f32_32x32x16_bf16 v[144:159], a[20:23], v[100:103], v[144:159]
    ds_read_b64_tr_b16 a[44:45], v233 offset:55296
    ds_read_b64_tr_b16 a[46:47], v233 offset:55808
    buffer_load_dwordx4 v[24:27], v242, s[40:43], s48 offen offset:2048 sc1
    v_mfma_f32_32x32x16_bf16 v[144:159], a[24:27], v[104:107], v[144:159]
    ds_read_b64_tr_b16 a[0:1], v234 offset:12288
    ds_read_b64_tr_b16 a[2:3], v234 offset:12800
    v_mfma_f32_32x32x16_bf16 v[144:159], a[28:31], v[108:111], v[144:159]
    ds_read_b64_tr_b16 a[4:5], v234 offset:14336
    ds_read_b64_tr_b16 a[6:7], v234 offset:14848
    buffer_load_dwordx4 v[28:31], v242, s[40:43], s48 offen offset:3072 sc1
    v_mfma_f32_32x32x16_bf16 v[144:159], a[32:35], v[112:115], v[144:159]
    ds_read_b64_tr_b16 a[8:9], v234 offset:45056
    ds_read_b64_tr_b16 a[10:11], v234 offset:45568
    s_waitcnt lgkmcnt(6)
    v_mfma_f32_32x32x16_bf16 v[144:159], a[36:39], v[116:119], v[144:159]
    ds_read_b64_tr_b16 a[12:13], v234 offset:47104
    ds_read_b64_tr_b16 a[14:15], v234 offset:47616
    s_lshr_b32 s48, s0, 4
    s_add_u32 s48, s48, s78
    s_add_u32 s48, s48, 0x4000
    buffer_load_dwordx4 v[48:51], v242, s[40:43], s48 offen sc1
    v_mfma_f32_32x32x16_bf16 v[144:159], a[40:43], v[120:123], v[144:159]
    ds_read_b64_tr_b16 a[16:17], v234 offset:16384
    ds_read_b64_tr_b16 a[18:19], v234 offset:16896
    v_mfma_f32_32x32x16_bf16 v[144:159], a[44:47], v[124:127], v[144:159]
    ds_read_b64_tr_b16 a[20:21], v234 offset:18432
    ds_read_b64_tr_b16 a[22:23], v234 offset:18944
    buffer_load_dwordx4 v[52:55], v242, s[40:43], s48 offen offset:1024 sc1
    s_waitcnt lgkmcnt(4)
    v_mfma_f32_32x32x16_bf16 v[160:175], a[0:3], v[80:83], v[160:175]
    ds_read_b64_tr_b16 a[24:25], v234 offset:49152
    ds_read_b64_tr_b16 a[26:27], v234 offset:49664
    v_mfma_f32_32x32x16_bf16 v[160:175], a[4:7], v[84:87], v[160:175]
    ds_read_b64_tr_b16 a[28:29], v234 offset:51200
    ds_read_b64_tr_b16 a[30:31], v234 offset:51712
    buffer_load_dwordx4 v[56:59], v242, s[40:43], s48 offen offset:2048 sc1
    v_mfma_f32_32x32x16_bf16 v[160:175], a[8:11], v[88:91], v[160:175]
    ds_read_b64_tr_b16 a[32:33], v234 offset:20480
    ds_read_b64_tr_b16 a[34:35], v234 offset:20992
    v_mul_f32 v144, v144, v152
    v_mul_f32 v145, v145, v153
    v_mul_f32 v146, v146, v154
    v_mul_f32 v147, v147, v155
    v_mul_f32 v148, v148, v156
    v_mul_f32 v149, v149, v157
    buffer_load_dwordx4 v[60:63], v242, s[40:43], s48 offen offset:3072 sc1
    v_mfma_f32_32x32x16_bf16 v[160:175], a[12:15], v[92:95], v[160:175]
    ds_read_b64_tr_b16 a[36:37], v234 offset:22528
    ds_read_b64_tr_b16 a[38:39], v234 offset:23040
    v_mul_f32 v150, v150, v158
    v_mul_f32 v151, v151, v159
    v_cvt_pk_bf16_f32 v144, v144, v145
    s_waitcnt lgkmcnt(2)
    v_mfma_f32_32x32x16_bf16 v[160:175], a[16:19], v[96:99], v[160:175]
    ds_read_b64_tr_b16 a[40:41], v234 offset:53248
    ds_read_b64_tr_b16 a[42:43], v234 offset:53760
    v_cvt_pk_bf16_f32 v145, v146, v147
    v_cvt_pk_bf16_f32 v146, v148, v149
    v_cvt_pk_bf16_f32 v147, v150, v151
    buffer_store_dwordx4 v[144:147], v242, s[40:43], s61 offen offset:1024 sc1
    v_mfma_f32_32x32x16_bf16 v[160:175], a[20:23], v[100:103], v[160:175]
    ds_read_b64_tr_b16 a[44:45], v234 offset:55296
    ds_read_b64_tr_b16 a[46:47], v234 offset:55808
    v_mfma_f32_32x32x16_bf16 v[160:175], a[24:27], v[104:107], v[160:175]
    ds_read_b64_tr_b16 a[0:1], v235 offset:12288
    ds_read_b64_tr_b16 a[2:3], v235 offset:12800
    s_lshr_b32 s48, s0, 4
    s_add_u32 s48, s48, s78
    s_add_u32 s48, s48, 0x5000
    buffer_load_dwordx4 a[192:195], v242, s[40:43], s48 offen sc1
    v_mfma_f32_32x32x16_bf16 v[160:175], a[28:31], v[108:111], v[160:175]
    ds_read_b64_tr_b16 a[4:5], v235 offset:14336
    ds_read_b64_tr_b16 a[6:7], v235 offset:14848
    v_mfma_f32_32x32x16_bf16 v[160:175], a[32:35], v[112:115], v[160:175]
    ds_read_b64_tr_b16 a[8:9], v235 offset:45056
    ds_read_b64_tr_b16 a[10:11], v235 offset:45568
    buffer_load_dwordx4 a[160:163], v242, s[40:43], s48 offen offset:1024 sc1
    s_waitcnt lgkmcnt(4)
    v_mfma_f32_32x32x16_bf16 v[160:175], a[36:39], v[116:119], v[160:175]
    ds_read_b64_tr_b16 a[12:13], v235 offset:47104
    ds_read_b64_tr_b16 a[14:15], v235 offset:47616
    v_mfma_f32_32x32x16_bf16 v[160:175], a[40:43], v[120:123], v[160:175]
    ds_read_b64_tr_b16 a[16:17], v235 offset:16384
    ds_read_b64_tr_b16 a[18:19], v235 offset:16896
    buffer_load_dwordx4 a[164:167], v242, s[40:43], s48 offen offset:2048 sc1
    v_mfma_f32_32x32x16_bf16 v[160:175], a[44:47], v[124:127], v[160:175]
    ds_read_b64_tr_b16 a[20:21], v235 offset:18432
    ds_read_b64_tr_b16 a[22:23], v235 offset:18944
    v_mfma_f32_32x32x16_bf16 v[176:191], a[0:3], v[80:83], v[176:191]
    ds_read_b64_tr_b16 a[24:25], v235 offset:49152
    ds_read_b64_tr_b16 a[26:27], v235 offset:49664
    buffer_load_dwordx4 a[168:171], v242, s[40:43], s48 offen offset:3072 sc1
    s_waitcnt lgkmcnt(5)
    v_mfma_f32_32x32x16_bf16 v[176:191], a[4:7], v[84:87], v[176:191]
    ds_read_b64_tr_b16 a[28:29], v235 offset:51200
    ds_read_b64_tr_b16 a[30:31], v235 offset:51712
    v_mfma_f32_32x32x16_bf16 v[176:191], a[8:11], v[88:91], v[176:191]
    ds_read_b64_tr_b16 a[32:33], v235 offset:20480
    ds_read_b64_tr_b16 a[34:35], v235 offset:20992
    v_mul_f32 v160, v160, v168
    v_mul_f32 v161, v161, v169
    v_mul_f32 v162, v162, v170
    v_mul_f32 v163, v163, v171
    v_mul_f32 v164, v164, v172
    v_mul_f32 v165, v165, v173
    s_lshr_b32 s48, s1, 4
    s_add_u32 s48, s48, s78
    v_mfma_f32_32x32x16_bf16 v[176:191], a[12:15], v[92:95], v[176:191]
    ds_read_b64_tr_b16 a[36:37], v235 offset:22528
    ds_read_b64_tr_b16 a[38:39], v235 offset:23040
    v_mul_f32 v166, v166, v174
    v_mul_f32 v167, v167, v175
    v_cvt_pk_bf16_f32 v160, v160, v161
    s_add_u32 s48, s48, 0x4000
    buffer_load_dwordx4 a[172:175], v242, s[40:43], s48 offen sc1
    s_waitcnt lgkmcnt(2)
    v_mfma_f32_32x32x16_bf16 v[176:191], a[16:19], v[96:99], v[176:191]
    ds_read_b64_tr_b16 a[40:41], v235 offset:53248
    ds_read_b64_tr_b16 a[42:43], v235 offset:53760
    v_cvt_pk_bf16_f32 v161, v162, v163
    v_cvt_pk_bf16_f32 v162, v164, v165
    v_cvt_pk_bf16_f32 v163, v166, v167
    buffer_store_dwordx4 v[160:163], v242, s[40:43], s61 offen offset:2048 sc1
    v_mfma_f32_32x32x16_bf16 v[176:191], a[20:23], v[100:103], v[176:191]
    ds_read_b64_tr_b16 a[44:45], v235 offset:55296
    ds_read_b64_tr_b16 a[46:47], v235 offset:55808
    s_barrier
    v_mfma_f32_32x32x16_bf16 v[176:191], a[24:27], v[104:107], v[176:191]
    buffer_load_dwordx4 a[176:179], v242, s[40:43], s48 offen offset:1024 sc1
    ds_write_b128 v46, a[104:107] offset:12288
    ds_write_b128 v46, a[108:111] offset:13312
    v_mfma_f32_32x32x16_bf16 v[176:191], a[28:31], v[108:111], v[176:191]
    ds_write_b128 v46, a[112:115] offset:14336
    ds_write_b128 v46, a[116:119] offset:15360
    v_mfma_f32_32x32x16_bf16 v[176:191], a[32:35], v[112:115], v[176:191]
    s_waitcnt vmcnt(7)
    buffer_store_dword v248, off, s[40:43], s57 offset:256 sc1
    s_waitcnt lgkmcnt(4)
    v_mfma_f32_32x32x16_bf16 v[176:191], a[36:39], v[116:119], v[176:191]
    v_mfma_f32_32x32x16_bf16 v[176:191], a[40:43], v[120:123], v[176:191]
    buffer_load_dwordx4 a[180:183], v242, s[40:43], s48 offen offset:2048 sc1
    v_mfma_f32_32x32x16_bf16 v[176:191], a[44:47], v[124:127], v[176:191]
    v_mfma_f32_32x32x16_bf16 v[64:79], a[200:203], v[0:3], 0
    buffer_load_dwordx4 a[184:187], v242, s[40:43], s48 offen offset:3072 sc1
    v_mfma_f32_32x32x16_bf16 v[80:95], a[204:207], v[0:3], 0
    s_lshr_b32 s48, s1, 4
    s_add_u32 s48, s48, s78
    s_add_u32 s48, s48, 0x5000
    buffer_load_dwordx4 a[188:191], v242, s[40:43], s48 offen sc1
    v_mfma_f32_32x32x16_bf16 v[64:79], a[208:211], v[4:7], v[64:79]
    buffer_load_dwordx4 a[104:107], v242, s[40:43], s48 offen offset:1024 sc1
    v_mfma_f32_32x32x16_bf16 v[80:95], a[212:215], v[4:7], v[80:95]
    buffer_load_dwordx4 a[200:203], v242, s[40:43], s48 offen offset:2048 sc1
    v_mfma_f32_32x32x16_bf16 v[64:79], a[216:219], v[8:11], v[64:79]
    v_mul_f32 v176, v176, v184
    v_mul_f32 v177, v177, v185
    v_mul_f32 v178, v178, v186
    v_mul_f32 v179, v179, v187
    v_mul_f32 v180, v180, v188
    v_mul_f32 v181, v181, v189
    v_mul_f32 v182, v182, v190
    v_mul_f32 v183, v183, v191
    v_cvt_pk_bf16_f32 v176, v176, v177
    v_cvt_pk_bf16_f32 v177, v178, v179
    v_cvt_pk_bf16_f32 v178, v180, v181
    v_cvt_pk_bf16_f32 v179, v182, v183
    buffer_store_dwordx4 v[176:179], v242, s[40:43], s61 offen offset:3072 sc1
    buffer_load_dwordx4 v[0:3], v242, s[40:43], s48 offen offset:3072 sc1
L_padB_5:
    s_cbranch_execz L_backB
    v_mfma_f32_32x32x16_bf16 v[80:95], a[220:223], v[8:11], v[80:95]
    s_lshr_b32 s48, s5, 4
    s_add_u32 s48, s48, s78
    s_add_u32 s48, s48, 0x4000
    buffer_load_dwordx4 v[4:7], v242, s[40:43], s48 offen sc1
    v_mfma_f32_32x32x16_bf16 v[64:79], a[224:227], v[12:15], v[64:79]
    buffer_load_dwordx4 v[128:131], v242, s[40:43], s48 offen offset:1024 sc1
    v_mfma_f32_32x32x16_bf16 v[80:95], a[228:231], v[12:15], v[80:95]
    buffer_load_dwordx4 v[132:135], v242, s[40:43], s48 offen offset:2048 sc1
    v_mfma_f32_32x32x16_bf16 v[64:79], a[232:235], v[16:19], v[64:79]
    buffer_load_dwordx4 v[8:11], v242, s[40:43], s48 offen offset:3072 sc1
    v_mfma_f32_32x32x16_bf16 v[80:95], a[236:239], v[16:19], v[80:95]
    s_lshr_b32 s48, s5, 4
    s_add_u32 s48, s48, s78
    s_add_u32 s48, s48, 0x5000
    buffer_load_dwordx4 v[136:139], v242, s[40:43], s48 offen sc1
    s_barrier
    v_mfma_f32_32x32x16_bf16 v[64:79], a[240:243], v[20:23], v[64:79]
    buffer_load_dword v36, v250, s[40:43], s58 offen offset:128 sc1
    ds_write_b128 v46, a[120:123] offset:16384
    ds_write_b128 v46, a[124:127] offset:17408
    v_mfma_f32_32x32x16_bf16 v[80:95], a[244:247], v[20:23], v[80:95]
    buffer_load_dwordx4 v[12:15], v242, s[40:43], s48 offen offset:1024 sc1
    ds_write_b128 v46, a[128:131] offset:18432
    v_mfma_f32_32x32x16_bf16 v[64:79], a[248:251], v[24:27], v[64:79]
    buffer_load_dwordx4 v[16:19], v242, s[40:43], s48 offen offset:2048 sc1
    ds_write_b128 v46, a[132:135] offset:19456
    v_mfma_f32_32x32x16_bf16 v[80:95], a[252:255], v[24:27], v[80:95]
    buffer_load_dwordx4 v[140:143], v242, s[40:43], s48 offen offset:3072 sc1
    ds_write_b128 v46, a[136:139] offset:20480
    ds_write_b128 v46, a[140:143] offset:21504
    v_mfma_f32_32x32x16_bf16 v[64:79], a[144:147], v[28:31], v[64:79]
    s_waitcnt vmcnt(10)
    buffer_store_dword v248, off, s[40:43], s57 offset:640 sc1
    s_add_u32 m0, s50, 0x1800
    s_add_u32 s49, s82, 0x18000
    buffer_load_dwordx4 v241, s[20:23], s49 offen lds
    v_mfma_f32_32x32x16_bf16 v[80:95], a[148:151], v[28:31], v[80:95]
    s_add_u32 m0, s50, 0x1c00
    s_add_u32 s49, s82, 0x1c000
    buffer_load_dwordx4 v241, s[20:23], s49 offen lds
    ds_write_b128 v46, v[192:195] offset:22528
    v_mfma_f32_32x32x16_bf16 v[64:79], a[152:155], v[48:51], v[64:79]
    s_add_u32 m0, s50, 0x2000
    s_add_u32 s49, s83, 0
    buffer_load_dwordx4 v241, s[12:15], s49 offen lds
    ds_write_b128 v46, v[196:199] offset:23552
    v_mfma_f32_32x32x16_bf16 v[80:95], a[156:159], v[48:51], v[80:95]
    s_add_u32 m0, s50, 0x2400
    s_add_u32 s49, s83, 0x4000
    buffer_load_dwordx4 v241, s[12:15], s49 offen lds
    v_mfma_f32_32x32x16_bf16 v[64:79], a[48:51], v[52:55], v[64:79]
    s_add_u32 m0, s50, 0x2800
    s_add_u32 s49, s83, 0x8000
    buffer_load_dwordx4 v241, s[12:15], s49 offen lds
    v_mfma_f32_32x32x16_bf16 v[80:95], a[52:55], v[52:55], v[80:95]
    s_add_u32 m0, s50, 0x2c00
    s_add_u32 s49, s83, 0xc000
    buffer_load_dwordx4 v241, s[12:15], s49 offen lds
    v_mfma_f32_32x32x16_bf16 v[64:79], a[56:59], v[56:59], v[64:79]
    v_mfma_f32_32x32x16_bf16 v[80:95], a[60:63], v[56:59], v[80:95]
    v_mfma_f32_32x32x16_bf16 v[64:79], a[64:67], v[60:63], v[64:79]
    v_mfma_f32_32x32x16_bf16 v[80:95], a[68:71], v[60:63], v[80:95]
    v_mfma_f32_32x32x16_bf16 v[64:79], a[72:75], a[192:195], v[64:79]
    v_mfma_f32_32x32x16_bf16 v[80:95], a[76:79], a[192:195], v[80:95]
    s_barrier
    v_mfma_f32_32x32x16_bf16 v[64:79], a[80:83], a[160:163], v[64:79]
    ds_read_b64_tr_b16 a[32:33], v251 offset:24576
    ds_read_b64_tr_b16 a[34:35], v251 offset:57344
    buffer_load_dword v47, v250, s[40:43], s58 offen offset:512 sc1
    v_mfma_f32_32x32x16_bf16 v[80:95], a[84:87], a[160:163], v[80:95]
    ds_read_b64_tr_b16 a[36:37], v252 offset:24576
    ds_read_b64_tr_b16 a[38:39], v252 offset:57344
    v_mfma_f32_32x32x16_bf16 v[64:79], a[88:91], a[164:167], v[64:79]
    ds_read_b64_tr_b16 a[40:41], v251 offset:25600
    ds_read_b64_tr_b16 a[42:43], v251 offset:58368
    v_mfma_f32_32x32x16_bf16 v[80:95], a[92:95], a[164:167], v[80:95]
    ds_read_b64_tr_b16 a[44:45], v252 offset:25600
    ds_read_b64_tr_b16 a[46:47], v252 offset:58368
    v_mfma_f32_32x32x16_bf16 v[64:79], a[96:99], a[168:171], v[64:79]
    ds_read_b64_tr_b16 a[0:1], v251 offset:26624
    ds_read_b64_tr_b16 a[2:3], v251 offset:59392
    v_lshrrev_b32 v32, 4, v243
    v_and_b32 v33, 31, v32
    v_lshrrev_b32 v34, 5, v32
    v_lshlrev_b32 v34, 3, v34
    s_lshr_b32 s51, s50, 3
    v_mfma_f32_32x32x16_bf16 v[80:95], a[100:103], a[168:171], v[80:95]
    ds_read_b64_tr_b16 a[4:5], v252 offset:26624
    ds_read_b64_tr_b16 a[6:7], v252 offset:59392
    s_add_u32 s51, s51, 0x20000
    v_add_u32 v232, s51, v243
    v_xor_b32 v233, 0x2000, v232
    s_and_b32 s51, s3, 1
    s_waitcnt lgkmcnt(2)
    v_mfma_f32_32x32x16_bf16 v[64:79], a[32:35], a[172:175], v[64:79]
    ds_read_b64_tr_b16 a[8:9], v251 offset:27648
    ds_read_b64_tr_b16 a[10:11], v251 offset:60416
    s_lshl_b32 s52, s51, 12
    s_add_u32 s52, s52, 0x24000
    v_lshlrev_b32 v35, 7, v33
    v_add3_u32 v238, v35, v34, s52
    v_and_b32 v35, 7, v32
    v_mfma_f32_32x32x16_bf16 v[80:95], a[36:39], a[172:175], v[80:95]
    ds_read_b64_tr_b16 a[12:13], v252 offset:27648
    ds_read_b64_tr_b16 a[14:15], v252 offset:60416
    v_lshlrev_b32 v35, 4, v35
    s_lshl_b32 s52, s70, 6
    v_xor_b32 v35, s52, v35
    v_add_u32 v238, v238, v35
    s_mul_i32 s51, s51, 0x1200
    v_mfma_f32_32x32x16_bf16 v[64:79], a[40:43], a[176:179], v[64:79]
    ds_read_b64_tr_b16 a[16:17], v251 offset:28672
    ds_read_b64_tr_b16 a[18:19], v251 offset:61440
    s_add_u32 s51, s51, s52
    s_add_u32 s51, s51, 0x20000
    v_mul_u32_u24 v33, 0x90, v33
    v_add3_u32 v244, v33, v34, s51
    v_lshrrev_b32 v33, 3, v32
    v_mfma_f32_32x32x16_bf16 v[80:95], a[44:47], a[176:179], v[80:95]
    ds_read_b64_tr_b16 a[20:21], v252 offset:28672
    ds_read_b64_tr_b16 a[22:23], v252 offset:61440
    v_and_b32 v34, 0x70, v243
    v_lshl_add_u32 v236, v33, 10, v34
    v_lshlrev_b32 v35, 4, v33
    v_xor_b32 v237, v236, v35
    s_mul_i32 s51, s3, 0x900
    v_mfma_f32_32x32x16_bf16 v[64:79], a[0:3], a[180:183], v[64:79]
    ds_read_b64_tr_b16 a[24:25], v251 offset:29696
    ds_read_b64_tr_b16 a[26:27], v251 offset:62464
    s_waitcnt vmcnt(11)
    v_cmp_ne_u32 vcc, s56, v36
    s_cbranch_vccnz L_gatespin_21
L_gateok_20:
    s_add_u32 s48, s79, 0
    buffer_load_dwordx4 v[20:23], v242, s[40:43], s48 offen sc1
    s_waitcnt lgkmcnt(2)
    v_mfma_f32_32x32x16_bf16 v[80:95], a[4:7], a[180:183], v[80:95]
    ds_read_b64_tr_b16 a[28:29], v252 offset:29696
    ds_read_b64_tr_b16 a[30:31], v252 offset:62464
    buffer_load_dwordx4 v[24:27], v242, s[40:43], s48 offen offset:1024 sc1
    s_add_u32 s51, s51, 0x20000
    v_mfma_f32_32x32x16_bf16 v[64:79], a[8:11], a[184:187], v[64:79]
    ds_read_b64_tr_b16 a[32:33], v251 offset:30720
    ds_read_b64_tr_b16 a[34:35], v251 offset:63488
    buffer_load_dwordx4 v[28:31], v242, s[40:43], s48 offen offset:2048 sc1
    v_mul_u32_u24 v33, 0x90, v33
    v_add3_u32 v245, v33, v34, s51
    v_mfma_f32_32x32x16_bf16 v[80:95], a[12:15], a[184:187], v[80:95]
    ds_read_b64_tr_b16 a[36:37], v252 offset:30720
    ds_read_b64_tr_b16 a[38:39], v252 offset:63488
    buffer_load_dwordx4 v[48:51], v242, s[40:43], s48 offen offset:3072 sc1
    v_mfma_f32_32x32x16_bf16 v[64:79], a[16:19], a[188:191], v[64:79]
    ds_read_b64_tr_b16 a[40:41], v251 offset:31744
    ds_read_b64_tr_b16 a[42:43], v251 offset:64512
    s_add_u32 s48, s79, 0x1000
    buffer_load_dwordx4 v[52:55], v242, s[40:43], s48 offen sc1
    v_mfma_f32_32x32x16_bf16 v[80:95], a[20:23], a[188:191], v[80:95]
    ds_read_b64_tr_b16 a[44:45], v252 offset:31744
    ds_read_b64_tr_b16 a[46:47], v252 offset:64512
    buffer_load_dwordx4 v[56:59], v242, s[40:43], s48 offen offset:1024 sc1
    s_barrier
    s_waitcnt lgkmcnt(4)
    v_mfma_f32_32x32x16_bf16 v[64:79], a[24:27], a[104:107], v[64:79]
    ds_read_b64_tr_b16 a[0:1], v253 offset:0
    ds_read_b64_tr_b16 a[2:3], v253 offset:1024
    buffer_load_dwordx4 v[60:63], v242, s[40:43], s48 offen offset:2048 sc1
    ds_write_b128 v46, v[200:203] offset:24576
    v_mfma_f32_32x32x16_bf16 v[80:95], a[28:31], a[104:107], v[80:95]
    ds_read_b64_tr_b16 a[4:5], v254 offset:0
    ds_read_b64_tr_b16 a[6:7], v254 offset:1024
    buffer_load_dwordx4 a[192:195], v242, s[40:43], s48 offen offset:3072 sc1
    ds_write_b128 v46, v[204:207] offset:25600
    v_mfma_f32_32x32x16_bf16 v[64:79], a[32:35], a[200:203], v[64:79]
    ds_read_b64_tr_b16 a[8:9], v253 offset:4096
    ds_read_b64_tr_b16 a[10:11], v253 offset:5120
    s_lshl_b32 s75, s3, 11
    s_add_u32 s75, s75, 0x24000
    s_add_u32 s72, s66, 0x2000
    buffer_load_dwordx4 v[224:227], v237, s[8:11], s66 offen
    v_mfma_f32_32x32x16_bf16 v[80:95], a[36:39], a[200:203], v[80:95]
    ds_read_b64_tr_b16 a[12:13], v254 offset:4096
    ds_read_b64_tr_b16 a[14:15], v254 offset:5120
    buffer_load_dwordx4 v[228:231], v237, s[8:11], s72 offen
    s_waitcnt lgkmcnt(3)
    v_mfma_f32_32x32x16_bf16 v[64:79], a[40:43], v[0:3], v[64:79]
    ds_read_b64_tr_b16 a[16:17], v253 offset:8192
    ds_read_b64_tr_b16 a[18:19], v253 offset:9216
    s_add_u32 m0, s50, 0x6800
    s_add_u32 s49, s0, 0x60000
    buffer_load_dwordx4 v241, s[20:23], s49 offen lds
    v_add_u32 v237, s75, v243
    v_mfma_f32_32x32x16_bf16 v[80:95], a[44:47], v[0:3], v[80:95]
    ds_read_b64_tr_b16 a[20:21], v254 offset:8192
    ds_read_b64_tr_b16 a[22:23], v254 offset:9216
    s_add_u32 m0, s50, 0x6c00
    s_add_u32 s49, s0, 0x64000
    buffer_load_dwordx4 v241, s[20:23], s49 offen lds
    v_mfma_f32_32x32x16_bf16 v[64:79], a[0:3], v[4:7], v[64:79]
    ds_read_b64_tr_b16 a[24:25], v253 offset:12288
    ds_read_b64_tr_b16 a[26:27], v253 offset:13312
    s_add_u32 m0, s50, 0x7000
    s_add_u32 s49, s1, 0x60000
    buffer_load_dwordx4 v241, s[20:23], s49 offen lds
    v_mfma_f32_32x32x16_bf16 v[80:95], a[4:7], v[4:7], v[80:95]
    ds_read_b64_tr_b16 a[28:29], v254 offset:12288
    ds_read_b64_tr_b16 a[30:31], v254 offset:13312
    s_waitcnt lgkmcnt(4)
    v_mfma_f32_32x32x16_bf16 v[64:79], a[8:11], v[128:131], v[64:79]
    ds_read_b64_tr_b16 a[32:33], v253 offset:16384
    ds_read_b64_tr_b16 a[34:35], v253 offset:17408
    buffer_load_dword v37, v250, s[40:43], s58 offen offset:256 sc1
    v_mfma_f32_32x32x16_bf16 v[80:95], a[12:15], v[128:131], v[80:95]
    ds_read_b64_tr_b16 a[36:37], v254 offset:16384
    ds_read_b64_tr_b16 a[38:39], v254 offset:17408
    v_mfma_f32_32x32x16_bf16 v[64:79], a[16:19], v[132:135], v[64:79]
    ds_read_b64_tr_b16 a[40:41], v253 offset:20480
    ds_read_b64_tr_b16 a[42:43], v253 offset:21504
    s_waitcnt vmcnt(14)
    v_cmp_ne_u32 vcc, s56, v47
    s_cbranch_vccnz L_gatespin_23
L_gateok_22:
    s_lshr_b32 s48, s83, 4
    s_add_u32 s48, s48, s80
    s_add_u32 s48, s48, 0x1c000
    buffer_load_dwordx4 a[160:163], v242, s[40:43], s48 offen sc1
    v_mfma_f32_32x32x16_bf16 v[80:95], a[20:23], v[132:135], v[80:95]
    ds_read_b64_tr_b16 a[44:45], v254 offset:20480
    ds_read_b64_tr_b16 a[46:47], v254 offset:21504
    buffer_load_dwordx4 a[164:167], v242, s[40:43], s48 offen offset:1024 sc1
    s_waitcnt lgkmcnt(2)
    v_mfma_f32_32x32x16_bf16 v[64:79], a[24:27], v[8:11], v[64:79]
    ds_read_b64_tr_b16 a[0:1], v253 offset:24576
    ds_read_b64_tr_b16 a[2:3], v253 offset:25600
    buffer_load_dwordx4 a[168:171], v242, s[40:43], s48 offen offset:2048 sc1
    v_mfma_f32_32x32x16_bf16 v[80:95], a[28:31], v[8:11], v[80:95]
    ds_read_b64_tr_b16 a[4:5], v254 offset:24576
    ds_read_b64_tr_b16 a[6:7], v254 offset:25600
    buffer_load_dwordx4 a[172:175], v242, s[40:43], s48 offen offset:3072 sc1
    v_mfma_f32_32x32x16_bf16 v[64:79], a[32:35], v[136:139], v[64:79]
    ds_read_b64_tr_b16 a[8:9], v253 offset:28672
    ds_read_b64_tr_b16 a[10:11], v253 offset:29696
    s_lshr_b32 s48, s6, 4
    s_add_u32 s48, s48, s80
    s_add_u32 s48, s48, 0x1c000
    buffer_load_dwordx4 a[176:179], v242, s[40:43], s48 offen sc1
    v_mfma_f32_32x32x16_bf16 v[80:95], a[36:39], v[136:139], v[80:95]
    ds_read_b64_tr_b16 a[12:13], v254 offset:28672
    ds_read_b64_tr_b16 a[14:15], v254 offset:29696
    buffer_load_dwordx4 a[180:183], v242, s[40:43], s48 offen offset:1024 sc1
    s_barrier
    v_mfma_f32_32x32x16_bf16 v[64:79], a[40:43], v[12:15], v[64:79]
    ds_read_b64_tr_b16 a[16:17], v251 offset:0
    ds_read_b64_tr_b16 a[18:19], v251 offset:32768
    buffer_load_dwordx4 a[184:187], v242, s[40:43], s48 offen offset:2048 sc1
    s_waitcnt lgkmcnt(4)
    v_mfma_f32_32x32x16_bf16 v[80:95], a[44:47], v[12:15], v[80:95]
    ds_read_b64_tr_b16 a[20:21], v252 offset:0
    ds_read_b64_tr_b16 a[22:23], v252 offset:32768
    buffer_load_dwordx4 a[188:191], v242, s[40:43], s48 offen offset:3072 sc1
    v_mfma_f32_32x32x16_bf16 v[64:79], a[0:3], v[16:19], v[64:79]
    ds_read_b64_tr_b16 a[24:25], v251 offset:1024
    ds_read_b64_tr_b16 a[26:27], v251 offset:33792
    s_lshr_b32 s48, s7, 4
    s_add_u32 s48, s48, s80
    s_add_u32 s48, s48, 0x1c000
    buffer_load_dwordx4 v[128:131], v242, s[40:43], s48 offen sc1
    v_mfma_f32_32x32x16_bf16 v[80:95], a[4:7], v[16:19], v[80:95]
    ds_read_b64_tr_b16 a[28:29], v252 offset:1024
    ds_read_b64_tr_b16 a[30:31], v252 offset:33792
    buffer_load_dwordx4 v[132:135], v242, s[40:43], s48 offen offset:1024 sc1
    v_mfma_f32_32x32x16_bf16 v[64:79], a[8:11], v[140:143], v[64:79]
    ds_read_b64_tr_b16 a[32:33], v251 offset:2048
    ds_read_b64_tr_b16 a[34:35], v251 offset:34816
    s_waitcnt lgkmcnt(4)
    v_mfma_f32_32x32x16_bf16 v[80:95], a[12:15], v[140:143], v[80:95]
    ds_read_b64_tr_b16 a[36:37], v252 offset:2048
    ds_read_b64_tr_b16 a[38:39], v252 offset:34816
    buffer_load_dwordx4 v[136:139], v242, s[40:43], s48 offen offset:2048 sc1
    s_waitcnt vmcnt(24)
    v_mfma_f32_32x32x16_bf16 v[64:79], a[16:19], v[20:23], v[64:79]
    ds_read_b64_tr_b16 a[40:41], v251 offset:3072
    ds_read_b64_tr_b16 a[42:43], v251 offset:35840
    buffer_load_dwordx4 v[144:147], v242, s[40:43], s48 offen offset:3072 sc1
    v_mfma_f32_32x32x16_bf16 v[80:95], a[20:23], v[20:23], v[80:95]
    ds_read_b64_tr_b16 a[44:45], v252 offset:3072
    ds_read_b64_tr_b16 a[46:47], v252 offset:35840
    s_waitcnt vmcnt(24)
    v_mfma_f32_32x32x16_bf16 v[64:79], a[24:27], v[24:27], v[64:79]
    ds_read_b64_tr_b16 a[0:1], v251 offset:4096
    ds_read_b64_tr_b16 a[2:3], v251 offset:36864
    buffer_load_dword v240, v250, s[40:43], s58 offen offset:640 sc1
    s_waitcnt lgkmcnt(4)
    v_mfma_f32_32x32x16_bf16 v[80:95], a[28:31], v[24:27], v[80:95]
    ds_read_b64_tr_b16 a[4:5], v252 offset:4096
    ds_read_b64_tr_b16 a[6:7], v252 offset:36864
    s_waitcnt vmcnt(24)
    v_mfma_f32_32x32x16_bf16 v[64:79], a[32:35], v[28:31], v[64:79]
    ds_read_b64_tr_b16 a[8:9], v251 offset:5120
    ds_read_b64_tr_b16 a[10:11], v251 offset:37888
    s_lshr_b32 s48, s69, 4
    s_add_u32 s48, s48, s80
    s_add_u32 s48, s48, 0x1c000
    buffer_load_dwordx4 v[140:143], v242, s[40:43], s48 offen sc1
    v_mfma_f32_32x32x16_bf16 v[80:95], a[36:39], v[28:31], v[80:95]
    ds_read_b64_tr_b16 a[12:13], v252 offset:5120
    ds_read_b64_tr_b16 a[14:15], v252 offset:37888
    buffer_load_dwordx4 v[148:151], v242, s[40:43], s48 offen offset:1024 sc1
    s_waitcnt vmcnt(25)
    v_mfma_f32_32x32x16_bf16 v[64:79], a[40:43], v[48:51], v[64:79]
    ds_read_b64_tr_b16 a[16:17], v251 offset:6144
    ds_read_b64_tr_b16 a[18:19], v251 offset:38912
    s_waitcnt lgkmcnt(4)
    v_mfma_f32_32x32x16_bf16 v[80:95], a[44:47], v[48:51], v[80:95]
    ds_read_b64_tr_b16 a[20:21], v252 offset:6144
    ds_read_b64_tr_b16 a[22:23], v252 offset:38912
    buffer_load_dwordx4 v[152:155], v242, s[40:43], s48 offen offset:2048 sc1
    s_waitcnt vmcnt(25)
    v_mfma_f32_32x32x16_bf16 v[64:79], a[0:3], v[52:55], v[64:79]
    ds_read_b64_tr_b16 a[24:25], v251 offset:7168
    ds_read_b64_tr_b16 a[26:27], v251 offset:39936
    v_mfma_f32_32x32x16_bf16 v[80:95], a[4:7], v[52:55], v[80:95]
    ds_read_b64_tr_b16 a[28:29], v252 offset:7168
    ds_read_b64_tr_b16 a[30:31], v252 offset:39936
    buffer_load_dwordx4 v[156:159], v242, s[40:43], s48 offen offset:3072 sc1
    s_barrier
    s_waitcnt vmcnt(25)
    v_mfma_f32_32x32x16_bf16 v[64:79], a[8:11], v[56:59], v[64:79]
    ds_read_b64_tr_b16 a[32:33], v251 offset:8192
    ds_read_b64_tr_b16 a[34:35], v251 offset:40960
    s_add_u32 m0, s50, 0x7400
    s_add_u32 s49, s1, 0x64000
    buffer_load_dwordx4 v241, s[20:23], s49 offen lds
    s_waitcnt lgkmcnt(2)
    v_mfma_f32_32x32x16_bf16 v[80:95], a[12:15], v[56:59], v[80:95]
    ds_read_b64_tr_b16 a[36:37], v252 offset:8192
    ds_read_b64_tr_b16 a[38:39], v252 offset:40960
    s_waitcnt vmcnt(25)
    v_mfma_f32_32x32x16_bf16 v[64:79], a[16:19], v[60:63], v[64:79]
    ds_read_b64_tr_b16 a[40:41], v251 offset:9216
    ds_read_b64_tr_b16 a[42:43], v251 offset:41984
    s_waitcnt vmcnt(18)
    v_cmp_ne_u32 vcc, s56, v37
    s_cbranch_vccnz L_gatespin_25
L_gateok_24:
    s_add_u32 m0, s50, 0x7800
    s_add_u32 s49, s5, 0x60000
    buffer_load_dwordx4 v241, s[20:23], s49 offen lds
    v_mfma_f32_32x32x16_bf16 v[80:95], a[20:23], v[60:63], v[80:95]
    ds_read_b64_tr_b16 a[44:45], v252 offset:9216
    ds_read_b64_tr_b16 a[46:47], v252 offset:41984
    v_mfma_f32_32x32x16_bf16 v[64:79], a[24:27], a[192:195], v[64:79]
    ds_read_b64_tr_b16 a[0:1], v251 offset:10240
    ds_read_b64_tr_b16 a[2:3], v251 offset:43008
    s_lshr_b32 s48, s81, 4
    s_add_u32 s48, s48, s78
    s_add_u32 s48, s48, 0x6000
    buffer_load_dwordx4 v[160:163], v242, s[40:43], s48 offen sc1
    v_mfma_f32_32x32x16_bf16 v[80:95], a[28:31], a[192:195], v[80:95]
    ds_read_b64_tr_b16 a[4:5], v252 offset:10240
    ds_read_b64_tr_b16 a[6:7], v252 offset:43008
    s_add_u32 m0, s50, 0x7c00
    s_add_u32 s49, s5, 0x64000
    buffer_load_dwordx4 v241, s[20:23], s49 offen lds
    s_waitcnt vmcnt(20) lgkmcnt(2)
    v_mfma_f32_32x32x16_bf16 v[96:111], a[32:35], a[160:163], 0
    ds_read_b64_tr_b16 a[8:9], v251 offset:11264
    ds_read_b64_tr_b16 a[10:11], v251 offset:44032
    v_mfma_f32_32x32x16_bf16 v[112:127], a[36:39], a[160:163], 0
    ds_read_b64_tr_b16 a[12:13], v252 offset:11264
    ds_read_b64_tr_b16 a[14:15], v252 offset:44032
    buffer_load_dwordx4 a[192:195], v242, s[40:43], s48 offen offset:1024 sc1
    s_waitcnt vmcnt(20)
    v_mfma_f32_32x32x16_bf16 v[96:111], a[40:43], a[164:167], v[96:111]
    ds_read_b64_tr_b16 a[16:17], v251 offset:12288
    ds_read_b64_tr_b16 a[18:19], v251 offset:45056
    s_add_u32 m0, s50, 0
    s_add_u32 s49, s81, 0x68000
    buffer_load_dwordx4 v241, s[20:23], s49 offen lds
    v_mfma_f32_32x32x16_bf16 v[112:127], a[44:47], a[164:167], v[112:127]
    ds_read_b64_tr_b16 a[20:21], v252 offset:12288
    ds_read_b64_tr_b16 a[22:23], v252 offset:45056
    s_waitcnt vmcnt(20)
    v_mfma_f32_32x32x16_bf16 v[96:111], a[0:3], a[168:171], v[96:111]
    ds_read_b64_tr_b16 a[24:25], v251 offset:13312
    ds_read_b64_tr_b16 a[26:27], v251 offset:46080
    s_lshr_b32 s48, s0, 4
    s_add_u32 s48, s48, s78
    s_add_u32 s48, s48, 0x6000
    buffer_load_dwordx4 a[160:163], v242, s[40:43], s48 offen sc1
    s_waitcnt lgkmcnt(3)
    v_mfma_f32_32x32x16_bf16 v[112:127], a[4:7], a[168:171], v[112:127]
    ds_read_b64_tr_b16 a[28:29], v252 offset:13312
    ds_read_b64_tr_b16 a[30:31], v252 offset:46080
    s_waitcnt vmcnt(20)
    v_mfma_f32_32x32x16_bf16 v[96:111], a[8:11], a[172:175], v[96:111]
    ds_read_b64_tr_b16 a[32:33], v251 offset:14336
    ds_read_b64_tr_b16 a[34:35], v251 offset:47104
    s_add_u32 m0, s50, 0x400
    s_add_u32 s49, s81, 0x6c000
    buffer_load_dwordx4 v241, s[20:23], s49 offen lds
    v_mfma_f32_32x32x16_bf16 v[112:127], a[12:15], a[172:175], v[112:127]
    ds_read_b64_tr_b16 a[36:37], v252 offset:14336
    ds_read_b64_tr_b16 a[38:39], v252 offset:47104
    buffer_load_dwordx4 a[164:167], v242, s[40:43], s48 offen offset:1024 sc1
    s_waitcnt vmcnt(21)
    v_mfma_f32_32x32x16_bf16 v[96:111], a[16:19], a[176:179], v[96:111]
    ds_read_b64_tr_b16 a[40:41], v251 offset:15360
    ds_read_b64_tr_b16 a[42:43], v251 offset:48128
    s_add_u32 m0, s50, 0x800
    s_add_u32 s49, s0, 0x68000
    buffer_load_dwordx4 v241, s[20:23], s49 offen lds
    s_waitcnt lgkmcnt(3)
    v_mfma_f32_32x32x16_bf16 v[112:127], a[20:23], a[176:179], v[112:127]
    ds_read_b64_tr_b16 a[44:45], v252 offset:15360
    ds_read_b64_tr_b16 a[46:47], v252 offset:48128
    s_barrier
    s_waitcnt vmcnt(21)
    v_mfma_f32_32x32x16_bf16 v[96:111], a[24:27], a[180:183], v[96:111]
    ds_read_b64_tr_b16 a[0:1], v251 offset:16384
    ds_read_b64_tr_b16 a[2:3], v251 offset:49152
    s_lshr_b32 s48, s1, 4
    s_add_u32 s48, s48, s78
    s_add_u32 s48, s48, 0x6000
    buffer_load_dwordx4 a[168:171], v242, s[40:43], s48 offen sc1
    v_mfma_f32_32x32x16_bf16 v[112:127], a[28:31], a[180:183], v[112:127]
    ds_read_b64_tr_b16 a[4:5], v252 offset:16384
    ds_read_b64_tr_b16 a[6:7], v252 offset:49152
    s_add_u32 m0, s50, 0xc00
    s_add_u32 s49, s0, 0x6c000
    buffer_load_dwordx4 v241, s[20:23], s49 offen lds
    s_waitcnt vmcnt(22)
    v_mfma_f32_32x32x16_bf16 v[96:111], a[32:35], a[184:187], v[96:111]
    ds_read_b64_tr_b16 a[8:9], v251 offset:17408
    ds_read_b64_tr_b16 a[10:11], v251 offset:50176
    buffer_load_dwordx4 a[172:175], v242, s[40:43], s48 offen offset:1024 sc1
    ds_write_b128 v237, v[224:227] offset:0
    s_lshr_b32 s48, s5, 4
    s_add_u32 s48, s48, s78
    s_add_u32 s48, s48, 0x6000
    buffer_load_dwordx4 a[176:179], v242, s[40:43], s48 offen sc1
    buffer_load_dwordx4 a[180:183], v242, s[40:43], s48 offen offset:1024 sc1
    s_waitcnt vmcnt(19)
    v_cmp_ne_u32 vcc, s56, v240
    s_cbranch_vccnz L_gatespin_27
L_gateok_26:
    s_waitcnt lgkmcnt(1)
    v_mfma_f32_32x32x16_bf16 v[112:127], a[36:39], a[184:187], v[112:127]
    ds_read_b64_tr_b16 a[12:13], v252 offset:17408
    ds_read_b64_tr_b16 a[14:15], v252 offset:50176
    s_add_u32 m0, s50, 0x1000
    s_add_u32 s49, s1, 0x68000
    buffer_load_dwordx4 v241, s[20:23], s49 offen lds
    v_mfma_f32_32x32x16_bf16 v[96:111], a[40:43], a[188:191], v[96:111]
    ds_read_b64_tr_b16 a[16:17], v251 offset:18432
    ds_read_b64_tr_b16 a[18:19], v251 offset:51200
    s_add_u32 m0, s50, 0x1400
    s_add_u32 s49, s1, 0x6c000
    buffer_load_dwordx4 v241, s[20:23], s49 offen lds
    v_mfma_f32_32x32x16_bf16 v[112:127], a[44:47], a[188:191], v[112:127]
    ds_read_b64_tr_b16 a[20:21], v252 offset:18432
    ds_read_b64_tr_b16 a[22:23], v252 offset:51200
    ds_write_b128 v237, v[228:231] offset:1024
    v_mfma_f32_32x32x16_bf16 v[96:111], a[0:3], v[128:131], v[96:111]
    ds_read_b64_tr_b16 a[24:25], v251 offset:19456
    ds_read_b64_tr_b16 a[26:27], v251 offset:52224
    s_add_u32 m0, s50, 0x1800
    s_add_u32 s49, s5, 0x68000
    buffer_load_dwordx4 v241, s[20:23], s49 offen lds
    v_mfma_f32_32x32x16_bf16 v[112:127], a[4:7], v[128:131], v[112:127]
    ds_read_b64_tr_b16 a[28:29], v252 offset:19456
    ds_read_b64_tr_b16 a[30:31], v252 offset:52224
    v_mfma_f32_32x32x16_bf16 v[96:111], a[8:11], v[132:135], v[96:111]
    ds_read_b64_tr_b16 a[32:33], v251 offset:20480
    ds_read_b64_tr_b16 a[34:35], v251 offset:53248
    s_lshr_b32 s48, s81, 4
    s_add_u32 s48, s48, s78
    s_add_u32 s48, s48, 0x6800
    buffer_load_dwordx4 a[184:187], v242, s[40:43], s48 offen sc1
    s_waitcnt lgkmcnt(4)
    v_mfma_f32_32x32x16_bf16 v[112:127], a[12:15], v[132:135], v[112:127]
    ds_read_b64_tr_b16 a[36:37], v252 offset:20480
    ds_read_b64_tr_b16 a[38:39], v252 offset:53248
    s_add_u32 m0, s50, 0x1c00
    s_add_u32 s49, s5, 0x6c000
    buffer_load_dwordx4 v241, s[20:23], s49 offen lds
    v_mfma_f32_32x32x16_bf16 v[96:111], a[16:19], v[136:139], v[96:111]
    ds_read_b64_tr_b16 a[40:41], v251 offset:21504
    ds_read_b64_tr_b16 a[42:43], v251 offset:54272
    buffer_load_dwordx4 a[188:191], v242, s[40:43], s48 offen offset:1024 sc1
    v_mfma_f32_32x32x16_bf16 v[112:127], a[20:23], v[136:139], v[112:127]
    ds_read_b64_tr_b16 a[44:45], v252 offset:21504
    ds_read_b64_tr_b16 a[46:47], v252 offset:54272
    s_lshr_b32 s48, s0, 4
    s_add_u32 s48, s48, s78
    s_add_u32 s48, s48, 0x6800
    buffer_load_dwordx4 v[128:131], v242, s[40:43], s48 offen sc1
    v_mfma_f32_32x32x16_bf16 v[96:111], a[24:27], v[144:147], v[96:111]
    ds_read_b64_tr_b16 a[0:1], v251 offset:22528
    ds_read_b64_tr_b16 a[2:3], v251 offset:55296
    buffer_load_dwordx4 v[132:135], v242, s[40:43], s48 offen offset:1024 sc1
    s_waitcnt lgkmcnt(3)
    v_mfma_f32_32x32x16_bf16 v[112:127], a[28:31], v[144:147], v[112:127]
    ds_read_b64_tr_b16 a[4:5], v252 offset:22528
    ds_read_b64_tr_b16 a[6:7], v252 offset:55296
    s_lshr_b32 s48, s1, 4
    s_add_u32 s48, s48, s78
    s_add_u32 s48, s48, 0x6800
    buffer_load_dwordx4 v[136:139], v242, s[40:43], s48 offen sc1
    s_waitcnt vmcnt(27)
    v_mfma_f32_32x32x16_bf16 v[96:111], a[32:35], v[140:143], v[96:111]
    ds_read_b64_tr_b16 a[8:9], v252 offset:23552
    ds_read_b64_tr_b16 a[10:11], v252 offset:56320
    buffer_load_dwordx4 v[144:147], v242, s[40:43], s48 offen offset:1024 sc1
    v_mfma_f32_32x32x16_bf16 v[112:127], a[36:39], v[140:143], v[112:127]
    ds_read_b64_tr_b16 a[12:13], v251 offset:23552
    ds_read_b64_tr_b16 a[14:15], v251 offset:56320
    s_lshr_b32 s48, s5, 4
    s_add_u32 s48, s48, s78
    s_add_u32 s48, s48, 0x6800
    buffer_load_dwordx4 v[164:167], v242, s[40:43], s48 offen sc1
    s_waitcnt vmcnt(22)
    s_barrier
    v_mfma_f32_32x32x16_bf16 v[96:111], a[40:43], v[148:151], v[96:111]
    ds_read_b64_tr_b16 a[16:17], v251 offset:24576
    ds_read_b64_tr_b16 a[18:19], v251 offset:57344
    buffer_load_dwordx4 v[140:143], v242, s[40:43], s48 offen offset:1024 sc1
    s_waitcnt lgkmcnt(2)
    v_mfma_f32_32x32x16_bf16 v[112:127], a[44:47], v[148:151], v[112:127]
    ds_read_b64_tr_b16 a[20:21], v252 offset:24576
    ds_read_b64_tr_b16 a[22:23], v252 offset:57344
    v_xor_b32 v32, 0, v238
    ds_read_b64 v[224:225], v32 offset:0
    v_xor_b32 v33, 16, v238
    ds_read_b64 v[226:227], v33 offset:0
    v_xor_b32 v34, 32, v238
    v_mfma_f32_32x32x16_bf16 v[96:111], a[0:3], v[152:155], v[96:111]
    ds_read_b64_tr_b16 a[24:25], v251 offset:25600
    ds_read_b64_tr_b16 a[26:27], v251 offset:58368
    ds_read_b64 v[228:229], v34 offset:0
    v_xor_b32 v35, 48, v238
    ds_read_b64 v[230:231], v35 offset:0
    v_mfma_f32_32x32x16_bf16 v[112:127], a[4:7], v[152:155], v[112:127]
    ds_read_b64_tr_b16 a[28:29], v252 offset:25600
    ds_read_b64_tr_b16 a[30:31], v252 offset:58368
    v_mfma_f32_32x32x16_bf16 v[112:127], a[8:11], v[156:159], v[112:127]
    ds_read_b64_tr_b16 a[32:33], v251 offset:26624
    ds_read_b64_tr_b16 a[34:35], v251 offset:59392
    v_mfma_f32_32x32x16_bf16 v[96:111], a[12:15], v[156:159], v[96:111]
    ds_read_b64_tr_b16 a[36:37], v252 offset:26624
    ds_read_b64_tr_b16 a[38:39], v252 offset:59392
    s_waitcnt lgkmcnt(6)
    v_mfma_f32_32x32x16_bf16 v[64:79], a[16:19], v[160:163], v[64:79]
    ds_read_b64_tr_b16 a[40:41], v251 offset:27648
    ds_read_b64_tr_b16 a[42:43], v251 offset:60416
    v_mfma_f32_32x32x16_bf16 v[80:95], a[20:23], v[160:163], v[80:95]
    ds_read_b64_tr_b16 a[44:45], v252 offset:27648
    ds_read_b64_tr_b16 a[46:47], v252 offset:60416
    ds_write_b128 v232, v[112:115] offset:0
    s_waitcnt vmcnt(22)
    v_mfma_f32_32x32x16_bf16 v[64:79], a[24:27], a[192:195], v[64:79]
    ds_read_b64_tr_b16 a[0:1], v251 offset:28672
    ds_read_b64_tr_b16 a[2:3], v251 offset:61440
    ds_write_b128 v232, v[116:119] offset:1024
    s_waitcnt lgkmcnt(6)
    v_mfma_f32_32x32x16_bf16 v[80:95], a[28:31], a[192:195], v[80:95]
    ds_read_b64_tr_b16 a[4:5], v252 offset:28672
    ds_read_b64_tr_b16 a[6:7], v252 offset:61440
    ds_write_b128 v232, v[120:123] offset:2048
    s_waitcnt vmcnt(20)
    v_mfma_f32_32x32x16_bf16 v[64:79], a[32:35], a[160:163], v[64:79]
L_padB_6:
    s_cbranch_execz L_backB
    ds_read_b64_tr_b16 a[8:9], v251 offset:29696
    ds_read_b64_tr_b16 a[10:11], v251 offset:62464
    ds_write_b128 v232, v[124:127] offset:3072
    v_lshlrev_b32 v48, 16, v224
    v_mfma_f32_32x32x16_bf16 v[80:95], a[36:39], a[160:163], v[80:95]
    ds_read_b64_tr_b16 a[12:13], v252 offset:29696
    ds_read_b64_tr_b16 a[14:15], v252 offset:62464
    v_and_b32 v49, s62, v224
    v_lshlrev_b32 v50, 16, v225
    v_and_b32 v51, s62, v225
    v_lshlrev_b32 v52, 16, v226
    s_waitcnt vmcnt(18)
    v_mfma_f32_32x32x16_bf16 v[64:79], a[40:43], a[164:167], v[64:79]
    ds_read_b64_tr_b16 a[16:17], v251 offset:30720
    ds_read_b64_tr_b16 a[18:19], v251 offset:63488
    v_and_b32 v53, s62, v226
    v_lshlrev_b32 v54, 16, v227
    v_and_b32 v55, s62, v227
    v_lshlrev_b32 v56, 16, v228
    s_waitcnt lgkmcnt(2)
    v_mfma_f32_32x32x16_bf16 v[80:95], a[44:47], a[164:167], v[80:95]
    ds_read_b64_tr_b16 a[20:21], v252 offset:30720
    ds_read_b64_tr_b16 a[22:23], v252 offset:63488
    v_and_b32 v57, s62, v228
    v_lshlrev_b32 v58, 16, v229
    v_and_b32 v59, s62, v229
    v_lshlrev_b32 v60, 16, v230
    s_waitcnt vmcnt(16)
    v_mfma_f32_32x32x16_bf16 v[64:79], a[0:3], a[168:171], v[64:79]
    ds_read_b64_tr_b16 a[24:25], v251 offset:31744
    ds_read_b64_tr_b16 a[26:27], v251 offset:64512
    v_and_b32 v61, s62, v230
    v_lshlrev_b32 v62, 16, v231
    v_and_b32 v63, s62, v231
    v_mfma_f32_32x32x16_bf16 v[80:95], a[4:7], a[168:171], v[80:95]
    ds_read_b64_tr_b16 a[28:29], v252 offset:31744
    ds_read_b64_tr_b16 a[30:31], v252 offset:64512
    s_waitcnt vmcnt(7)
    s_barrier
    v_mfma_f32_32x32x16_bf16 v[64:79], a[8:11], a[172:175], v[64:79]
    ds_read_b64_tr_b16 a[32:33], v252 offset:0
    ds_read_b64_tr_b16 a[34:35], v252 offset:32768
    ds_read_b128 v[16:19], v233 offset:0
    ds_read_b128 v[20:23], v233 offset:1024
    ds_read_b128 v[24:27], v233 offset:2048
    ds_read_b128 v[28:31], v233 offset:3072
    v_mfma_f32_32x32x16_bf16 v[80:95], a[12:15], a[172:175], v[80:95]
    ds_read_b64_tr_b16 a[36:37], v252 offset:1024
    ds_read_b64_tr_b16 a[38:39], v252 offset:33792
    s_waitcnt lgkmcnt(8)
    v_mfma_f32_32x32x16_bf16 v[64:79], a[16:19], a[176:179], v[64:79]
    ds_read_b64_tr_b16 a[40:41], v252 offset:2048
    ds_read_b64_tr_b16 a[42:43], v252 offset:34816
    v_mfma_f32_32x32x16_bf16 v[80:95], a[20:23], a[176:179], v[80:95]
    ds_read_b64_tr_b16 a[44:45], v252 offset:3072
    ds_read_b64_tr_b16 a[46:47], v252 offset:35840
    s_waitcnt lgkmcnt(6)
    v_add_f32 v16, v16, v96
    v_add_f32 v17, v17, v97
    v_add_f32 v18, v18, v98
    v_add_f32 v19, v19, v99
    v_mfma_f32_32x32x16_bf16 v[64:79], a[24:27], a[180:183], v[64:79]
    ds_read_b64_tr_b16 a[0:1], v252 offset:4096
    ds_read_b64_tr_b16 a[2:3], v252 offset:36864
    v_add_f32 v20, v20, v100
    v_add_f32 v21, v21, v101
    v_add_f32 v22, v22, v102
    v_add_f32 v23, v23, v103
    v_add_f32 v24, v24, v104
    v_mfma_f32_32x32x16_bf16 v[80:95], a[28:31], a[180:183], v[80:95]
    ds_read_b64_tr_b16 a[4:5], v252 offset:5120
    ds_read_b64_tr_b16 a[6:7], v252 offset:37888
    v_add_f32 v25, v25, v105
    v_add_f32 v26, v26, v106
    v_add_f32 v27, v27, v107
    v_add_f32 v28, v28, v108
    v_add_f32 v29, v29, v109
    v_mfma_f32_32x32x16_bf16 v[80:95], a[32:35], a[184:187], v[80:95]
    ds_read_b64_tr_b16 a[8:9], v252 offset:6144
    ds_read_b64_tr_b16 a[10:11], v252 offset:38912
    v_add_f32 v30, v30, v110
    v_add_f32 v31, v31, v111
    v_mov_b32 v38, 0xbfb8aa3b
    v_mov_b32 v39, 0xbfb8aa3b
    s_waitcnt vmcnt(6) lgkmcnt(2)
    v_mfma_f32_32x32x16_bf16 v[80:95], a[36:39], a[188:191], v[80:95]
    ds_read_b64_tr_b16 a[12:13], v252 offset:7168
    ds_read_b64_tr_b16 a[14:15], v252 offset:39936
    v_mov_b32 v40, 1.0
    v_mov_b32 v41, 1.0
    s_waitcnt vmcnt(5)
    v_mfma_f32_32x32x16_bf16 v[80:95], a[40:43], v[128:131], v[80:95]
    ds_read_b64_tr_b16 a[16:17], v251 offset:0
    ds_read_b64_tr_b16 a[18:19], v251 offset:32768
    s_waitcnt vmcnt(4)
    v_mfma_f32_32x32x16_bf16 v[80:95], a[44:47], v[132:135], v[80:95]
    ds_read_b64_tr_b16 a[20:21], v251 offset:1024
    ds_read_b64_tr_b16 a[22:23], v251 offset:33792
    s_waitcnt vmcnt(3)
    v_mfma_f32_32x32x16_bf16 v[80:95], a[0:3], v[136:139], v[80:95]
    ds_read_b64_tr_b16 a[24:25], v251 offset:2048
    ds_read_b64_tr_b16 a[26:27], v251 offset:34816
    s_waitcnt vmcnt(2)
    v_mfma_f32_32x32x16_bf16 v[80:95], a[4:7], v[144:147], v[80:95]
    ds_read_b64_tr_b16 a[28:29], v251 offset:3072
    ds_read_b64_tr_b16 a[30:31], v251 offset:35840
    s_waitcnt vmcnt(1) lgkmcnt(5)
    v_mfma_f32_32x32x16_bf16 v[80:95], a[8:11], v[164:167], v[80:95]
    ds_read_b64_tr_b16 a[32:33], v251 offset:4096
    ds_read_b64_tr_b16 a[34:35], v251 offset:36864
    s_waitcnt vmcnt(0)
    v_mfma_f32_32x32x16_bf16 v[80:95], a[12:15], v[140:143], v[80:95]
    ds_read_b64_tr_b16 a[36:37], v251 offset:5120
    ds_read_b64_tr_b16 a[38:39], v251 offset:37888
    v_mfma_f32_32x32x16_bf16 v[64:79], a[16:19], a[184:187], v[64:79]
    ds_read_b64_tr_b16 a[40:41], v251 offset:6144
    ds_read_b64_tr_b16 a[42:43], v251 offset:38912
    s_waitcnt lgkmcnt(6)
    v_mfma_f32_32x32x16_bf16 v[64:79], a[20:23], a[188:191], v[64:79]
    ds_read_b64_tr_b16 a[44:45], v251 offset:7168
    ds_read_b64_tr_b16 a[46:47], v251 offset:39936
    v_mfma_f32_32x32x16_bf16 v[64:79], a[24:27], v[128:131], v[64:79]
    v_mfma_f32_32x32x16_bf16 v[64:79], a[28:31], v[132:135], v[64:79]
    s_waitcnt lgkmcnt(4)
    v_mfma_f32_32x32x16_bf16 v[64:79], a[32:35], v[136:139], v[64:79]
    ds_write_b128 v232, v[80:83] offset:16384
    ds_write_b128 v232, v[84:87] offset:17408
    ds_write_b128 v232, v[88:91] offset:18432
    v_mfma_f32_32x32x16_bf16 v[64:79], a[36:39], v[144:147], v[64:79]
    ds_write_b128 v232, v[92:95] offset:19456
    s_waitcnt lgkmcnt(4)
    v_mfma_f32_32x32x16_bf16 v[64:79], a[40:43], v[164:167], v[64:79]
    s_waitcnt lgkmcnt(0)
    s_barrier
    ds_read_b128 v[0:3], v233 offset:16384
    ds_read_b128 v[4:7], v233 offset:17408
    ds_read_b128 v[8:11], v233 offset:18432
    ds_read_b128 v[12:15], v233 offset:19456
    v_mfma_f32_32x32x16_bf16 v[64:79], a[44:47], v[140:143], v[64:79]
    s_waitcnt lgkmcnt(3)
    s_nop 10
    v_pk_add_f32 v[0:1], v[0:1], v[64:65]
    v_pk_add_f32 v[2:3], v[2:3], v[66:67]
    v_pk_mul_f32 v[112:113], v[0:1], v[38:39]
    v_pk_mul_f32 v[114:115], v[2:3], v[38:39]
    v_pk_mul_f32 v[0:1], v[0:1], v[16:17]
    v_pk_mul_f32 v[2:3], v[2:3], v[18:19]
    v_exp_f32 v112, v112
    v_exp_f32 v113, v113
    v_exp_f32 v114, v114
    v_exp_f32 v115, v115
    s_waitcnt lgkmcnt(0)
    v_pk_add_f32 v[4:5], v[4:5], v[68:69]
    v_pk_add_f32 v[6:7], v[6:7], v[70:71]
    v_pk_mul_f32 v[116:117], v[4:5], v[38:39]
    v_pk_mul_f32 v[118:119], v[6:7], v[38:39]
    v_pk_mul_f32 v[4:5], v[4:5], v[20:21]
    v_pk_mul_f32 v[6:7], v[6:7], v[22:23]
    v_exp_f32 v116, v116
    v_exp_f32 v117, v117
    v_exp_f32 v118, v118
    v_exp_f32 v119, v119
    v_pk_add_f32 v[8:9], v[8:9], v[72:73]
    v_pk_add_f32 v[10:11], v[10:11], v[74:75]
    v_pk_mul_f32 v[120:121], v[8:9], v[38:39]
    v_pk_mul_f32 v[122:123], v[10:11], v[38:39]
    v_pk_mul_f32 v[8:9], v[8:9], v[24:25]
    v_pk_mul_f32 v[10:11], v[10:11], v[26:27]
    v_exp_f32 v120, v120
    v_exp_f32 v121, v121
    v_exp_f32 v122, v122
    v_exp_f32 v123, v123
    v_pk_add_f32 v[12:13], v[12:13], v[76:77]
    v_pk_add_f32 v[14:15], v[14:15], v[78:79]
    v_pk_mul_f32 v[124:125], v[12:13], v[38:39]
    v_pk_mul_f32 v[126:127], v[14:15], v[38:39]
    v_pk_mul_f32 v[12:13], v[12:13], v[28:29]
    v_pk_mul_f32 v[14:15], v[14:15], v[30:31]
    v_exp_f32 v124, v124
    v_exp_f32 v125, v125
    v_exp_f32 v126, v126
    v_exp_f32 v127, v127
    v_pk_add_f32 v[112:113], v[112:113], v[40:41]
    v_pk_add_f32 v[114:115], v[114:115], v[40:41]
    v_rcp_f32 v112, v112
    v_rcp_f32 v113, v113
    v_rcp_f32 v114, v114
    v_rcp_f32 v115, v115
    v_pk_add_f32 v[116:117], v[116:117], v[40:41]
    v_pk_add_f32 v[118:119], v[118:119], v[40:41]
    v_rcp_f32 v116, v116
    v_rcp_f32 v117, v117
    v_rcp_f32 v118, v118
    v_rcp_f32 v119, v119
    v_pk_add_f32 v[120:121], v[120:121], v[40:41]
    v_pk_add_f32 v[122:123], v[122:123], v[40:41]
    v_rcp_f32 v120, v120
    v_rcp_f32 v121, v121
    v_rcp_f32 v122, v122
    v_rcp_f32 v123, v123
    v_pk_add_f32 v[124:125], v[124:125], v[40:41]
    v_pk_add_f32 v[126:127], v[126:127], v[40:41]
    v_rcp_f32 v124, v124
    v_rcp_f32 v125, v125
    v_rcp_f32 v126, v126
    v_rcp_f32 v127, v127
    v_pk_fma_f32 v[0:1], v[0:1], v[112:113], v[48:49]
    v_pk_fma_f32 v[2:3], v[2:3], v[114:115], v[50:51]
    v_cvt_pk_bf16_f32 v224, v0, v1
    v_cvt_pk_bf16_f32 v225, v2, v3
    ds_write_b64 v244, v[224:225] offset:0
    v_pk_fma_f32 v[4:5], v[4:5], v[116:117], v[52:53]
    v_pk_fma_f32 v[6:7], v[6:7], v[118:119], v[54:55]
    v_cvt_pk_bf16_f32 v226, v4, v5
    v_cvt_pk_bf16_f32 v227, v6, v7
    ds_write_b64 v244, v[226:227] offset:16
    v_pk_fma_f32 v[8:9], v[8:9], v[120:121], v[56:57]
    v_pk_fma_f32 v[10:11], v[10:11], v[122:123], v[58:59]
    v_cvt_pk_bf16_f32 v228, v8, v9
    v_cvt_pk_bf16_f32 v229, v10, v11
    ds_write_b64 v244, v[228:229] offset:32
    v_pk_fma_f32 v[12:13], v[12:13], v[124:125], v[60:61]
    v_pk_fma_f32 v[14:15], v[14:15], v[126:127], v[62:63]
    v_cvt_pk_bf16_f32 v230, v12, v13
    v_cvt_pk_bf16_f32 v231, v14, v15
    ds_write_b64 v244, v[230:231] offset:48
    s_waitcnt lgkmcnt(0)
    s_barrier
    ds_read_b128 v[112:115], v245 offset:0
    ds_read_b128 v[116:119], v245 offset:1152
    s_waitcnt lgkmcnt(1)
    buffer_store_dwordx4 v[112:115], v236, s[36:39], s66 offen
    s_waitcnt lgkmcnt(0)
    buffer_store_dwordx4 v[116:119], v236, s[36:39], s72 offen
    s_endpgm
L_tagspin_17:
    s_mov_b32 s64, 0
L_tagspin_17_l:
    buffer_load_dword v248, off, s[24:27], 0 sc1
    s_add_u32 s64, s64, 1
    s_waitcnt vmcnt(0)
    v_readfirstlane_b32 s56, v248
    s_cmp_ge_u32 s64, 65536
    s_cbranch_scc1 L_tagok_16
    s_cmp_eq_u32 s56, 0
    s_cbranch_scc1 L_tagspin_17_l
    s_branch L_tagok_16
L_gatespin_19:
    s_mov_b32 s64, 0
L_gatespin_19_l:
    buffer_load_dword v249, v250, s[40:43], s58 offen offset:0 sc1
    s_waitcnt vmcnt(0)
    v_cmp_ne_u32 vcc, s56, v249
    s_cbranch_vccz L_gateok_18
    s_add_u32 s64, s64, 1
    s_cmp_ge_u32 s64, 65536
    s_cbranch_scc0 L_gatespin_19_l
    s_branch L_gateok_18
L_gatespin_21:
    s_mov_b32 s64, 0
L_gatespin_21_l:
    buffer_load_dword v36, v250, s[40:43], s58 offen offset:128 sc1
    s_waitcnt vmcnt(0)
    v_cmp_ne_u32 vcc, s56, v36
    s_cbranch_vccz L_gateok_20
    s_add_u32 s64, s64, 1
    s_cmp_ge_u32 s64, 65536
    s_cbranch_scc0 L_gatespin_21_l
    s_branch L_gateok_20
L_gatespin_23:
    s_mov_b32 s64, 0
L_gatespin_23_l:
    buffer_load_dword v47, v250, s[40:43], s58 offen offset:512 sc1
    s_waitcnt vmcnt(0)
    v_cmp_ne_u32 vcc, s56, v47
    s_cbranch_vccz L_gateok_22
    s_add_u32 s64, s64, 1
    s_cmp_ge_u32 s64, 65536
    s_cbranch_scc0 L_gatespin_23_l
    s_branch L_gateok_22
L_gatespin_25:
    s_mov_b32 s64, 0
L_gatespin_25_l:
    buffer_load_dword v37, v250, s[40:43], s58 offen offset:256 sc1
    s_waitcnt vmcnt(0)
    v_cmp_ne_u32 vcc, s56, v37
    s_cbranch_vccz L_gateok_24
    s_add_u32 s64, s64, 1
    s_cmp_ge_u32 s64, 65536
    s_cbranch_scc0 L_gatespin_25_l
    s_branch L_gateok_24
L_gatespin_27:
    s_mov_b32 s64, 0
L_gatespin_27_l:
    buffer_load_dword v240, v250, s[40:43], s58 offen offset:640 sc1
    s_waitcnt vmcnt(0)
    v_cmp_ne_u32 vcc, s56, v240
    s_cbranch_vccz L_gateok_26
    s_add_u32 s64, s64, 1
    s_cmp_ge_u32 s64, 65536
    s_cbranch_scc0 L_gatespin_27_l
    s_branch L_gateok_26
L_end:
    s_endpgm
L_code_end:
.p2align 12
.section .rodata,"a"
.p2align 6
.amdhsa_kernel recurrent_scan__sliding_local_dilated__glu_gated_bilinear__prompt_kernel
  .amdhsa_next_free_vgpr 512
  .amdhsa_next_free_sgpr 102
  .amdhsa_accum_offset 256
  .amdhsa_group_segment_fixed_size 0
  .amdhsa_kernarg_size 80
  .amdhsa_user_sgpr_count 2
  .amdhsa_user_sgpr_kernarg_segment_ptr 1
  .amdhsa_system_sgpr_workgroup_id_x 1
.end_amdhsa_kernel
```
